```python
import torch

def _softmax(x, axis=-1):
    return torch.softmax(x, dim=axis)
def _gelu(x):
    return torch.nn.functional.gelu(x, approximate="tanh")
def _silu(x):
    return torch.nn.functional.silu(x)
def _sigmoid(x):
    return torch.sigmoid(x)
def _layernorm(x, axis=-1, eps=1e-5):
    m = x.mean(dim=axis, keepdim=True)
    v = x.var(dim=axis, keepdim=True, unbiased=False)
    return (x - m) / torch.sqrt(v + eps)
def _scatter_add(tgt, idx, src, axis=0):
    return tgt.clone().index_add_(axis, idx, src)
def _segment_sum(src, seg, n):
    out = torch.zeros((n,) + src.shape[1:], dtype=src.dtype)
    return out.index_add_(0, seg, src)
def _pad(x, pw):
    flat = tuple(v for pair in reversed(pw) for v in pair)
    return torch.nn.functional.pad(x, flat)

kernel_name = 'interleave_layers__linear_kernel_hedgehog__geglu_ffn__prompt'

def setup_inputs():

    _w = (lambda a: (lambda t: t.to(torch.bfloat16) if t.is_floating_point() else t)(torch.as_tensor(a)))
    def _A_setup():
        B, S, D, H = 1, 2048, 512, 32
        Dh = D // H
        return {
            "x": _w((lambda *s: torch.randn(*s, dtype=torch.bfloat16) * 0.05)(B, S, D)),
            "wqkv": _w((lambda *s: torch.randn(*s, dtype=torch.bfloat16) * 0.2)(D, 3 * D)),
            "w_phi": _w((lambda *s: torch.randn(*s, dtype=torch.bfloat16) * 0.2)(H, Dh, Dh) * (Dh ** -0.5)),
            "wo": _w((lambda *s: torch.randn(*s, dtype=torch.bfloat16) * 0.05)(D, D)),
        }
    _A_in = _A_setup()

    def _B_setup():
        B, S, D, F = 1, 2048, 512, 1792
        return {
            "x": _w((lambda *s: torch.randn(*s, dtype=torch.bfloat16) * 0.05)(B, S, D)),
            "w_gate": _w((lambda *s: torch.randn(*s, dtype=torch.bfloat16) * 0.05)(D, F)),
            "w_up": _w((lambda *s: torch.randn(*s, dtype=torch.bfloat16) * 0.05)(D, F)),
            "w_down": _w((lambda *s: torch.randn(*s, dtype=torch.bfloat16) * 0.05)(F, D)),
        }
    _B_in = _B_setup()

    return {
        "A_x": _A_in["x"],
        "A_wqkv": _A_in["wqkv"],
        "A_w_phi": _A_in["w_phi"],
        "A_wo": _A_in["wo"],
        "B_x": _B_in["x"],
        "B_w_gate": _B_in["w_gate"],
        "B_w_up": _B_in["w_up"],
        "B_w_down": _B_in["w_down"],
    }

def reference(A_x, A_wqkv, A_w_phi, A_wo, B_x, B_w_gate, B_w_up, B_w_down):
    def _A_ref(x, wqkv, w_phi, wo):
        B, S, D = x.shape
        H = 32; Dh = D // H
        qkv = (lambda x, *d: x.permute(*d))((x @ wqkv).reshape(B, S, 3, H, Dh), 2, 0, 3, 1, 4)
        q, k, v = qkv[0], qkv[1], qkv[2]
        pq = torch.einsum("bhsd,hdf->bhsf", q, w_phi)
        pk = torch.einsum("bhsd,hdf->bhsf", k, w_phi)
        phi_q = torch.concatenate([_softmax(pq, axis=-1), _softmax(-pq, axis=-1)], axis=-1)
        phi_k = torch.concatenate([_softmax(pk, axis=-1), _softmax(-pk, axis=-1)], axis=-1)
        kv = torch.einsum("bhsf,bhsd->bhfd", phi_k, v)
        z  = torch.einsum("bhsf->bhf", phi_k)
        num = torch.einsum("bhqf,bhfd->bhqd", phi_q, kv)
        den = torch.einsum("bhqf,bhf->bhq", phi_q, z)[..., None] + 1e-6
        o = num / den
        return (lambda x, *d: x.permute(*d))(o, 0, 2, 1, 3).reshape(B, S, D) @ wo

    def _B_ref(x, w_gate, w_up, w_down):
        return (_gelu(x @ w_gate) * (x @ w_up)) @ w_down

    x = A_x
    x = x + _A_ref(_layernorm(x, axis=-1), A_wqkv, A_w_phi, A_wo)
    x = x + _B_ref(_layernorm(x, axis=-1), B_w_gate, B_w_up, B_w_down)
    x = x + _A_ref(_layernorm(x, axis=-1), A_wqkv, A_w_phi, A_wo)
    x = x + _B_ref(_layernorm(x, axis=-1), B_w_gate, B_w_up, B_w_down)
    return x
```

```asm
; @launch grid=(256,1,1) block=(256,1,1) lds=163840
.amdgcn_target "amdgcn-amd-amdhsa--gfx950"
.text
.globl interleave_layers__linear_kernel_hedgehog__geglu_ffn__prompt_kernel
.p2align 8
.type interleave_layers__linear_kernel_hedgehog__geglu_ffn__prompt_kernel,@function
interleave_layers__linear_kernel_hedgehog__geglu_ffn__prompt_kernel:
    s_cmp_ge_u32 s2, 256
    s_cbranch_scc1 L_end
    s_getpc_b64 s[12:13]
L_pc:
    s_bfe_u32 s3, s2, 0x30003
    s_lshl_b32 s3, s3, 13
    v_lshl_add_u32 v1, v0, 5, s3
    v_min_u32 v1, L_codeend-L_pc-4, v1
    global_load_dword v21, v1, s[12:13]
    s_load_dwordx16 s[40:55], s[0:1], 0x0
    s_load_dwordx4 s[56:59], s[0:1], 0x40
    s_load_dwordx2 s[60:61], s[0:1], 0x50
    v_lshrrev_b32 v2, 6, v0
    v_bfe_u32 v29, v0, 3, 3
    v_readfirstlane_b32 s32, v2
    v_and_b32 v30, 7, v0
    v_lshlrev_b32 v30, 4, v30
    v_and_b32 v63, 63, v0
    s_and_b32 s65, s2, 7
    s_lshr_b32 s66, s2, 3
    s_cmp_lt_u32 s2, 192
    s_cselect_b32 s22, 3, 1
    s_cselect_b32 s39, 0, 24
    s_lshl_b32 s70, s22, 10
    s_lshl_b32 s22, s22, 19
    s_sub_u32 s71, s66, s39
    s_lshl_b32 s62, s65, 2
    s_add_u32 s62, s62, s32
    s_lshl_b32 s62, s62, 4
    s_mul_i32 s69, s62, s70
    s_lshl_b32 s39, s71, 7
    s_add_u32 s69, s69, s39
    v_mad_u32_u24 v52, v29, s70, v30
    s_lshl_b32 s70, s70, 3
    s_add_u32 s70, s70, s69
    s_lshl_b32 s64, s32, 11
    s_add_u32 m0, s64, 122880
    s_mov_b32 s23, 0x20000
    s_mov_b32 s27, 0x20000
    s_mov_b32 s26, 0x200000
    s_lshl_b32 s63, s65, 5
    s_add_u32 s63, s63, s66
    s_lshl_b32 s63, s63, 13
    s_add_u32 s63, s63, s64
    v_lshlrev_b32_e64 v53, 5, v63
    s_mov_b32 s39, 3584
    v_mad_u32_u24 v54, v29, s39, v30
    s_mul_i32 s62, s62, s39
    v_lshl_add_u32 v55, v29, 10, v30
    s_cmp_lt_u32 s2, 192
    s_waitcnt lgkmcnt(0)
    s_cselect_b32 s20, s42, s46
    s_cselect_b32 s21, s43, s47
    s_and_b32 s21, s21, 0xffff
    buffer_load_dwordx4 v52, s[20:23], s69 offen nt lds
    s_add_u32 m0, s64, 123904
    s_mov_b32 s24, s40
    buffer_load_dwordx4 v52, s[20:23], s70 offen nt lds
    s_and_b32 s25, s41, 0xffff
    buffer_load_dword v21, v53, s[24:27], s63 offen nt
    s_lshl_b32 s39, s66, 7
    s_add_u32 s62, s62, s39
    s_add_u32 s63, s62, 28672
    s_cmp_lt_u32 s2, 224
    s_cselect_b32 s22, 0x1c0000, 0
    s_mov_b32 s20, s50
    s_and_b32 s21, s51, 0xffff
    s_add_u32 m0, s64, 131072
    s_nop 0
    buffer_load_dwordx4 v54, s[20:23], s62 offen nt lds
    s_add_u32 m0, s64, 132096
    s_nop 0
    buffer_load_dwordx4 v54, s[20:23], s63 offen nt lds
    s_mov_b32 s20, s52
    s_and_b32 s21, s53, 0xffff
    s_add_u32 m0, s64, 139264
    s_nop 0
    buffer_load_dwordx4 v54, s[20:23], s62 offen nt lds
    s_add_u32 m0, s64, 140288
    s_nop 0
    buffer_load_dwordx4 v54, s[20:23], s63 offen nt lds
    s_mov_b32 s20, s54
    s_and_b32 s21, s55, 0xffff
    s_lshl_b32 s62, s66, 2
    s_add_u32 s62, s62, s32
    s_lshl_b32 s62, s62, 14
    s_lshl_b32 s39, s65, 7
    s_add_u32 s62, s62, s39
    s_add_u32 s63, s62, 8192
    s_add_u32 m0, s64, 147456
    s_nop 0
    buffer_load_dwordx4 v55, s[20:23], s62 offen nt lds
    s_add_u32 m0, s64, 148480
    s_nop 0
    buffer_load_dwordx4 v55, s[20:23], s63 offen nt lds
    s_load_dwordx2 s[28:29], s[60:61], 0x0
    s_mov_b32 s4, s60
    s_and_b32 s5, s61, 0xffff
    s_mov_b32 s6, 0x1900000
    s_mov_b32 s7, 0x20000
    s_mov_b32 s16, s60
    s_and_b32 s17, s61, 0xffff
    s_mov_b32 s19, 0x20000
    s_cmp_lt_u32 s2, 192
    s_cselect_b32 s18, 0x1900000, 0
    v_lshlrev_b32 v0, 4, v63
    v_lshlrev_b32 v1, 2, v63
    s_getreg_b32 s75, hwreg(HW_REG_XCC_ID, 0, 4)
    s_and_b32 s31, s66, 15
    s_lshr_b32 s62, s66, 4
    s_lshl_b32 s30, s65, 1
    s_add_u32 s30, s30, s62
    s_mov_b32 s80, 0x3f803f80
    v_and_b32 v24, 31, v63
    v_lshrrev_b32 v25, 5, v63
    v_and_b32_e64 v26, 15, v63
    v_bfe_u32 v27, v63, 4, 1
    v_lshrrev_b32 v28, 4, v63
    s_lshl_b32 s97, s30, 2
    s_lshr_b32 s39, s31, 3
    s_lshl_b32 s39, s39, 1
    s_add_u32 s98, s97, s39
    s_add_u32 s97, s97, s32
    s_and_b32 s95, s31, 7
    v_lshrrev_b32 v31, 2, v26
    v_lshl_add_u32 v31, v25, 2, v31
    v_lshlrev_b32 v31, 7, v31
    v_and_b32 v32, 3, v26
    v_lshl_add_u32 v31, v32, 3, v31
    v_lshlrev_b32 v33, 2, v24
    s_mov_b32 s20, s44
    s_and_b32 s21, s45, 0xffff
    s_mov_b32 s22, 0x4000
    s_mov_b32 s23, 0x20000
    s_lshl_b32 s39, s31, 10
    s_lshl_b32 s62, s32, 8
    s_add_u32 s39, s39, s62
    s_add_u32 m0, s62, 156672
    s_nop 0
    buffer_load_dword v1, s[20:23], s39 offen lds
    s_sub_u32 s12, s12, L_pc-interleave_layers__linear_kernel_hedgehog__geglu_ffn__prompt_kernel
    s_subb_u32 s13, s13, 0
    s_lshl_b32 s39, s31, 2
    s_add_u32 s39, s39, s32
    s_mul_i32 s76, s39, 10240
    s_add_u32 s76, s76, 0x1600000
    v_lshrrev_b32 v9, 1, v28
    v_lshlrev_b32_e64 v9, 8, v9
    v_lshl_add_u32 v9, v26, 4, v9
    v_lshl_add_u32 v9, v27, 3, v9
    s_lshl_b32 s39, s30, 9
    v_add_u32_e64 v9, s39, v9
    s_lshl_b32 s39, s30, 7
    s_add_u32 s39, s39, 8192
    v_lshlrev_b32_e64 v10, 3, v28
    v_lshl_add_u32 v10, v32, 5, v10
    v_add_u32 v10, s39, v10
    v_mov_b32 v40, -1
    v_mov_b32_e64 v41, -1
    buffer_store_dwordx2 v[40:41], v9, s[4:7], s76 offen sc1
    buffer_store_dwordx2 v[40:41], v10, s[4:7], s76 offen sc1
    s_lshl_b32 s67, s65, 7
    s_add_u32 s67, s67, 32768
    s_lshl_b32 s39, s66, 2
    s_add_u32 s39, s39, s32
    s_mul_i32 s62, s39, 147
    s_lshr_b32 s62, s62, 10
    s_mul_i32 s62, s62, 3
    s_add_u32 s39, s39, s62
    s_add_u32 s39, s39, 3
    s_mul_i32 s39, s39, 33792
    s_add_u32 s68, s39, 0x100000
    s_lshl_b32 s14, s65, 12
    s_add_u32 s14, s14, s68
    s_add_u32 s72, s68, s67
    s_lshl_b32 s39, s65, 1
    s_lshr_b32 s63, s32, 1
    s_add_u32 s39, s39, s63
    s_mul_i32 s39, s39, 112
    s_lshl_b32 s63, s66, 2
    s_add_u32 s39, s39, s63
    s_and_b32 s62, s32, 1
    s_lshl_b32 s63, s62, 1
    s_add_u32 s39, s39, s63
    s_lshl_b32 s39, s39, 10
    s_add_u32 s15, s39, 0x700000
    s_lshr_b32 s93, s71, 3
    s_add_u32 s93, s93, 2
    s_cmp_ge_u32 s93, 3
    s_cselect_b32 s39, 3, 0
    s_sub_u32 s93, s93, s39
    s_and_b32 s39, s71, 7
    s_lshl_b32 s39, s39, 1
    s_add_u32 s39, s39, s62
    s_lshl_b32 s63, s39, 15
    s_add_u32 s63, s63, 0x680000
    s_mul_i32 s39, s39, 10
    s_add_u32 s93, s93, s39
    s_mul_i32 s93, s93, 33792
    s_add_u32 s93, s93, 0x100000
    s_add_u32 s94, s93, s67
    s_cmp_lt_u32 s2, 192
    s_cselect_b32 s93, s93, s63
    s_lshl_b32 s39, s65, 12
    s_add_u32 s93, s93, s39
    s_lshr_b32 s39, s32, 1
    s_lshl_b32 s39, s39, 11
    s_add_u32 s93, s93, s39
    v_add_u32 v2, 0, v0
    v_add_u32 v3, 33792, v0
    v_add_u32 v4, 67584, v0
    v_add_u32 v5, 101376, v0
    v_add_u32 v20, 135168, v0
    s_lshl_b32 s39, s32, 5
    v_add_u32 v6, s39, v24
    v_mul_u32_u24 v6, 200, v6
    v_lshl_add_u32 v6, v25, 3, v6
    v_add_u32 v6, 135168, v6
    v_lshrrev_b32_e64 v43, 2, v26
    v_lshl_add_u32 v43, v28, 3, v43
    v_mul_u32_u24 v43, 200, v43
    v_lshl_add_u32 v43, v32, 3, v43
    s_lshl_b32 s39, s32, 5
    s_add_u32 s39, s39, 135168
    v_add_u32 v7, s39, v43
    s_lshr_b32 s39, s32, 1
    s_lshl_b32 s39, s39, 5
    s_add_u32 s39, s39, 135296
    v_add_u32 v8, s39, v43
    v_lshlrev_b32 v11, 4, v30
    v_lshl_add_u32 v11, v25, 7, v11
    v_lshl_add_u32 v11, v27, 4, v11
    v_add_u32 v11, 8192, v11
    v_lshlrev_b32_e64 v12, 9, v27
    v_lshl_add_u32 v12, v26, 4, v12
    v_lshl_add_u32 v12, v25, 3, v12
    s_lshl_b32 s39, s32, 10
    s_add_u32 s39, s39, 135168
    v_add_u32 v12, s39, v12
    s_and_b32 s39, s32, 1
    s_lshl_b32 s39, s39, 8
    v_xor_b32 v13, s39, v0
    v_lshlrev_b32 v14, 2, v0
    v_bfe_u32 v15, v63, 2, 1
    v_lshlrev_b32_e64 v15, 10, v15
    v_lshl_add_u32 v15, v32, 3, v15
    s_lshl_b32 s77, s30, 10
    s_add_u32 s77, s77, 0x11000
    v_lshlrev_b32 v19, 3, v26
    v_add_u32 v19, s77, v19
    s_lshl_b32 s39, s31, 3
    s_add_u32 s77, s77, s39
    s_and_b32 s39, s30, 1
    s_lshl_b32 s39, s39, 7
    s_lshr_b32 s62, s30, 1
    s_add_u32 s39, s39, s62
    v_lshlrev_b32 v44, 3, v26
    v_add_u32 v44, s39, v44
    v_subrev_u32 v45, 2, v29
    v_lshlrev_b32 v45, 6, v45
    v_lshrrev_b32 v46, 4, v30
    s_lshr_b32 s39, s31, 1
    s_lshl_b32 s39, s39, 3
    v_add3_u32 v45, v45, v46, s39
    v_subrev_u32 v47, 16, v63
    v_cmp_gt_u32 vcc, 24, v47
    s_nop 1
    v_cndmask_b32 v44, v44, v45, vcc
    s_lshl_b32 s39, s95, 3
    s_add_u32 s39, s39, 192
    v_add_u32 v45, s39, v46
    v_cmp_eq_u32 vcc, 5, v29
    s_nop 1
    v_cndmask_b32 v44, v44, v45, vcc
    v_and_b32 v45, 1, v26
    v_lshlrev_b32 v45, 7, v45
    v_lshrrev_b32_e64 v47, 1, v26
    s_lshl_b32 s39, s31, 3
    v_add3_u32 v45, v45, v47, s39
    v_cmp_eq_u32 vcc, 3, v28
    s_nop 1
    v_cndmask_b32 v44, v44, v45, vcc
    v_lshlrev_b32 v44, 7, v44
    v_add_u32 v62, 0x1000, v44
    s_mul_i32 s39, s31, 7
    s_add_u32 s62, s39, 6
    s_lshr_b32 s39, s39, 2
    s_lshr_b32 s62, s62, 2
    v_add_u32 v44, s39, v29
    v_min_u32 v44, s62, v44
    v_lshl_add_u32 v44, v44, 3, v46
    v_subrev_u32 v45, 24, v63
    v_and_b32 v45, 31, v45
    v_lshlrev_b32 v45, 3, v45
    v_add_u32 v45, s95, v45
    v_cmp_gt_u32 vcc, 24, v63
    s_nop 1
    v_cndmask_b32 v44, v45, v44, vcc
    v_lshlrev_b32 v44, 7, v44
    v_add_u32 v18, 0x9000, v44
    v_lshlrev_b32 v44, 3, v27
    v_sub_u32 v44, v26, v44
    v_and_b32 v45, 1, v44
    v_lshlrev_b32 v45, 4, v45
    v_mov_b32 v46, 0x3f80
    v_lshlrev_b32 v45, v45, v46
    v_lshrrev_b32 v44, 1, v44
    v_cmp_eq_u32 vcc, 0, v44
    s_nop 1
    v_cndmask_b32 v80, 0, v45, vcc
    v_cmp_eq_u32 vcc, 1, v44
    s_nop 1
    v_cndmask_b32 v81, 0, v45, vcc
    v_cmp_eq_u32 vcc, 2, v44
    s_nop 1
    v_cndmask_b32 v82, 0, v45, vcc
    v_cmp_eq_u32 vcc, 3, v44
    s_nop 1
    v_cndmask_b32 v83, 0, v45, vcc
    ds_write_b128 v20, v[80:83] offset:27648
    v_lshrrev_b32 v36, 1, v29
    v_lshlrev_b32 v36, 4, v36
    v_xor_b32_e64 v36, v36, v30
    v_lshl_add_u32 v104, v29, 10, v36
    v_xor_b32_e64 v105, 64, v104
    v_bfe_u32 v36, v24, 1, 3
    v_lshlrev_b32 v36, 4, v36
    v_lshlrev_b32 v37, 7, v24
    v_lshl_add_u32 v37, v25, 3, v37
    s_lshl_b32 s39, s32, 15
    v_add_u32 v37, s39, v37
    v_xor_b32 v96, 0, v36
    v_add_u32 v96, v96, v37
    v_xor_b32 v97, 16, v36
    v_add_u32 v97, v97, v37
    v_xor_b32 v98, 32, v36
    v_add_u32 v98, v98, v37
    v_xor_b32 v99, 48, v36
    v_add_u32 v99, v99, v37
    v_xor_b32 v100, 64, v36
    v_add_u32 v100, v100, v37
    v_xor_b32 v101, 80, v36
    v_add_u32_e64 v101, v101, v37
    v_xor_b32 v102, 96, v36
    v_add_u32_e64 v102, v102, v37
    v_xor_b32 v103, 112, v36
    v_add_u32_e64 v103, v103, v37
    v_lshl_add_u32 v52, v27, 5, v31
    s_and_b32 s39, s32, 1
    s_lshl_b32 s39, s39, 6
    s_lshr_b32 s62, s32, 1
    s_lshl_b32 s62, s62, 12
    s_add_u32 s39, s39, s62
    v_add_u32 v52, s39, v52
    v_xor_b32 v53, 0x1000, v52
    v_add_u32 v52, 122880, v52
    v_add_u32 v53, 122880, v53
    v_lshl_add_u32 v35, v27, 13, v31
    s_lshl_b32 s39, s32, 5
    s_add_u32 s39, s39, 131072
    v_add_u32 v35, s39, v35
    v_lshl_add_u32 v36, v27, 5, v31
    s_lshr_b32 s39, s32, 1
    s_lshl_b32 s39, s39, 6
    s_and_b32 s62, s32, 1
    s_lshl_b32 s62, s62, 12
    s_add_u32 s39, s39, s62
    s_add_u32 s39, s39, 147456
    v_add_u32_e64 v36, s39, v36
    s_waitcnt lgkmcnt(0)
    s_add_u32 s28, s28, 0x7f4a7c10
    s_addc_u32 s29, s29, 0x9e3779b9
    s_and_b32 s28, s28, -16
    v_mov_b32 v16, s28
    v_mov_b32_e64 v17, s29
    s_waitcnt vmcnt(9)
    s_barrier
    ds_read_b64_tr_b16 v[112:113], v52 offset:0
    ds_read_b64_tr_b16 v[114:115], v52 offset:1024
    ds_read_b64_tr_b16 v[116:117], v52 offset:2048
    ds_read_b64_tr_b16 v[118:119], v52 offset:3072
    ds_read_b64_tr_b16 v[120:121], v53 offset:0
    ds_read_b64_tr_b16 v[122:123], v53 offset:1024
    ds_read_b64_tr_b16 v[124:125], v53 offset:2048
    ds_read_b64_tr_b16 v[126:127], v53 offset:3072
    s_waitcnt lgkmcnt(6)
    buffer_store_dwordx4 v[112:115], v0, s[4:7], s93 offen sc1
    s_waitcnt lgkmcnt(4)
    buffer_store_dwordx4 v[116:119], v0, s[4:7], s93 offen offset:1024 sc1
    v_mov_b32 v56, 0
    v_mov_b32 v57, 0
    v_dot2c_f32_bf16 v56, s80, v112
    v_dot2c_f32_bf16 v57, s80, v113
    v_dot2c_f32_bf16 v56, s80, v114
    v_dot2c_f32_bf16 v57, s80, v115
    v_dot2c_f32_bf16 v56, s80, v116
    v_dot2c_f32_bf16 v57, s80, v117
    v_dot2c_f32_bf16 v56, s80, v118
    v_dot2c_f32_bf16 v57, s80, v119
    s_waitcnt lgkmcnt(3)
    v_dot2c_f32_bf16 v56, s80, v120
    v_dot2c_f32_bf16 v57, s80, v121
    s_waitcnt lgkmcnt(2)
    v_dot2c_f32_bf16 v56, s80, v122
    v_dot2c_f32_bf16 v57, s80, v123
    s_waitcnt lgkmcnt(1)
    v_dot2c_f32_bf16 v56, s80, v124
    v_dot2c_f32_bf16 v57, s80, v125
    s_waitcnt lgkmcnt(0)
    v_dot2c_f32_bf16 v56, s80, v126
    v_dot2c_f32_bf16 v57, s80, v127
    s_nop 2
    v_add_f32 v56, v56, v57
    v_mov_b32 v57, v56
    s_nop 1
    v_permlane32_swap_b32 v56, v57
    v_add_f32 v56, v56, v57
    v_cvt_pk_bf16_f32 v57, v56, v56
    v_lshlrev_b32 v57, 16, v57
    v_sub_f32 v57, v56, v57
    v_cvt_pk_bf16_f32 v58, v56, v57
    buffer_store_dword v58, v33, s[16:19], s94 offen sc1
    s_lshl_b32 s38, s32, 15
    s_lshl_b32 s93, s97, 15
    s_add_u32 m0, s38, 0
    s_add_u32 s94, s93, 0
    buffer_load_dwordx4 v104, s[24:27], s94 offen lds
    s_add_u32 m0, s38, 1024
    s_add_u32 s94, s93, 8192
    buffer_load_dwordx4 v105, s[24:27], s94 offen lds
    s_add_u32 m0, s38, 2048
    s_add_u32 s94, s93, 16384
    buffer_load_dwordx4 v104, s[24:27], s94 offen lds
    v_and_b32_e64 v34, -4, v63
    s_add_u32 m0, s38, 3072
    s_add_u32 s94, s93, 24576
    buffer_load_dwordx4 v105, s[24:27], s94 offen lds
    v_lshl_add_u32 v34, v32, 7, v34
    s_lshr_b32 s39, s32, 1
    s_lshl_b32 s39, s39, 9
    s_and_b32 s62, s32, 1
    s_lshl_b32 s62, s62, 6
    s_add_u32 s39, s39, s62
    v_add_u32_e64 v63, s39, v34
    s_lshl_b32 s33, s32, 13
    s_mul_i32 s39, s31, 337920
    s_add_u32 s39, s39, 0x100000
    s_lshl_b32 s11, s32, 12
    s_add_u32 s34, s39, s11
    s_lshl_b32 s35, s32, 8
    s_add_u32 s35, s35, 32768
    s_add_u32 s36, s39, 32768
    s_lshl_b32 s39, s97, 15
    s_add_u32 m0, s38, 4096
    s_add_u32 s94, s93, 128
    buffer_load_dwordx4 v104, s[24:27], s94 offen lds
    s_add_u32 s65, s39, 0x900000
    s_lshl_b32 s62, s31, 11
    s_add_u32 s39, s39, s62
    s_add_u32 s67, s39, 0xc00000
    s_lshl_b32 s39, s97, 11
    s_add_u32 s66, s39, 0xb00000
    s_lshr_b32 s64, s95, 2
    s_xor_b32 s64, s64, s32
    s_and_b32 s64, s64, 1
    s_add_u32 s64, s64, s98
    s_lshl_b32 s39, s64, 11
    s_lshl_b32 s62, s95, 8
    s_add_u32 s39, s39, s62
    s_add_u32 s71, s39, 0xb00000
    s_lshl_b32 s39, s64, 10
    s_lshl_b32 s62, s95, 3
    s_add_u32 m0, s38, 5120
    s_add_u32 s94, s93, 8320
    buffer_load_dwordx4 v105, s[24:27], s94 offen lds
    s_add_u32 s39, s39, s62
    s_add_u32 s9, s39, 0x15000
    s_lshl_b32 s39, s97, 10
    s_add_u32 s10, s39, 0x15000
    s_mul_i32 s39, s97, 114688
    s_mul_i32 s62, s31, 7168
    s_add_u32 s39, s39, s62
    s_add_u32 s73, s39, 0xe00000
    s_lshl_b32 s39, s97, 10
    s_lshl_b32 s62, s31, 3
    s_add_u32 s39, s39, s62
    s_add_u32 s87, s39, 0x15000
    s_lshl_b32 s39, s98, 10
    s_lshl_b32 s62, s32, 5
    s_add_u32 s39, s39, s62
    s_add_u32 s92, s39, 0x15000
    s_add_u32 m0, s38, 6144
    s_add_u32 s94, s93, 16512
    buffer_load_dwordx4 v104, s[24:27], s94 offen lds
    s_lshr_b32 s64, s95, 2
    s_xor_b32 s64, s64, 0
    s_add_u32 s64, s64, s98
    s_lshl_b32 s39, s64, 15
    s_add_u32 s62, s39, s33
    s_add_u32 s68, s62, 0xc00000
    s_lshl_b32 s62, s95, 2
    s_add_u32 s62, s62, s32
    s_lshl_b32 s63, s62, 10
    s_add_u32 s63, s63, s39
    s_add_u32 s69, s63, 0x900000
    s_lshl_b32 s63, s62, 5
    s_add_u32 s85, s63, s39
    s_lshr_b32 s39, s32, 1
    s_xor_b32 s39, s39, 0
    s_lshl_b32 s62, s95, 1
    s_add_u32 m0, s38, 7168
    s_add_u32 s94, s93, 24704
    buffer_load_dwordx4 v105, s[24:27], s94 offen lds
    s_add_u32 s39, s39, s62
    s_lshl_b32 s62, s39, 15
    s_add_u32 s62, s62, s33
    s_add_u32 s81, s62, 0x680000
    s_mul_i32 s39, s39, 114688
    s_mul_i32 s62, s32, 28672
    s_add_u32 s39, s39, s62
    s_add_u32 s83, s39, 0x700000
    s_lshr_b32 s64, s95, 2
    s_xor_b32 s64, s64, 1
    s_add_u32 s64, s64, s98
    s_lshl_b32 s39, s64, 15
    s_add_u32 s62, s39, s33
    s_add_u32 s96, s62, 0xc00000
    s_lshl_b32 s62, s95, 2
    s_add_u32 s62, s62, s32
    s_add_u32 m0, s38, 8192
    s_add_u32 s94, s93, 256
    buffer_load_dwordx4 v104, s[24:27], s94 offen lds
    s_lshl_b32 s63, s62, 10
    s_add_u32 s63, s63, s39
    s_add_u32 s70, s63, 0x900000
    s_lshl_b32 s63, s62, 5
    s_add_u32 s86, s63, s39
    s_lshr_b32 s39, s32, 1
    s_xor_b32 s39, s39, 1
    s_lshl_b32 s62, s95, 1
    s_add_u32 s39, s39, s62
    s_lshl_b32 s62, s39, 15
    s_add_u32 s62, s62, s33
    s_add_u32 s82, s62, 0x680000
    s_mul_i32 s39, s39, 114688
    s_mul_i32 s62, s32, 28672
    s_add_u32 s39, s39, s62
    s_add_u32 s84, s39, 0x700000
    s_add_u32 m0, s38, 9216
    s_add_u32 s94, s93, 8448
    buffer_load_dwordx4 v105, s[24:27], s94 offen lds
    s_xor_b32 s39, s32, 1
    s_mul_i32 s39, s39, 6144
    s_add_u32 s99, s39, 0
    s_xor_b32 s39, s32, 2
    s_mul_i32 s39, s39, 6144
    s_add_u32 s100, s39, 2048
    s_xor_b32 s39, s32, 3
    s_mul_i32 s39, s39, 6144
    s_add_u32 s101, s39, 4096
    s_mul_i32 s3, s32, 6144
    s_mov_b32 s20, s56
    s_and_b32 s21, s57, 0xffff
    s_mov_b32 s22, 0x200000
    s_mov_b32 s23, 0x20000
    s_lshr_b32 s64, s95, 2
    s_xor_b32 s64, s64, 0
    s_add_u32 m0, s38, 10240
    s_add_u32 s94, s93, 16640
    buffer_load_dwordx4 v104, s[24:27], s94 offen lds
    s_add_u32 s64, s64, s98
    s_mul_i32 s39, s64, 114688
    s_mul_i32 s62, s32, 28672
    s_add_u32 s39, s39, s62
    s_add_u32 s39, s39, 0xe00000
    s_add_u32 s62, s95, 0
    s_and_b32 s62, s62, 3
    s_mul_i32 s62, s62, 7168
    s_add_u32 s40, s39, s62
    s_add_u32 s41, s40, 4096
    s_add_u32 s62, s95, 1
    s_and_b32 s62, s62, 3
    s_mul_i32 s62, s62, 7168
    s_add_u32 s42, s39, s62
    s_add_u32 s43, s42, 4096
    s_add_u32 s62, s95, 2
    s_add_u32 m0, s38, 11264
    s_add_u32 s94, s93, 24832
    buffer_load_dwordx4 v105, s[24:27], s94 offen lds
    s_and_b32 s62, s62, 3
    s_mul_i32 s62, s62, 7168
    s_add_u32 s44, s39, s62
    s_add_u32 s45, s44, 4096
    s_add_u32 s62, s95, 3
    s_and_b32 s62, s62, 3
    s_mul_i32 s62, s62, 7168
    s_add_u32 s46, s39, s62
    s_add_u32 s47, s46, 4096
    s_lshr_b32 s64, s95, 2
    s_xor_b32 s64, s64, 1
    s_add_u32 s64, s64, s98
    s_mul_i32 s39, s64, 114688
    s_mul_i32 s62, s32, 28672
    s_add_u32 s39, s39, s62
    s_add_u32 s39, s39, 0xe00000
    s_add_u32 s62, s95, 0
    s_and_b32 s62, s62, 3
    s_mul_i32 s62, s62, 7168
    s_add_u32 s48, s39, s62
    s_add_u32 s49, s48, 4096
    s_add_u32 s62, s95, 1
    s_and_b32 s62, s62, 3
    s_mul_i32 s62, s62, 7168
    s_add_u32 s50, s39, s62
    s_add_u32 s51, s50, 4096
    s_add_u32 s62, s95, 2
    s_and_b32 s62, s62, 3
    s_mul_i32 s62, s62, 7168
    s_add_u32 s52, s39, s62
    s_add_u32 s53, s52, 4096
    s_add_u32 s62, s95, 3
    s_and_b32 s62, s62, 3
    s_mul_i32 s62, s62, 7168
    s_add_u32 s54, s39, s62
    s_add_u32 s55, s54, 4096
    s_lshl_b32 s39, s97, 15
    s_lshl_b32 s62, s31, 11
    s_add_u32 s39, s39, s62
    s_add_u32 s39, s39, 0xc00000
    s_lshl_b32 s62, s97, 10
    s_add_u32 s62, s62, 0x15000
    s_lshl_b32 s63, s30, 10
    s_add_u32 s63, s63, 0x10c00
    v_mov_b32 v38, s62
    v_mov_b32 v39, s63
    v_cmp_gt_u32 vcc, 8, v26
    s_nop 1
    v_cndmask_b32 v38, v39, v38, vcc
    v_mov_b32 v39, s39
    v_cmp_eq_u32 vcc, 0, v27
    s_nop 1
    v_cndmask_b32 v38, v38, v39, vcc
    v_lshl_add_u32 v22, v26, 7, v38
    v_mov_b32 v38, s69
    v_mov_b32_e64 v39, s70
    v_cmp_gt_u32 vcc, 8, v26
    s_nop 1
    v_cndmask_b32 v38, v39, v38, vcc
    v_lshl_add_u32 v38, v30, 3, v38
    v_and_b32 v39, 1, v26
    v_lshlrev_b32 v39, 7, v39
    v_add_u32 v39, s71, v39
    v_cmp_eq_u32 vcc, 0, v27
    s_nop 1
    v_cndmask_b32 v38, v39, v38, vcc
    v_cmp_eq_u32 vcc, 0, v25
    s_nop 1
    v_cndmask_b32 v22, v38, v22, vcc
    s_waitcnt vmcnt(12)
    s_barrier
    s_cmp_lg_u32 s32, 3
    s_cbranch_scc1 post_1
    v_or_b32 v48, s75, v16
    v_mov_b32 v49, v17
    v_lshlrev_b32_e64 v50, 1, v1
    s_lshl_b32 s39, s2, 7
    s_add_u32 s39, s39, 0x1000
    s_mov_b64 exec, 0xffff
    buffer_store_dwordx2 v[48:49], v50, s[4:7], s39 offen sc1
    s_mov_b64 exec, -1
post_1:
    s_cmp_lt_u32 s2, 224
    s_cselect_b32 s18, 0x1900000, 0
    ds_read_b64_tr_b16 a[0:1], v35 offset:0
    s_add_u32 m0, s38, 12288
    s_add_u32 s94, s93, 384
    buffer_load_dwordx4 v104, s[24:27], s94 offen lds
    ds_read_b64_tr_b16 a[2:3], v35 offset:1024
    ds_read_b64_tr_b16 a[4:5], v35 offset:2048
    ds_read_b64_tr_b16 a[6:7], v35 offset:3072
    ds_read_b64_tr_b16 a[8:9], v35 offset:4096
    ds_read_b64_tr_b16 a[10:11], v35 offset:5120
    ds_read_b64_tr_b16 a[12:13], v35 offset:6144
    ds_read_b64_tr_b16 a[14:15], v35 offset:7168
    ds_read_b64_tr_b16 a[16:17], v36 offset:0
    ds_read_b64_tr_b16 a[18:19], v36 offset:1024
    ds_read_b64_tr_b16 a[20:21], v36 offset:2048
    ds_read_b64_tr_b16 a[22:23], v36 offset:3072
    v_lshrrev_b32 v44, 2, v26
    s_add_u32 m0, s38, 13312
    s_add_u32 s94, s93, 8576
    buffer_load_dwordx4 v105, s[24:27], s94 offen lds
    v_lshl_add_u32 v44, v25, 2, v44
    v_lshlrev_b32_e64 v44, 5, v44
    v_lshl_add_u32 v44, v32, 3, v44
    s_and_b32 s39, s32, 1
    s_lshl_b32 s62, s39, 9
    s_add_u32 s62, s62, 156672
    v_add_u32_e64 v44, s62, v44
    ds_read_b64_tr_b16 v[72:73], v44
    ds_read_b64_tr_b16 v[74:75], v44 offset:256
    v_lshlrev_b32 v45, 31, v27
    v_lshrrev_b32 v46, 16, v45
    v_or_b32_e64 v45, v45, v46
    s_add_u32 m0, s38, 14336
    s_add_u32 s94, s93, 16768
    buffer_load_dwordx4 v104, s[24:27], s94 offen lds
    s_lshl_b32 s39, s39, 10
    v_add_u32 v44, s39, v20
    s_waitcnt lgkmcnt(1)
    v_xor_b32 v72, v45, v72
    v_xor_b32 v73, v45, v73
    s_waitcnt lgkmcnt(0)
    v_xor_b32 v74, v45, v74
    v_xor_b32 v75, v45, v75
    ds_write_b128 v44, v[72:75] offset:25600
    v_mov_b32 v52, s80
    v_mov_b32 v53, s80
    v_mov_b32_e64 v54, s80
    s_add_u32 m0, s38, 15360
    s_add_u32 s94, s93, 24960
    buffer_load_dwordx4 v105, s[24:27], s94 offen lds
    v_mov_b32 v55, s80
    s_nop 1
    v_mfma_f32_32x32x16_bf16 v[80:95], v[52:55], a[0:3], 0
    v_mfma_f32_32x32x16_bf16 v[80:95], v[52:55], a[4:7], v[80:95]
    v_mfma_f32_32x32x16_bf16 v[80:95], v[52:55], a[8:11], v[80:95]
    v_mfma_f32_32x32x16_bf16 v[80:95], v[52:55], a[12:15], v[80:95]
    v_mov_b64_e64 v[38:39], -1
    s_add_u32 m0, s38, 16384
    s_add_u32 s94, s93, 512
    buffer_load_dwordx4 v104, s[24:27], s94 offen lds
    v_mov_b64 v[24:25], 0
    v_mov_b64_e64 v[26:27], 0
    s_waitcnt vmcnt(13)
    ds_read_b64 v[128:129], v96 offset:0
    ds_read_b64 v[130:131], v97 offset:0
    ds_read_b64 v[132:133], v98 offset:0
    ds_read_b64 v[134:135], v99 offset:0
    ds_read_b64 v[136:137], v100 offset:0
    ds_read_b64 v[138:139], v101 offset:0
    ds_read_b64 v[140:141], v102 offset:0
    ds_read_b64 v[142:143], v103 offset:0
    v_cvt_pk_bf16_f32 v81, v80, v80
    s_add_u32 m0, s38, 17408
    s_add_u32 s94, s93, 8704
    buffer_load_dwordx4 v105, s[24:27], s94 offen lds
    v_lshlrev_b32 v81, 16, v81
    v_sub_f32 v81, v80, v81
    v_cvt_pk_bf16_f32 v37, v80, v81
    s_waitcnt vmcnt(10)
    ds_read_b64 v[144:145], v96 offset:4096
    ds_read_b64 v[146:147], v97 offset:4096
    ds_read_b64 v[148:149], v98 offset:4096
    ds_read_b64 v[150:151], v99 offset:4096
    ds_read_b64 v[152:153], v100 offset:4096
    ds_read_b64 v[154:155], v101 offset:4096
    ds_read_b64 v[156:157], v102 offset:4096
    ds_read_b64 v[158:159], v103 offset:4096
    s_add_u32 m0, s38, 18432
    s_add_u32 s94, s93, 16896
    buffer_load_dwordx4 v104, s[24:27], s94 offen lds
    s_add_u32 m0, s38, 19456
    s_add_u32 s94, s93, 25088
    buffer_load_dwordx4 v105, s[24:27], s94 offen lds
    s_waitcnt lgkmcnt(15)
    v_dot2c_f32_bf16 v24, s80, v128
    v_dot2c_f32_bf16 v25, v128, v128
    v_dot2c_f32_bf16 v26, s80, v129
    v_dot2c_f32_bf16 v27, v129, v129
    s_waitcnt lgkmcnt(14)
    v_dot2c_f32_bf16 v24, s80, v130
    v_dot2c_f32_bf16 v25, v130, v130
    v_dot2c_f32_bf16 v26, s80, v131
    s_add_u32 m0, s38, 20480
    s_add_u32 s94, s93, 640
    buffer_load_dwordx4 v104, s[24:27], s94 offen lds
    v_dot2c_f32_bf16 v27, v131, v131
    s_waitcnt lgkmcnt(13)
    v_dot2c_f32_bf16 v24, s80, v132
    v_dot2c_f32_bf16 v25, v132, v132
    v_dot2c_f32_bf16 v26, s80, v133
    v_dot2c_f32_bf16 v27, v133, v133
    s_waitcnt lgkmcnt(12)
    v_dot2c_f32_bf16 v24, s80, v134
    v_dot2c_f32_bf16 v25, v134, v134
    v_dot2c_f32_bf16 v26, s80, v135
    v_dot2c_f32_bf16 v27, v135, v135
    s_waitcnt vmcnt(9)
    ds_read_b64 v[160:161], v96 offset:8192
    s_add_u32 m0, s38, 21504
    s_add_u32 s94, s93, 8832
    buffer_load_dwordx4 v105, s[24:27], s94 offen lds
    ds_read_b64 v[162:163], v97 offset:8192
    ds_read_b64 v[164:165], v98 offset:8192
    ds_read_b64 v[166:167], v99 offset:8192
    ds_read_b64 v[168:169], v100 offset:8192
    ds_read_b64 v[170:171], v101 offset:8192
    ds_read_b64 v[172:173], v102 offset:8192
    ds_read_b64 v[174:175], v103 offset:8192
    s_add_u32 m0, s38, 22528
    s_add_u32 s94, s93, 17024
    buffer_load_dwordx4 v104, s[24:27], s94 offen lds
    s_add_u32 m0, s38, 23552
    s_add_u32 s94, s93, 25216
    buffer_load_dwordx4 v105, s[24:27], s94 offen lds
    s_waitcnt lgkmcnt(15)
    v_dot2c_f32_bf16 v24, s80, v136
    s_add_u32 m0, s38, 24576
    s_add_u32 s94, s93, 768
    buffer_load_dwordx4 v104, s[24:27], s94 offen lds
    v_dot2c_f32_bf16 v25, v136, v136
    v_dot2c_f32_bf16 v26, s80, v137
    v_dot2c_f32_bf16 v27, v137, v137
    s_waitcnt lgkmcnt(15)
    v_dot2c_f32_bf16 v24, s80, v138
    v_dot2c_f32_bf16 v25, v138, v138
    v_dot2c_f32_bf16 v26, s80, v139
    v_dot2c_f32_bf16 v27, v139, v139
    s_waitcnt lgkmcnt(15)
    v_dot2c_f32_bf16 v24, s80, v140
    v_dot2c_f32_bf16 v25, v140, v140
    v_dot2c_f32_bf16 v26, s80, v141
    s_add_u32 m0, s38, 25600
    s_add_u32 s94, s93, 8960
    buffer_load_dwordx4 v105, s[24:27], s94 offen lds
    v_dot2c_f32_bf16 v27, v141, v141
    s_waitcnt lgkmcnt(15)
    v_dot2c_f32_bf16 v24, s80, v142
    v_dot2c_f32_bf16 v25, v142, v142
    v_dot2c_f32_bf16 v26, s80, v143
    v_dot2c_f32_bf16_e64 v27, v143, v143
    s_waitcnt vmcnt(10)
    ds_read_b64 v[176:177], v96 offset:12288
    ds_read_b64 v[178:179], v97 offset:12288
    ds_read_b64 v[180:181], v98 offset:12288
    ds_read_b64 v[182:183], v99 offset:12288
    ds_read_b64 v[184:185], v100 offset:12288
    s_add_u32 m0, s38, 26624
    s_add_u32 s94, s93, 17152
    buffer_load_dwordx4 v104, s[24:27], s94 offen lds
    ds_read_b64 v[186:187], v101 offset:12288
    ds_read_b64 v[188:189], v102 offset:12288
    ds_read_b64 v[190:191], v103 offset:12288
    s_add_u32 m0, s38, 27648
    s_add_u32 s94, s93, 25344
    buffer_load_dwordx4 v105, s[24:27], s94 offen lds
    s_waitcnt lgkmcnt(15)
    v_dot2c_f32_bf16 v24, s80, v144
    v_dot2c_f32_bf16 v25, v144, v144
    v_dot2c_f32_bf16 v26, s80, v145
    v_dot2c_f32_bf16 v27, v145, v145
    s_waitcnt lgkmcnt(15)
    v_dot2c_f32_bf16_e64 v24, s80, v146
    s_add_u32 m0, s38, 28672
    s_add_u32 s94, s93, 896
    buffer_load_dwordx4 v104, s[24:27], s94 offen lds
    v_dot2c_f32_bf16 v25, v146, v146
    v_dot2c_f32_bf16 v26, s80, v147
    v_dot2c_f32_bf16 v27, v147, v147
    s_waitcnt lgkmcnt(15)
    v_dot2c_f32_bf16 v24, s80, v148
    v_dot2c_f32_bf16 v25, v148, v148
    v_dot2c_f32_bf16 v26, s80, v149
    v_dot2c_f32_bf16 v27, v149, v149
    s_waitcnt lgkmcnt(15)
    v_dot2c_f32_bf16 v24, s80, v150
    v_dot2c_f32_bf16 v25, v150, v150
    v_dot2c_f32_bf16 v26, s80, v151
    s_add_u32 m0, s38, 29696
    s_add_u32 s94, s93, 9088
    buffer_load_dwordx4 v105, s[24:27], s94 offen lds
    v_dot2c_f32_bf16 v27, v151, v151
    s_waitcnt vmcnt(10)
    ds_read_b64 v[192:193], v96 offset:16384
    ds_read_b64 v[194:195], v97 offset:16384
    ds_read_b64 v[196:197], v98 offset:16384
    ds_read_b64 v[198:199], v99 offset:16384
    ds_read_b64 v[200:201], v100 offset:16384
    ds_read_b64 v[202:203], v101 offset:16384
    ds_read_b64 v[204:205], v102 offset:16384
    ds_read_b64 v[206:207], v103 offset:16384
    s_add_u32 m0, s38, 30720
    s_add_u32 s94, s93, 17280
    buffer_load_dwordx4 v104, s[24:27], s94 offen lds
    s_add_u32 m0, s38, 31744
    s_add_u32 s94, s93, 25472
    buffer_load_dwordx4 v105, s[24:27], s94 offen lds
    s_waitcnt lgkmcnt(15)
    v_dot2c_f32_bf16 v24, s80, v152
    v_dot2c_f32_bf16 v25, v152, v152
    v_dot2c_f32_bf16 v26, s80, v153
    v_dot2c_f32_bf16 v27, v153, v153
    s_waitcnt lgkmcnt(15)
    v_dot2c_f32_bf16 v24, s80, v154
    v_dot2c_f32_bf16 v25, v154, v154
    v_dot2c_f32_bf16 v26, s80, v155
    v_dot2c_f32_bf16 v27, v155, v155
    s_waitcnt lgkmcnt(15)
    v_dot2c_f32_bf16 v24, s80, v156
    v_dot2c_f32_bf16 v25, v156, v156
    v_dot2c_f32_bf16 v26, s80, v157
    v_dot2c_f32_bf16 v27, v157, v157
    s_waitcnt lgkmcnt(15)
    v_dot2c_f32_bf16 v24, s80, v158
    v_dot2c_f32_bf16 v25, v158, v158
    v_dot2c_f32_bf16 v26, s80, v159
    v_dot2c_f32_bf16_e64 v27, v159, v159
    s_waitcnt vmcnt(8)
    ds_read_b64 v[208:209], v96 offset:20480
    ds_read_b64 v[210:211], v97 offset:20480
    ds_read_b64 v[212:213], v98 offset:20480
    ds_read_b64 v[214:215], v99 offset:20480
    ds_read_b64 v[216:217], v100 offset:20480
    ds_read_b64 v[218:219], v101 offset:20480
    ds_read_b64 v[220:221], v102 offset:20480
    ds_read_b64 v[222:223], v103 offset:20480
    s_waitcnt lgkmcnt(15)
    v_dot2c_f32_bf16 v24, s80, v160
    v_dot2c_f32_bf16 v25, v160, v160
    v_dot2c_f32_bf16 v26, s80, v161
    v_dot2c_f32_bf16 v27, v161, v161
    s_waitcnt lgkmcnt(15)
    v_dot2c_f32_bf16 v24, s80, v162
    v_dot2c_f32_bf16 v25, v162, v162
    v_dot2c_f32_bf16 v26, s80, v163
    v_dot2c_f32_bf16 v27, v163, v163
    s_waitcnt lgkmcnt(15)
    v_dot2c_f32_bf16 v24, s80, v164
    v_dot2c_f32_bf16 v25, v164, v164
    v_dot2c_f32_bf16 v26, s80, v165
    v_dot2c_f32_bf16 v27, v165, v165
    s_waitcnt lgkmcnt(15)
    v_dot2c_f32_bf16 v24, s80, v166
    v_dot2c_f32_bf16 v25, v166, v166
    v_dot2c_f32_bf16 v26, s80, v167
    v_dot2c_f32_bf16_e64 v27, v167, v167
    s_waitcnt vmcnt(4)
    ds_read_b64 v[224:225], v96 offset:24576
    ds_read_b64 v[226:227], v97 offset:24576
    ds_read_b64 v[228:229], v98 offset:24576
    ds_read_b64 v[230:231], v99 offset:24576
    ds_read_b64 v[232:233], v100 offset:24576
    ds_read_b64 v[234:235], v101 offset:24576
    ds_read_b64 v[236:237], v102 offset:24576
    ds_read_b64 v[238:239], v103 offset:24576
    s_cmp_lg_u32 s32, 0
    s_cbranch_scc1 p0pre_3
    buffer_load_dwordx2 v[60:61], v62, s[4:7], 0 offen sc1
p0pre_3:
    s_waitcnt lgkmcnt(15)
    v_dot2c_f32_bf16 v24, s80, v168
    v_dot2c_f32_bf16 v25, v168, v168
    v_dot2c_f32_bf16 v26, s80, v169
    v_dot2c_f32_bf16 v27, v169, v169
    s_waitcnt lgkmcnt(15)
    v_dot2c_f32_bf16 v24, s80, v170
    v_dot2c_f32_bf16 v25, v170, v170
    v_dot2c_f32_bf16 v26, s80, v171
    v_dot2c_f32_bf16 v27, v171, v171
    s_waitcnt lgkmcnt(15)
    v_dot2c_f32_bf16 v24, s80, v172
    v_dot2c_f32_bf16 v25, v172, v172
    v_dot2c_f32_bf16 v26, s80, v173
    v_dot2c_f32_bf16 v27, v173, v173
    s_waitcnt lgkmcnt(15)
    v_dot2c_f32_bf16 v24, s80, v174
    v_dot2c_f32_bf16 v25, v174, v174
    v_dot2c_f32_bf16 v26, s80, v175
    v_dot2c_f32_bf16_e64 v27, v175, v175
    s_waitcnt vmcnt(0)
    ds_read_b64 v[240:241], v96 offset:28672
    ds_read_b64 v[242:243], v97 offset:28672
    ds_read_b64 v[244:245], v98 offset:28672
    ds_read_b64 v[246:247], v99 offset:28672
    ds_read_b64 v[248:249], v100 offset:28672
    ds_read_b64 v[250:251], v101 offset:28672
    ds_read_b64 v[252:253], v102 offset:28672
    ds_read_b64 v[254:255], v103 offset:28672
    s_cmp_lg_u32 s32, 0
    s_cbranch_scc1 p0poll_5
    s_mov_b32 s74, 0
    s_waitcnt vmcnt(0)
    s_branch pchk_9
poll_7:
    buffer_load_dwordx2 v[60:61], v62, s[4:7], 0 offen sc1
    s_waitcnt vmcnt(0)
pchk_9:
    v_and_b32 v48, -16, v60
    v_mov_b32 v49, v61
    v_cmp_ne_u64_e64 vcc, s[28:29], v[48:49]
    s_cbranch_vccz polled_8
    s_mov_b64 exec, vcc
    s_sleep 2
    s_add_u32 s74, s74, 1
    s_cmp_lt_u32 s74, 0x20000
    s_cbranch_scc1 poll_7
    s_mov_b32 s74, 1
    s_branch L_timeout
polled_8:
    s_mov_b64 exec, -1
    s_or_b32 s39, s28, s75
    v_cmp_ne_u32 vcc, s39, v60
    s_nop 0
    s_and_b32 s39, vcc_lo, 0xffff
    v_mov_b32 v48, s39
    ds_write_b32 v20, v48 offset:20480
p0poll_5:
    s_waitcnt lgkmcnt(0)
    s_barrier
    ds_read_b32 v48, v20 offset:20480
    s_add_u32 m0, s11, 0
    s_add_u32 s37, s34, 0
    buffer_load_dwordx4 v0, s[4:7], s37 offen lds
    buffer_load_dwordx4 v0, s[4:7], s37 offen offset:1024 lds
    buffer_load_dwordx4 v0, s[4:7], s37 offen offset:2048 lds
    buffer_load_dwordx4 v0, s[4:7], s37 offen offset:3072 lds
    v_lshrrev_b32 v62, 1, v0
    v_and_b32 v62, 0x38, v62
    s_waitcnt lgkmcnt(0)
    v_readfirstlane_b32 s8, v48
    s_nop 0
L_p1_0:
    v_dot2c_f32_bf16 v24, s80, v176
    s_add_u32 m0, s11, 16384
    s_add_u32 s37, s34, 16384
    buffer_load_dwordx4 v0, s[4:7], s37 offen lds
    v_dot2c_f32_bf16 v25, v176, v176
    v_dot2c_f32_bf16 v26, s80, v177
    v_dot2c_f32_bf16 v27, v177, v177
    v_dot2c_f32_bf16 v24, s80, v178
    v_dot2c_f32_bf16 v25, v178, v178
    v_dot2c_f32_bf16 v26, s80, v179
    v_dot2c_f32_bf16 v27, v179, v179
    v_dot2c_f32_bf16 v24, s80, v180
    v_dot2c_f32_bf16 v25, v180, v180
    v_dot2c_f32_bf16 v26, s80, v181
    v_dot2c_f32_bf16 v27, v181, v181
    v_dot2c_f32_bf16 v24, s80, v182
    v_dot2c_f32_bf16 v25, v182, v182
    v_dot2c_f32_bf16 v26, s80, v183
    v_dot2c_f32_bf16 v27, v183, v183
    v_dot2c_f32_bf16 v24, s80, v184
    buffer_load_dwordx4 v0, s[4:7], s37 offen offset:1024 lds
    v_dot2c_f32_bf16 v25, v184, v184
    v_dot2c_f32_bf16 v26, s80, v185
    v_dot2c_f32_bf16 v27, v185, v185
    v_dot2c_f32_bf16 v24, s80, v186
    v_dot2c_f32_bf16 v25, v186, v186
    v_dot2c_f32_bf16 v26, s80, v187
    v_dot2c_f32_bf16 v27, v187, v187
    v_dot2c_f32_bf16 v24, s80, v188
    v_dot2c_f32_bf16 v25, v188, v188
    v_dot2c_f32_bf16 v26, s80, v189
    v_dot2c_f32_bf16 v27, v189, v189
    v_dot2c_f32_bf16 v24, s80, v190
    v_dot2c_f32_bf16 v25, v190, v190
    v_dot2c_f32_bf16 v26, s80, v191
    v_dot2c_f32_bf16 v27, v191, v191
    v_dot2c_f32_bf16 v24, s80, v192
    buffer_load_dwordx4 v0, s[4:7], s37 offen offset:2048 lds
    v_dot2c_f32_bf16 v25, v192, v192
    v_dot2c_f32_bf16 v26, s80, v193
    v_dot2c_f32_bf16 v27, v193, v193
    v_dot2c_f32_bf16 v24, s80, v194
    v_dot2c_f32_bf16 v25, v194, v194
    v_dot2c_f32_bf16 v26, s80, v195
    v_dot2c_f32_bf16 v27, v195, v195
    v_dot2c_f32_bf16 v24, s80, v196
    v_dot2c_f32_bf16 v25, v196, v196
    v_dot2c_f32_bf16 v26, s80, v197
    v_dot2c_f32_bf16 v27, v197, v197
    v_dot2c_f32_bf16 v24, s80, v198
    v_dot2c_f32_bf16 v25, v198, v198
    v_dot2c_f32_bf16 v26, s80, v199
    v_dot2c_f32_bf16 v27, v199, v199
    v_dot2c_f32_bf16 v24, s80, v200
    buffer_load_dwordx4 v0, s[4:7], s37 offen offset:3072 lds
    v_dot2c_f32_bf16 v25, v200, v200
    v_dot2c_f32_bf16 v26, s80, v201
    v_dot2c_f32_bf16 v27, v201, v201
    v_dot2c_f32_bf16 v24, s80, v202
    v_dot2c_f32_bf16 v25, v202, v202
    v_dot2c_f32_bf16 v26, s80, v203
    v_dot2c_f32_bf16 v27, v203, v203
    v_dot2c_f32_bf16 v24, s80, v204
    v_dot2c_f32_bf16 v25, v204, v204
    v_dot2c_f32_bf16 v26, s80, v205
    v_dot2c_f32_bf16 v27, v205, v205
    v_dot2c_f32_bf16 v24, s80, v206
    v_dot2c_f32_bf16 v25, v206, v206
    v_dot2c_f32_bf16 v26, s80, v207
    v_dot2c_f32_bf16 v27, v207, v207
    v_dot2c_f32_bf16 v24, s80, v208
    s_add_u32 m0, s35, 0
    s_add_u32 s37, s36, 0
    buffer_load_dword v63, s[4:7], s37 offen lds
    v_dot2c_f32_bf16 v25, v208, v208
    v_dot2c_f32_bf16 v26, s80, v209
    v_dot2c_f32_bf16 v27, v209, v209
    v_dot2c_f32_bf16 v24, s80, v210
    v_dot2c_f32_bf16 v25, v210, v210
    v_dot2c_f32_bf16 v26, s80, v211
    v_dot2c_f32_bf16 v27, v211, v211
    v_dot2c_f32_bf16 v24, s80, v212
    v_dot2c_f32_bf16 v25, v212, v212
    v_dot2c_f32_bf16 v26, s80, v213
    v_dot2c_f32_bf16 v27, v213, v213
    v_dot2c_f32_bf16 v24, s80, v214
    v_dot2c_f32_bf16 v25, v214, v214
    v_dot2c_f32_bf16 v26, s80, v215
    v_dot2c_f32_bf16 v27, v215, v215
    v_dot2c_f32_bf16 v24, s80, v216
    s_add_u32 m0, s11, 33792
    s_add_u32 s37, s34, 33792
    buffer_load_dwordx4 v0, s[4:7], s37 offen lds
    v_dot2c_f32_bf16 v25, v216, v216
    v_dot2c_f32_bf16 v26, s80, v217
    v_dot2c_f32_bf16 v27, v217, v217
    v_dot2c_f32_bf16 v24, s80, v218
    v_dot2c_f32_bf16 v25, v218, v218
    v_dot2c_f32_bf16 v26, s80, v219
    v_dot2c_f32_bf16 v27, v219, v219
    v_dot2c_f32_bf16 v24, s80, v220
    v_dot2c_f32_bf16 v25, v220, v220
    v_dot2c_f32_bf16 v26, s80, v221
    v_dot2c_f32_bf16 v27, v221, v221
    v_dot2c_f32_bf16 v24, s80, v222
    v_dot2c_f32_bf16 v25, v222, v222
    v_dot2c_f32_bf16 v26, s80, v223
    v_dot2c_f32_bf16 v27, v223, v223
    v_dot2c_f32_bf16 v24, s80, v224
    buffer_load_dwordx4 v0, s[4:7], s37 offen offset:1024 lds
    v_dot2c_f32_bf16 v25, v224, v224
    v_dot2c_f32_bf16 v26, s80, v225
    v_dot2c_f32_bf16 v27, v225, v225
    v_dot2c_f32_bf16 v24, s80, v226
    v_dot2c_f32_bf16 v25, v226, v226
    v_dot2c_f32_bf16 v26, s80, v227
    v_dot2c_f32_bf16 v27, v227, v227
    v_dot2c_f32_bf16 v24, s80, v228
    v_dot2c_f32_bf16 v25, v228, v228
    v_dot2c_f32_bf16 v26, s80, v229
    v_dot2c_f32_bf16 v27, v229, v229
    v_dot2c_f32_bf16 v24, s80, v230
    v_dot2c_f32_bf16 v25, v230, v230
    v_dot2c_f32_bf16 v26, s80, v231
    v_dot2c_f32_bf16 v27, v231, v231
    v_dot2c_f32_bf16 v24, s80, v232
    buffer_load_dwordx4 v0, s[4:7], s37 offen offset:2048 lds
    v_dot2c_f32_bf16 v25, v232, v232
    v_dot2c_f32_bf16 v26, s80, v233
    v_dot2c_f32_bf16 v27, v233, v233
    v_dot2c_f32_bf16 v24, s80, v234
    v_dot2c_f32_bf16 v25, v234, v234
    v_dot2c_f32_bf16 v26, s80, v235
    v_dot2c_f32_bf16 v27, v235, v235
    v_dot2c_f32_bf16 v24, s80, v236
    v_dot2c_f32_bf16 v25, v236, v236
    v_dot2c_f32_bf16 v26, s80, v237
    v_dot2c_f32_bf16 v27, v237, v237
    v_dot2c_f32_bf16 v24, s80, v238
    v_dot2c_f32_bf16 v25, v238, v238
    v_dot2c_f32_bf16 v26, s80, v239
    v_dot2c_f32_bf16 v27, v239, v239
    v_dot2c_f32_bf16 v24, s80, v240
    v_dot2c_f32_bf16 v25, v240, v240
    v_dot2c_f32_bf16 v26, s80, v241
    v_dot2c_f32_bf16 v27, v241, v241
    v_dot2c_f32_bf16 v24, s80, v242
    v_dot2c_f32_bf16 v25, v242, v242
    v_dot2c_f32_bf16 v26, s80, v243
    v_dot2c_f32_bf16 v27, v243, v243
    v_dot2c_f32_bf16 v24, s80, v244
    v_dot2c_f32_bf16 v25, v244, v244
    v_dot2c_f32_bf16 v26, s80, v245
    v_dot2c_f32_bf16 v27, v245, v245
    v_dot2c_f32_bf16 v24, s80, v246
    v_dot2c_f32_bf16 v25, v246, v246
    v_dot2c_f32_bf16 v26, s80, v247
    v_dot2c_f32_bf16 v27, v247, v247
    v_dot2c_f32_bf16 v24, s80, v248
    v_dot2c_f32_bf16 v25, v248, v248
    v_dot2c_f32_bf16 v26, s80, v249
    v_dot2c_f32_bf16 v27, v249, v249
    v_dot2c_f32_bf16 v24, s80, v250
    v_dot2c_f32_bf16 v25, v250, v250
    v_dot2c_f32_bf16 v26, s80, v251
    v_dot2c_f32_bf16 v27, v251, v251
    v_dot2c_f32_bf16 v24, s80, v252
    v_dot2c_f32_bf16 v25, v252, v252
    v_dot2c_f32_bf16 v26, s80, v253
    v_dot2c_f32_bf16 v27, v253, v253
    v_dot2c_f32_bf16 v24, s80, v254
    v_dot2c_f32_bf16 v25, v254, v254
    v_dot2c_f32_bf16 v26, s80, v255
    v_dot2c_f32_bf16 v27, v255, v255
    s_nop 1
    v_add_f32 v24, v24, v26
    v_add_f32 v25, v25, v27
    s_nop 1
    v_permlane32_swap_b32 v24, v25
    v_add_f32_e64 v24, v24, v25
    v_mul_f32 v24, 0x3b000000, v24
    v_mov_b32 v25, v24
    s_nop 1
    v_permlane32_swap_b32_e64 v24, v25
    v_fma_f32 v25, -v24, v24, v25
    v_max_f32_e64 v25, 0, v25
    v_add_f32 v46, 0x3727c5ac, v25
    v_rsq_f32_e64 v47, v46
    v_cvt_pk_bf16_f32 v40, -v24, -v24
    v_mov_b32 v41, v40
    v_mov_b32 v42, v40
    v_mov_b32_e64 v43, v40
    v_mul_f32 v44, 0x3fb8aa3b, v47
    s_waitcnt vmcnt(8)
    s_barrier
    ds_read_b128 a[224:227], v2 offset:0
    ds_read_b128 a[228:231], v2 offset:1024
    ds_read_b128 a[232:235], v2 offset:2048
    ds_read_b128 a[236:239], v2 offset:3072
    ds_read_b128 a[240:243], v2 offset:4096
    ds_read_b128 a[244:247], v2 offset:5120
    s_waitcnt lgkmcnt(3)
    v_mfma_f32_32x32x16_bf16 v[64:79], a[224:227], v[128:131], 0
    ds_read_b128 a[248:251], v2 offset:6144
    buffer_load_dwordx4 v0, s[4:7], s37 offen offset:3072 lds
    v_mfma_f32_32x32x16_bf16 v[64:79], a[228:231], v[132:135], v[64:79]
    ds_read_b128 a[252:255], v2 offset:7168
    v_mfma_f32_32x32x16_bf16 v[64:79], a[232:235], v[136:139], v[64:79]
    ds_read_b128 a[224:227], v2 offset:8192
    s_add_u32 m0, s11, 50176
    s_add_u32 s37, s34, 50176
    buffer_load_dwordx4 v0, s[4:7], s37 offen lds
    s_waitcnt lgkmcnt(3)
    v_mfma_f32_32x32x16_bf16 v[64:79], a[236:239], v[140:143], v[64:79]
    ds_read_b128 a[228:231], v2 offset:9216
    v_mfma_f32_32x32x16_bf16 v[64:79], a[240:243], v[144:147], v[64:79]
    ds_read_b128 a[232:235], v2 offset:10240
    buffer_load_dwordx4 v0, s[4:7], s37 offen offset:1024 lds
    v_mfma_f32_32x32x16_bf16 v[64:79], a[244:247], v[148:151], v[64:79]
    ds_read_b128 a[236:239], v2 offset:11264
    s_waitcnt lgkmcnt(3)
    v_mfma_f32_32x32x16_bf16 v[64:79], a[248:251], v[152:155], v[64:79]
    ds_read_b128 a[240:243], v2 offset:12288
    buffer_load_dwordx4 v0, s[4:7], s37 offen offset:2048 lds
    v_mfma_f32_32x32x16_bf16 v[64:79], a[252:255], v[156:159], v[64:79]
    ds_read_b128 a[244:247], v2 offset:13312
    v_mfma_f32_32x32x16_bf16 v[64:79], a[224:227], v[160:163], v[64:79]
    ds_read_b128 a[248:251], v2 offset:14336
    buffer_load_dwordx4 v0, s[4:7], s37 offen offset:3072 lds
    s_waitcnt lgkmcnt(3)
    v_mfma_f32_32x32x16_bf16 v[64:79], a[228:231], v[164:167], v[64:79]
    ds_read_b128 a[252:255], v2 offset:15360
    v_mfma_f32_32x32x16_bf16 v[64:79], a[232:235], v[168:171], v[64:79]
    s_add_u32 m0, s35, 33792
    s_add_u32 s37, s36, 33792
    buffer_load_dword v63, s[4:7], s37 offen lds
    v_mfma_f32_32x32x16_bf16 v[64:79], a[236:239], v[172:175], v[64:79]
    s_waitcnt lgkmcnt(0)
    s_waitcnt vmcnt(9)
    s_barrier
    ds_read_b128 a[224:227], v2 offset:16384
    ds_read_b128 a[228:231], v2 offset:17408
    v_mfma_f32_32x32x16_bf16 v[64:79], a[240:243], v[176:179], v[64:79]
    ds_read_b128 a[232:235], v2 offset:18432
    v_lshlrev_b32 v56, 6, v0
    v_and_b32 v56, 0x7c00, v56
    v_lshrrev_b32_e64 v57, 9, v0
    v_lshl_add_u32 v56, v57, 4, v56
    buffer_load_dwordx4 a[32:35], v56, s[24:27], s85 offen
    buffer_load_dwordx4 a[36:39], v56, s[24:27], s86 offen
    v_mfma_f32_32x32x16_bf16 v[64:79], a[244:247], v[180:183], v[64:79]
    ds_read_b128 a[236:239], v2 offset:19456
    v_mfma_f32_32x32x16_bf16 v[64:79], a[248:251], v[184:187], v[64:79]
    ds_read_b128 a[240:243], v2 offset:20480
    s_add_u32 s39, s76, 655360
    buffer_store_dwordx2 v[38:39], v9, s[4:7], s39 offen sc1
    buffer_store_dwordx2 v[38:39], v10, s[4:7], s39 offen sc1
    v_mfma_f32_32x32x16_bf16 v[64:79], a[252:255], v[188:191], v[64:79]
    ds_read_b128 a[244:247], v2 offset:21504
    s_waitcnt lgkmcnt(3)
    v_mfma_f32_32x32x16_bf16 v[64:79], a[224:227], v[192:195], v[64:79]
    ds_read_b128 a[248:251], v2 offset:22528
    v_mfma_f32_32x32x16_bf16 v[64:79], a[228:231], v[196:199], v[64:79]
    ds_read_b128 a[252:255], v2 offset:23552
    v_mfma_f32_32x32x16_bf16 v[64:79], a[232:235], v[200:203], v[64:79]
    ds_read_b128 a[224:227], v2 offset:24576
    s_waitcnt lgkmcnt(3)
    v_mfma_f32_32x32x16_bf16 v[64:79], a[236:239], v[204:207], v[64:79]
    ds_read_b128 a[228:231], v2 offset:25600
    v_mfma_f32_32x32x16_bf16 v[64:79], a[240:243], v[208:211], v[64:79]
    ds_read_b128 a[232:235], v2 offset:26624
    v_mfma_f32_32x32x16_bf16 v[64:79], a[244:247], v[212:215], v[64:79]
    ds_read_b128 a[236:239], v2 offset:27648
    s_waitcnt lgkmcnt(3)
    v_mfma_f32_32x32x16_bf16 v[64:79], a[248:251], v[216:219], v[64:79]
    ds_read_b128 a[240:243], v2 offset:28672
    v_mfma_f32_32x32x16_bf16 v[64:79], a[252:255], v[220:223], v[64:79]
    ds_read_b128 a[244:247], v2 offset:29696
    v_mfma_f32_32x32x16_bf16 v[64:79], a[224:227], v[224:227], v[64:79]
    ds_read_b128 a[248:251], v2 offset:30720
    s_waitcnt lgkmcnt(3)
    v_mfma_f32_32x32x16_bf16 v[64:79], a[228:231], v[228:231], v[64:79]
    ds_read_b128 a[252:255], v2 offset:31744
    v_mfma_f32_32x32x16_bf16 v[64:79], a[232:235], v[232:235], v[64:79]
    ds_read_b128 a[224:227], v2 offset:32768
    v_mfma_f32_32x32x16_bf16 v[64:79], a[236:239], v[236:239], v[64:79]
    s_waitcnt lgkmcnt(3)
    v_mfma_f32_32x32x16_bf16 v[64:79], a[240:243], v[240:243], v[64:79]
    s_waitcnt lgkmcnt(0)
    s_waitcnt vmcnt(9)
    s_barrier
    ds_read_b128 a[228:231], v3 offset:0
    ds_read_b128 a[232:235], v3 offset:1024
    s_add_u32 m0, s11, 67584
    s_add_u32 s37, s34, 67584
    buffer_load_dwordx4 v0, s[4:7], s37 offen lds
    v_mfma_f32_32x32x16_bf16 v[64:79], a[244:247], v[244:247], v[64:79]
    ds_read_b128 a[236:239], v3 offset:2048
    v_mfma_f32_32x32x16_bf16 v[64:79], a[248:251], v[248:251], v[64:79]
    ds_read_b128 a[240:243], v3 offset:3072
    buffer_load_dwordx4 v0, s[4:7], s37 offen offset:1024 lds
    v_mfma_f32_32x32x16_bf16 v[64:79], a[252:255], v[252:255], v[64:79]
    ds_read_b128 a[244:247], v3 offset:4096
    v_mfma_f32_32x32x16_bf16 v[64:79], a[224:227], v[40:43], v[64:79]
    ds_read_b128 a[248:251], v3 offset:5120
    buffer_load_dwordx4 v0, s[4:7], s37 offen offset:2048 lds
    s_waitcnt lgkmcnt(3)
    v_mfma_f32_32x32x16_bf16 v[80:95], a[228:231], v[128:131], 0
    ds_read_b128 a[252:255], v3 offset:6144
    v_mfma_f32_32x32x16_bf16 v[80:95], a[232:235], v[132:135], v[80:95]
    ds_read_b128 a[224:227], v3 offset:7168
    buffer_load_dwordx4 v0, s[4:7], s37 offen offset:3072 lds
    v_mfma_f32_32x32x16_bf16 v[80:95], a[236:239], v[136:139], v[80:95]
    ds_read_b128 a[228:231], v3 offset:8192
    s_waitcnt lgkmcnt(3)
    v_mfma_f32_32x32x16_bf16 v[80:95], a[240:243], v[140:143], v[80:95]
    ds_read_b128 a[232:235], v3 offset:9216
    s_add_u32 m0, s11, 83968
    s_add_u32 s37, s34, 83968
    buffer_load_dwordx4 v0, s[4:7], s37 offen lds
    v_mfma_f32_32x32x16_bf16 v[80:95], a[244:247], v[144:147], v[80:95]
    ds_read_b128 a[236:239], v3 offset:10240
    v_mfma_f32_32x32x16_bf16 v[80:95], a[248:251], v[148:151], v[80:95]
    ds_read_b128 a[240:243], v3 offset:11264
    buffer_load_dwordx4 v0, s[4:7], s37 offen offset:1024 lds
    s_waitcnt lgkmcnt(3)
    v_mfma_f32_32x32x16_bf16 v[80:95], a[252:255], v[152:155], v[80:95]
    ds_read_b128 a[244:247], v3 offset:12288
    v_mfma_f32_32x32x16_bf16 v[80:95], a[224:227], v[156:159], v[80:95]
    ds_read_b128 a[248:251], v3 offset:13312
    buffer_load_dwordx4 v0, s[4:7], s37 offen offset:2048 lds
    v_mfma_f32_32x32x16_bf16 v[80:95], a[228:231], v[160:163], v[80:95]
    ds_read_b128 a[252:255], v3 offset:14336
    s_waitcnt lgkmcnt(3)
    v_mfma_f32_32x32x16_bf16 v[80:95], a[232:235], v[164:167], v[80:95]
    ds_read_b128 a[224:227], v3 offset:15360
    buffer_load_dwordx4 v0, s[4:7], s37 offen offset:3072 lds
    v_mfma_f32_32x32x16_bf16 v[80:95], a[236:239], v[168:171], v[80:95]
    v_mfma_f32_32x32x16_bf16 v[80:95], a[240:243], v[172:175], v[80:95]
    s_waitcnt lgkmcnt(0)
    s_waitcnt vmcnt(12)
    s_barrier
    ds_read_b128 a[228:231], v3 offset:16384
    ds_read_b128 a[232:235], v3 offset:17408
    s_add_u32 m0, s35, 67584
    s_add_u32 s37, s36, 67584
    buffer_load_dword v63, s[4:7], s37 offen lds
    v_mfma_f32_32x32x16_bf16 v[80:95], a[244:247], v[176:179], v[80:95]
    ds_read_b128 a[236:239], v3 offset:18432
    v_mfma_f32_32x32x16_bf16 v[80:95], a[248:251], v[180:183], v[80:95]
    ds_read_b128 a[240:243], v3 offset:19456
    v_mfma_f32_32x32x16_bf16 v[80:95], a[252:255], v[184:187], v[80:95]
    ds_read_b128 a[244:247], v3 offset:20480
    v_mfma_f32_32x32x16_bf16 v[80:95], a[224:227], v[188:191], v[80:95]
    ds_read_b128 a[248:251], v3 offset:21504
    s_waitcnt lgkmcnt(3)
    v_mfma_f32_32x32x16_bf16 v[80:95], a[228:231], v[192:195], v[80:95]
    ds_read_b128 a[252:255], v3 offset:22528
    v_mfma_f32_32x32x16_bf16 v[80:95], a[232:235], v[196:199], v[80:95]
    ds_read_b128 a[224:227], v3 offset:23552
    v_mfma_f32_32x32x16_bf16 v[80:95], a[236:239], v[200:203], v[80:95]
    ds_read_b128 a[228:231], v3 offset:24576
    s_waitcnt lgkmcnt(3)
    v_mfma_f32_32x32x16_bf16 v[80:95], a[240:243], v[204:207], v[80:95]
    ds_read_b128 a[232:235], v3 offset:25600
    v_mfma_f32_32x32x16_bf16 v[80:95], a[244:247], v[208:211], v[80:95]
    ds_read_b128 a[236:239], v3 offset:26624
    v_mfma_f32_32x32x16_bf16 v[80:95], a[248:251], v[212:215], v[80:95]
    ds_read_b128 a[240:243], v3 offset:27648
    buffer_store_dwordx4 a[0:3], v0, s[16:19], s14 offen sc1
    s_waitcnt lgkmcnt(3)
    v_mfma_f32_32x32x16_bf16 v[80:95], a[252:255], v[216:219], v[80:95]
    ds_read_b128 a[244:247], v3 offset:28672
    v_mfma_f32_32x32x16_bf16 v[80:95], a[224:227], v[220:223], v[80:95]
    ds_read_b128 a[248:251], v3 offset:29696
    buffer_store_dwordx4 a[4:7], v0, s[16:19], s14 offen offset:1024 sc1
    v_mfma_f32_32x32x16_bf16 v[80:95], a[228:231], v[224:227], v[80:95]
    ds_read_b128 a[252:255], v3 offset:30720
    s_waitcnt lgkmcnt(3)
    v_mfma_f32_32x32x16_bf16 v[80:95], a[232:235], v[228:231], v[80:95]
    ds_read_b128 a[224:227], v3 offset:31744
    buffer_store_dwordx4 a[8:11], v0, s[16:19], s14 offen offset:2048 sc1
    v_mfma_f32_32x32x16_bf16 v[80:95], a[236:239], v[232:235], v[80:95]
    ds_read_b128 a[228:231], v3 offset:32768
    v_mfma_f32_32x32x16_bf16 v[80:95], a[240:243], v[236:239], v[80:95]
    buffer_store_dwordx4 a[12:15], v0, s[16:19], s14 offen offset:3072 sc1
    s_waitcnt lgkmcnt(3)
    v_mfma_f32_32x32x16_bf16 v[80:95], a[244:247], v[240:243], v[80:95]
    v_mfma_f32_32x32x16_bf16 v[80:95], a[248:251], v[244:247], v[80:95]
    buffer_store_dwordx4 a[16:19], v0, s[16:19], s15 offen sc1
    s_waitcnt lgkmcnt(2)
    v_mfma_f32_32x32x16_bf16 v[80:95], a[252:255], v[248:251], v[80:95]
    ds_read_b128 a[232:235], v20 offset:25600
    ds_read_b128 a[236:239], v20 offset:26624
    s_waitcnt lgkmcnt(3)
    v_mfma_f32_32x32x16_bf16 v[80:95], a[224:227], v[252:255], v[80:95]
    buffer_store_dwordx4 a[20:23], v0, s[16:19], s15 offen offset:1024 sc1
    s_waitcnt lgkmcnt(2)
    v_mfma_f32_32x32x16_bf16 v[80:95], a[228:231], v[40:43], v[80:95]
    v_cvt_pk_bf16_f32 v48, v64, v65
    buffer_store_dword v37, v33, s[16:19], s72 offen sc1
    v_cvt_pk_bf16_f32 v49, v66, v67
    v_cvt_pk_bf16_f32 v50, v68, v69
    v_cvt_pk_bf16_f32 v51, v70, v71
    v_cvt_pk_bf16_f32 v52, v72, v73
    v_cvt_pk_bf16_f32 v53, v74, v75
    v_cvt_pk_bf16_f32 v54, v76, v77
    v_cvt_pk_bf16_f32 v55, v78, v79
    s_waitcnt lgkmcnt(1)
    v_mfma_f32_32x32x16_bf16 v[96:111], a[232:235], v[48:51], 0
    s_waitcnt lgkmcnt(0)
    v_mfma_f32_32x32x16_bf16 v[112:127], a[236:239], v[52:55], 0
    v_mul_f32 v80, v80, v47
    v_mul_f32 v81, v81, v47
    v_mul_f32 v82, v82, v47
    s_mov_b64 exec, 0xffff0000
    buffer_load_dword v21, v22, s[4:7], 0 offen
    s_mov_b64 exec, -1
    v_mul_f32 v83, v83, v47
    v_mul_f32 v84, v84, v47
    v_mul_f32 v85, v85, v47
    v_mul_f32 v86, v86, v47
    v_mul_f32 v87, v87, v47
    v_mul_f32 v88, v88, v47
    v_mul_f32 v89, v89, v47
    v_mul_f32 v90, v90, v47
    v_mul_f32 v91, v91, v47
    v_mul_f32 v92, v92, v47
    v_mul_f32 v93, v93, v47
    v_mul_f32 v94, v94, v47
    v_mul_f32 v95, v95, v47
    v_cvt_pk_bf16_f32 v80, v80, v81
    v_cvt_pk_bf16_f32 v81, v82, v83
    ds_write_b64 v6, v[80:81] offset:128
    v_cvt_pk_bf16_f32 v84, v84, v85
    v_cvt_pk_bf16_f32 v85, v86, v87
    ds_write_b64 v6, v[84:85] offset:144
    v_cvt_pk_bf16_f32 v88, v88, v89
    v_cvt_pk_bf16_f32 v89, v90, v91
    ds_write_b64 v6, v[88:89] offset:160
    v_cvt_pk_bf16_f32 v92, v92, v93
    v_cvt_pk_bf16_f32 v93, v94, v95
    ds_write_b64 v6, v[92:93] offset:176
    v_max3_f32 v56, v96, v97, v98
    v_max3_f32 v48, v99, v100, v101
    v_max3_f32 v56, v102, v103, v56
    v_max_f32_e64 v56, v56, v48
    v_max3_f32 v57, v104, v105, v106
    v_max3_f32 v49, v107, v108, v109
    v_max3_f32 v57, v110, v111, v57
    v_max_f32_e64 v57, v57, v49
    v_max3_f32 v58, v112, v113, v114
    v_max3_f32 v50, v115, v116, v117
    v_max3_f32 v58, v118, v119, v58
    v_max_f32_e64 v58, v58, v50
    v_max3_f32 v59, v120, v121, v122
    v_max3_f32 v51, v123, v124, v125
    v_max3_f32 v59, v126, v127, v59
    v_max_f32 v59, v59, v51
    v_permlane32_swap_b32 v56, v57
    s_nop 0
    v_permlane32_swap_b32 v58, v59
    v_max_f32 v56, v56, v57
    v_max_f32 v58, v58, v59
    v_mul_f32 v57, v56, v44
    v_mul_f32 v56, v56, v44
    v_mul_f32 v59, v58, v44
    v_mul_f32 v58, v58, v44
    v_permlane32_swap_b32 v56, v57
    s_nop 0
    v_permlane32_swap_b32_e64 v58, v59
    v_pk_fma_f32 v[96:97], v[96:97], v[44:45], v[56:57] op_sel:[0,0,0] op_sel_hi:[1,0,0] neg_lo:[0,0,1] neg_hi:[0,0,1]
    v_pk_fma_f32 v[98:99], v[98:99], v[44:45], v[56:57] op_sel:[0,0,0] op_sel_hi:[1,0,0] neg_lo:[0,0,1] neg_hi:[0,0,1]
    v_pk_fma_f32 v[100:101], v[100:101], v[44:45], v[56:57] op_sel:[0,0,0] op_sel_hi:[1,0,0] neg_lo:[0,0,1] neg_hi:[0,0,1]
    v_pk_fma_f32 v[102:103], v[102:103], v[44:45], v[56:57] op_sel:[0,0,0] op_sel_hi:[1,0,0] neg_lo:[0,0,1] neg_hi:[0,0,1]
    v_pk_fma_f32 v[104:105], v[104:105], v[44:45], v[56:57] op_sel:[0,0,1] op_sel_hi:[1,0,1] neg_lo:[0,0,1] neg_hi:[0,0,1]
    v_pk_fma_f32 v[106:107], v[106:107], v[44:45], v[56:57] op_sel:[0,0,1] op_sel_hi:[1,0,1] neg_lo:[0,0,1] neg_hi:[0,0,1]
    v_pk_fma_f32 v[108:109], v[108:109], v[44:45], v[56:57] op_sel:[0,0,1] op_sel_hi:[1,0,1] neg_lo:[0,0,1] neg_hi:[0,0,1]
    v_pk_fma_f32 v[110:111], v[110:111], v[44:45], v[56:57] op_sel:[0,0,1] op_sel_hi:[1,0,1] neg_lo:[0,0,1] neg_hi:[0,0,1]
    v_pk_fma_f32 v[112:113], v[112:113], v[44:45], v[58:59] op_sel:[0,0,0] op_sel_hi:[1,0,0] neg_lo:[0,0,1] neg_hi:[0,0,1]
    v_pk_fma_f32 v[114:115], v[114:115], v[44:45], v[58:59] op_sel:[0,0,0] op_sel_hi:[1,0,0] neg_lo:[0,0,1] neg_hi:[0,0,1]
    v_pk_fma_f32 v[116:117], v[116:117], v[44:45], v[58:59] op_sel:[0,0,0] op_sel_hi:[1,0,0] neg_lo:[0,0,1] neg_hi:[0,0,1]
    v_pk_fma_f32 v[118:119], v[118:119], v[44:45], v[58:59] op_sel:[0,0,0] op_sel_hi:[1,0,0] neg_lo:[0,0,1] neg_hi:[0,0,1]
    v_pk_fma_f32 v[120:121], v[120:121], v[44:45], v[58:59] op_sel:[0,0,1] op_sel_hi:[1,0,1] neg_lo:[0,0,1] neg_hi:[0,0,1]
    v_pk_fma_f32 v[122:123], v[122:123], v[44:45], v[58:59] op_sel:[0,0,1] op_sel_hi:[1,0,1] neg_lo:[0,0,1] neg_hi:[0,0,1]
    v_pk_fma_f32 v[124:125], v[124:125], v[44:45], v[58:59] op_sel:[0,0,1] op_sel_hi:[1,0,1] neg_lo:[0,0,1] neg_hi:[0,0,1]
    v_pk_fma_f32 v[126:127], v[126:127], v[44:45], v[58:59] op_sel:[0,0,1] op_sel_hi:[1,0,1] neg_lo:[0,0,1] neg_hi:[0,0,1]
    v_exp_f32 v96, v96
    v_exp_f32 v97, v97
    v_exp_f32 v98, v98
    v_exp_f32 v99, v99
    v_exp_f32 v100, v100
    v_exp_f32 v101, v101
    v_exp_f32 v102, v102
    v_exp_f32 v103, v103
    v_exp_f32 v104, v104
    v_exp_f32 v105, v105
    v_exp_f32 v106, v106
    v_exp_f32 v107, v107
    v_exp_f32 v108, v108
    v_exp_f32 v109, v109
    v_exp_f32 v110, v110
    v_exp_f32 v111, v111
    v_exp_f32 v112, v112
    v_exp_f32 v113, v113
    v_exp_f32 v114, v114
    v_exp_f32 v115, v115
    v_exp_f32 v116, v116
    v_exp_f32 v117, v117
    v_exp_f32 v118, v118
    v_exp_f32 v119, v119
    v_exp_f32 v120, v120
    v_exp_f32 v121, v121
    v_exp_f32 v122, v122
    v_exp_f32 v123, v123
    v_exp_f32 v124, v124
    v_exp_f32 v125, v125
    v_exp_f32 v126, v126
    v_exp_f32 v127, v127
    v_pk_add_f32 v[48:49], v[96:97], v[98:99]
    v_pk_add_f32 v[48:49], v[48:49], v[100:101]
    v_pk_add_f32 v[48:49], v[48:49], v[102:103]
    v_add_f32_e64 v56, v48, v49
    v_pk_add_f32 v[50:51], v[104:105], v[106:107]
    v_pk_add_f32 v[50:51], v[50:51], v[108:109]
    v_pk_add_f32 v[50:51], v[50:51], v[110:111]
    v_add_f32_e64 v57, v50, v51
    v_pk_add_f32 v[52:53], v[112:113], v[114:115]
    v_pk_add_f32 v[52:53], v[52:53], v[116:117]
    v_pk_add_f32 v[52:53], v[52:53], v[118:119]
    v_add_f32_e64 v58, v52, v53
    v_pk_add_f32 v[54:55], v[120:121], v[122:123]
    v_pk_add_f32 v[54:55], v[54:55], v[124:125]
    v_pk_add_f32 v[54:55], v[54:55], v[126:127]
    v_add_f32 v59, v54, v55
    v_permlane32_swap_b32 v56, v57
    s_nop 0
    v_permlane32_swap_b32 v58, v59
    v_add_f32 v56, v56, v57
    v_add_f32 v58, v58, v59
    v_rcp_f32 v56, v56
    v_rcp_f32 v58, v58
    v_mov_b32 v57, v56
    v_mov_b32 v59, v58
    s_nop 0
    v_permlane32_swap_b32 v56, v57
    v_permlane32_swap_b32_e64 v58, v59
    v_pk_mul_f32 v[96:97], v[96:97], v[56:57] op_sel:[0,0] op_sel_hi:[1,0]
    v_pk_mul_f32 v[98:99], v[98:99], v[56:57] op_sel:[0,0] op_sel_hi:[1,0]
    v_pk_mul_f32 v[100:101], v[100:101], v[56:57] op_sel:[0,0] op_sel_hi:[1,0]
    v_pk_mul_f32 v[102:103], v[102:103], v[56:57] op_sel:[0,0] op_sel_hi:[1,0]
    v_pk_mul_f32 v[104:105], v[104:105], v[56:57] op_sel:[0,1] op_sel_hi:[1,1]
    v_pk_mul_f32 v[106:107], v[106:107], v[56:57] op_sel:[0,1] op_sel_hi:[1,1]
    v_pk_mul_f32 v[108:109], v[108:109], v[56:57] op_sel:[0,1] op_sel_hi:[1,1]
    v_pk_mul_f32 v[110:111], v[110:111], v[56:57] op_sel:[0,1] op_sel_hi:[1,1]
    v_cvt_pk_bf16_f32 v96, v96, v97
    v_cvt_pk_bf16_f32 v97, v98, v99
    ds_write_b64 v6, v[96:97] offset:0
    v_cvt_pk_bf16_f32 v100, v100, v101
    v_cvt_pk_bf16_f32 v101, v102, v103
    ds_write_b64 v6, v[100:101] offset:16
    v_cvt_pk_bf16_f32 v104, v104, v105
    v_cvt_pk_bf16_f32 v105, v106, v107
    ds_write_b64 v6, v[104:105] offset:32
    v_cvt_pk_bf16_f32 v108, v108, v109
    v_cvt_pk_bf16_f32 v109, v110, v111
    ds_write_b64 v6, v[108:109] offset:48
    v_pk_mul_f32 v[112:113], v[112:113], v[58:59] op_sel:[0,0] op_sel_hi:[1,0]
    v_pk_mul_f32 v[114:115], v[114:115], v[58:59] op_sel:[0,0] op_sel_hi:[1,0]
    v_pk_mul_f32 v[116:117], v[116:117], v[58:59] op_sel:[0,0] op_sel_hi:[1,0]
    v_pk_mul_f32 v[118:119], v[118:119], v[58:59] op_sel:[0,0] op_sel_hi:[1,0]
    v_pk_mul_f32 v[120:121], v[120:121], v[58:59] op_sel:[0,1] op_sel_hi:[1,1]
    v_pk_mul_f32 v[122:123], v[122:123], v[58:59] op_sel:[0,1] op_sel_hi:[1,1]
    v_pk_mul_f32 v[124:125], v[124:125], v[58:59] op_sel:[0,1] op_sel_hi:[1,1]
    v_pk_mul_f32 v[126:127], v[126:127], v[58:59] op_sel:[0,1] op_sel_hi:[1,1]
    v_cvt_pk_bf16_f32 v112, v112, v113
    v_cvt_pk_bf16_f32 v113, v114, v115
    ds_write_b64 v6, v[112:113] offset:64
    v_cvt_pk_bf16_f32 v116, v116, v117
    v_cvt_pk_bf16_f32 v117, v118, v119
    ds_write_b64 v6, v[116:117] offset:80
    v_cvt_pk_bf16_f32 v120, v120, v121
    v_cvt_pk_bf16_f32 v121, v122, v123
    ds_write_b64 v6, v[120:121] offset:96
    v_cvt_pk_bf16_f32 v124, v124, v125
    v_cvt_pk_bf16_f32 v125, v126, v127
    ds_write_b64 v6, v[124:125] offset:112
    v_mov_b32 v48, s80
    v_mov_b32 v49, s80
    v_mov_b32 v50, s80
    v_mov_b32 v51, s80
    s_waitcnt lgkmcnt(0)
    s_barrier
    ds_read_b64_tr_b16 v[80:81], v7 offset:0
    ds_read_b64_tr_b16 v[82:83], v7 offset:800
    ds_read_b64_tr_b16 v[96:97], v8 offset:0
    ds_read_b64_tr_b16 v[98:99], v8 offset:800
    ds_read_b64_tr_b16 v[84:85], v7 offset:6400
    ds_read_b64_tr_b16 v[86:87], v7 offset:7200
    ds_read_b64_tr_b16 v[100:101], v8 offset:6400
    ds_read_b64_tr_b16 v[102:103], v8 offset:7200
    ds_read_b64_tr_b16 v[88:89], v7 offset:12800
    ds_read_b64_tr_b16 v[90:91], v7 offset:13600
    ds_read_b64_tr_b16 v[104:105], v8 offset:12800
    ds_read_b64_tr_b16 v[106:107], v8 offset:13600
    ds_read_b64_tr_b16 v[92:93], v7 offset:19200
    ds_read_b64_tr_b16 v[94:95], v7 offset:20000
    ds_read_b64_tr_b16 v[108:109], v8 offset:19200
    ds_read_b64_tr_b16 v[110:111], v8 offset:20000
    s_waitcnt lgkmcnt(12)
    v_mfma_f32_16x16x32_bf16 v[64:67], v[80:83], v[96:99], 0
    v_mfma_f32_16x16x32_bf16 v[68:71], v[80:83], v[48:51], 0
    s_waitcnt lgkmcnt(8)
    v_mfma_f32_16x16x32_bf16 v[64:67], v[84:87], v[100:103], v[64:67]
    v_mfma_f32_16x16x32_bf16 v[68:71], v[84:87], v[48:51], v[68:71]
    s_waitcnt lgkmcnt(4)
    v_mfma_f32_16x16x32_bf16 v[64:67], v[88:91], v[104:107], v[64:67]
    v_mfma_f32_16x16x32_bf16 v[68:71], v[88:91], v[48:51], v[68:71]
    s_waitcnt lgkmcnt(0)
    v_mfma_f32_16x16x32_bf16 v[64:67], v[92:95], v[108:111], v[64:67]
    v_mfma_f32_16x16x32_bf16 v[68:71], v[92:95], v[48:51], v[68:71]
    s_waitcnt vmcnt(17)
    s_nop 5
    v_cvt_pk_bf16_f32 v72, v64, v65
    v_cvt_pk_bf16_f32 v73, v66, v67
    v_min_u32_e64 v72, -2, v72
    buffer_store_dwordx2 v[72:73], v9, s[4:7], s76 offen sc1
    v_cvt_pk_bf16_f32 v74, v68, v69
    v_cvt_pk_bf16_f32 v75, v70, v71
    v_min_u32_e64 v74, -2, v74
    buffer_store_dwordx2 v[74:75], v10, s[4:7], s76 offen sc1
    s_waitcnt vmcnt(3)
    s_barrier
    s_cmp_lg_u32 s32, 3
    s_cbranch_scc1 post_10
    v_mov_b32 v48, v16
    v_mov_b32 v49, v17
    v_lshlrev_b32 v50, 1, v1
    s_lshl_b32 s39, s2, 7
    s_add_u32 s39, s39, 0x9000
    s_mov_b64 exec, 0xffff
    buffer_store_dwordx2 v[48:49], v50, s[4:7], s39 offen sc1
    s_mov_b64 exec, -1
post_10:
    ds_read_b128 a[240:243], v4 offset:0
    ds_read_b128 a[244:247], v4 offset:1024
    ds_read_b128 a[248:251], v4 offset:2048
    ds_read_b128 a[252:255], v4 offset:3072
    ds_read_b128 a[224:227], v4 offset:4096
    ds_read_b128 a[228:231], v4 offset:5120
    s_waitcnt lgkmcnt(3)
    v_mfma_f32_32x32x16_bf16 v[80:95], a[240:243], v[128:131], 0
    ds_read_b128 a[232:235], v4 offset:6144
    v_mfma_f32_32x32x16_bf16 v[80:95], a[244:247], v[132:135], v[80:95]
    ds_read_b128 a[236:239], v4 offset:7168
    buffer_load_dwordx4 v[128:131], v13, s[4:7], s81 offen
    v_mfma_f32_32x32x16_bf16 v[80:95], a[248:251], v[136:139], v[80:95]
    ds_read_b128 a[240:243], v4 offset:8192
    s_waitcnt lgkmcnt(3)
    v_mfma_f32_32x32x16_bf16 v[80:95], a[252:255], v[140:143], v[80:95]
    ds_read_b128 a[244:247], v4 offset:9216
    buffer_load_dwordx4 v[132:135], v13, s[4:7], s81 offen offset:1024
    v_mfma_f32_32x32x16_bf16 v[80:95], a[224:227], v[144:147], v[80:95]
    ds_read_b128 a[248:251], v4 offset:10240
    v_mfma_f32_32x32x16_bf16 v[80:95], a[228:231], v[148:151], v[80:95]
    ds_read_b128 a[252:255], v4 offset:11264
    buffer_load_dwordx4 v[136:139], v13, s[4:7], s81 offen offset:2048
    s_waitcnt lgkmcnt(3)
    v_mfma_f32_32x32x16_bf16 v[80:95], a[232:235], v[152:155], v[80:95]
    ds_read_b128 a[224:227], v4 offset:12288
    v_mfma_f32_32x32x16_bf16 v[80:95], a[236:239], v[156:159], v[80:95]
    ds_read_b128 a[228:231], v4 offset:13312
    buffer_load_dwordx4 v[140:143], v13, s[4:7], s81 offen offset:3072
    v_mfma_f32_32x32x16_bf16 v[80:95], a[240:243], v[160:163], v[80:95]
    ds_read_b128 a[232:235], v4 offset:14336
    s_waitcnt lgkmcnt(3)
    v_mfma_f32_32x32x16_bf16 v[80:95], a[244:247], v[164:167], v[80:95]
    ds_read_b128 a[236:239], v4 offset:15360
    s_add_u32 s93, s81, 4096
    buffer_load_dwordx4 v[144:147], v13, s[4:7], s93 offen
    v_mfma_f32_32x32x16_bf16 v[80:95], a[248:251], v[168:171], v[80:95]
    ds_read_b128 a[240:243], v4 offset:16384
    v_mfma_f32_32x32x16_bf16 v[80:95], a[252:255], v[172:175], v[80:95]
    ds_read_b128 a[244:247], v4 offset:17408
    buffer_load_dwordx4 v[148:151], v13, s[4:7], s93 offen offset:1024
    s_waitcnt lgkmcnt(3)
    v_mfma_f32_32x32x16_bf16 v[80:95], a[224:227], v[176:179], v[80:95]
    ds_read_b128 a[248:251], v4 offset:18432
    v_mfma_f32_32x32x16_bf16 v[80:95], a[228:231], v[180:183], v[80:95]
    ds_read_b128 a[252:255], v4 offset:19456
    buffer_load_dwordx4 v[152:155], v13, s[4:7], s93 offen offset:2048
    v_mfma_f32_32x32x16_bf16 v[80:95], a[232:235], v[184:187], v[80:95]
    ds_read_b128 a[224:227], v4 offset:20480
    s_waitcnt lgkmcnt(3)
    v_mfma_f32_32x32x16_bf16 v[80:95], a[236:239], v[188:191], v[80:95]
    ds_read_b128 a[228:231], v4 offset:21504
    buffer_load_dwordx4 v[156:159], v13, s[4:7], s93 offen offset:3072
    v_mfma_f32_32x32x16_bf16 v[80:95], a[240:243], v[192:195], v[80:95]
    ds_read_b128 a[232:235], v4 offset:22528
    v_mfma_f32_32x32x16_bf16 v[80:95], a[244:247], v[196:199], v[80:95]
    ds_read_b128 a[236:239], v4 offset:23552
    buffer_load_dwordx4 v[160:163], v13, s[4:7], s82 offen
    s_waitcnt lgkmcnt(3)
    v_mfma_f32_32x32x16_bf16 v[80:95], a[248:251], v[200:203], v[80:95]
    ds_read_b128 a[240:243], v4 offset:24576
    v_mfma_f32_32x32x16_bf16 v[80:95], a[252:255], v[204:207], v[80:95]
    ds_read_b128 a[244:247], v4 offset:25600
    buffer_load_dwordx4 v[164:167], v13, s[4:7], s82 offen offset:1024
    v_mfma_f32_32x32x16_bf16 v[80:95], a[224:227], v[208:211], v[80:95]
    ds_read_b128 a[248:251], v4 offset:26624
    s_waitcnt lgkmcnt(3)
    v_mfma_f32_32x32x16_bf16 v[80:95], a[228:231], v[212:215], v[80:95]
    ds_read_b128 a[252:255], v4 offset:27648
    buffer_load_dwordx4 v[168:171], v13, s[4:7], s82 offen offset:2048
    v_mfma_f32_32x32x16_bf16 v[80:95], a[232:235], v[216:219], v[80:95]
    ds_read_b128 a[224:227], v4 offset:28672
    v_mfma_f32_32x32x16_bf16 v[80:95], a[236:239], v[220:223], v[80:95]
    ds_read_b128 a[228:231], v4 offset:29696
    buffer_load_dwordx4 v[172:175], v13, s[4:7], s82 offen offset:3072
    s_waitcnt lgkmcnt(3)
    v_mfma_f32_32x32x16_bf16 v[80:95], a[240:243], v[224:227], v[80:95]
    ds_read_b128 a[232:235], v4 offset:30720
    v_mfma_f32_32x32x16_bf16 v[80:95], a[244:247], v[228:231], v[80:95]
    ds_read_b128 a[236:239], v4 offset:31744
    s_add_u32 s93, s82, 4096
    buffer_load_dwordx4 v[176:179], v13, s[4:7], s93 offen
    v_mfma_f32_32x32x16_bf16 v[80:95], a[248:251], v[232:235], v[80:95]
    ds_read_b128 a[240:243], v4 offset:32768
    s_waitcnt lgkmcnt(3)
    v_mfma_f32_32x32x16_bf16 v[80:95], a[252:255], v[236:239], v[80:95]
    buffer_load_dwordx4 v[180:183], v13, s[4:7], s93 offen offset:1024
    v_mfma_f32_32x32x16_bf16 v[80:95], a[224:227], v[240:243], v[80:95]
    v_mfma_f32_32x32x16_bf16 v[80:95], a[228:231], v[244:247], v[80:95]
    buffer_load_dwordx4 v[184:187], v13, s[4:7], s93 offen offset:2048
    s_waitcnt lgkmcnt(2)
    v_mfma_f32_32x32x16_bf16 v[80:95], a[232:235], v[248:251], v[80:95]
    ds_read_b128 a[244:247], v20 offset:25600
    ds_read_b128 a[248:251], v20 offset:26624
    s_waitcnt lgkmcnt(3)
    v_mfma_f32_32x32x16_bf16 v[80:95], a[236:239], v[252:255], v[80:95]
    buffer_load_dwordx4 v[188:191], v13, s[4:7], s93 offen offset:3072
    s_waitcnt lgkmcnt(2)
    v_mfma_f32_32x32x16_bf16 v[80:95], a[240:243], v[40:43], v[80:95]
    s_nop 11
    v_cvt_pk_bf16_f32 v48, v80, v81
    buffer_load_dwordx4 v[192:195], v0, s[4:7], s76 offen sc1
    v_cvt_pk_bf16_f32 v49, v82, v83
    v_cvt_pk_bf16_f32 v50, v84, v85
    v_cvt_pk_bf16_f32 v51, v86, v87
    v_cvt_pk_bf16_f32 v52, v88, v89
    v_cvt_pk_bf16_f32 v53, v90, v91
    v_cvt_pk_bf16_f32 v54, v92, v93
    v_cvt_pk_bf16_f32 v55, v94, v95
    s_waitcnt lgkmcnt(1)
    v_mfma_f32_32x32x16_bf16 v[96:111], a[244:247], v[48:51], 0
    s_waitcnt lgkmcnt(0)
    v_mfma_f32_32x32x16_bf16 v[112:127], a[248:251], v[52:55], 0
    s_nop 9
    v_max3_f32 v56, v96, v97, v98
    buffer_load_dwordx4 v[196:199], v0, s[4:7], s76 offen offset:1024 sc1
    v_max3_f32 v48, v99, v100, v101
    v_max3_f32 v56, v102, v103, v56
    v_max_f32_e64 v56, v56, v48
    v_max3_f32 v57, v104, v105, v106
    v_max3_f32 v49, v107, v108, v109
    v_max3_f32 v57, v110, v111, v57
    v_max_f32_e64 v57, v57, v49
    v_max3_f32 v58, v112, v113, v114
    v_max3_f32 v50, v115, v116, v117
    v_max3_f32 v58, v118, v119, v58
    v_max_f32_e64 v58, v58, v50
    v_max3_f32 v59, v120, v121, v122
    v_max3_f32 v51, v123, v124, v125
    v_max3_f32 v59, v126, v127, v59
    v_max_f32 v59, v59, v51
    v_permlane32_swap_b32 v56, v57
    buffer_load_dwordx4 v[200:203], v0, s[4:7], s76 offen offset:2048 sc1
    v_permlane32_swap_b32 v58, v59
    v_max_f32 v56, v56, v57
    v_max_f32 v58, v58, v59
    v_mul_f32 v57, v56, v44
    v_mul_f32 v56, v56, v44
    v_mul_f32 v59, v58, v44
    v_mul_f32 v58, v58, v44
    v_permlane32_swap_b32 v56, v57
    s_nop 0
    v_permlane32_swap_b32 v58, v59
    v_pk_fma_f32 v[96:97], v[96:97], v[44:45], v[56:57] op_sel:[0,0,0] op_sel_hi:[1,0,0] neg_lo:[0,0,1] neg_hi:[0,0,1]
    v_pk_fma_f32 v[98:99], v[98:99], v[44:45], v[56:57] op_sel:[0,0,0] op_sel_hi:[1,0,0] neg_lo:[0,0,1] neg_hi:[0,0,1]
    v_pk_fma_f32 v[100:101], v[100:101], v[44:45], v[56:57] op_sel:[0,0,0] op_sel_hi:[1,0,0] neg_lo:[0,0,1] neg_hi:[0,0,1]
    buffer_load_dwordx4 v[204:207], v0, s[4:7], s76 offen offset:3072 sc1
    v_pk_fma_f32 v[102:103], v[102:103], v[44:45], v[56:57] op_sel:[0,0,0] op_sel_hi:[1,0,0] neg_lo:[0,0,1] neg_hi:[0,0,1]
    v_pk_fma_f32 v[104:105], v[104:105], v[44:45], v[56:57] op_sel:[0,0,1] op_sel_hi:[1,0,1] neg_lo:[0,0,1] neg_hi:[0,0,1]
    v_pk_fma_f32 v[106:107], v[106:107], v[44:45], v[56:57] op_sel:[0,0,1] op_sel_hi:[1,0,1] neg_lo:[0,0,1] neg_hi:[0,0,1]
    v_pk_fma_f32 v[108:109], v[108:109], v[44:45], v[56:57] op_sel:[0,0,1] op_sel_hi:[1,0,1] neg_lo:[0,0,1] neg_hi:[0,0,1]
    v_pk_fma_f32 v[110:111], v[110:111], v[44:45], v[56:57] op_sel:[0,0,1] op_sel_hi:[1,0,1] neg_lo:[0,0,1] neg_hi:[0,0,1]
    v_pk_fma_f32 v[112:113], v[112:113], v[44:45], v[58:59] op_sel:[0,0,0] op_sel_hi:[1,0,0] neg_lo:[0,0,1] neg_hi:[0,0,1]
    v_pk_fma_f32 v[114:115], v[114:115], v[44:45], v[58:59] op_sel:[0,0,0] op_sel_hi:[1,0,0] neg_lo:[0,0,1] neg_hi:[0,0,1]
    v_pk_fma_f32 v[116:117], v[116:117], v[44:45], v[58:59] op_sel:[0,0,0] op_sel_hi:[1,0,0] neg_lo:[0,0,1] neg_hi:[0,0,1]
    v_pk_fma_f32 v[118:119], v[118:119], v[44:45], v[58:59] op_sel:[0,0,0] op_sel_hi:[1,0,0] neg_lo:[0,0,1] neg_hi:[0,0,1]
    v_pk_fma_f32 v[120:121], v[120:121], v[44:45], v[58:59] op_sel:[0,0,1] op_sel_hi:[1,0,1] neg_lo:[0,0,1] neg_hi:[0,0,1]
    v_pk_fma_f32 v[122:123], v[122:123], v[44:45], v[58:59] op_sel:[0,0,1] op_sel_hi:[1,0,1] neg_lo:[0,0,1] neg_hi:[0,0,1]
    v_pk_fma_f32 v[124:125], v[124:125], v[44:45], v[58:59] op_sel:[0,0,1] op_sel_hi:[1,0,1] neg_lo:[0,0,1] neg_hi:[0,0,1]
    v_pk_fma_f32 v[126:127], v[126:127], v[44:45], v[58:59] op_sel:[0,0,1] op_sel_hi:[1,0,1] neg_lo:[0,0,1] neg_hi:[0,0,1]
    v_exp_f32 v96, v96
    v_exp_f32 v97, v97
    s_add_u32 s94, s76, 4096
    buffer_load_dwordx4 v[208:211], v0, s[4:7], s94 offen sc1
    v_exp_f32 v98, v98
    v_exp_f32 v99, v99
    v_exp_f32 v100, v100
    v_exp_f32 v101, v101
    v_exp_f32 v102, v102
    v_exp_f32 v103, v103
    v_exp_f32 v104, v104
    v_exp_f32 v105, v105
    buffer_load_dwordx4 v[212:215], v0, s[4:7], s94 offen offset:1024 sc1
    v_exp_f32 v106, v106
    v_exp_f32 v107, v107
    v_exp_f32 v108, v108
    v_exp_f32 v109, v109
    v_exp_f32 v110, v110
    v_exp_f32 v111, v111
    v_exp_f32 v112, v112
    v_exp_f32 v113, v113
    buffer_load_dwordx4 v[216:219], v0, s[4:7], s94 offen offset:2048 sc1
    v_exp_f32 v114, v114
    v_exp_f32 v115, v115
    v_exp_f32 v116, v116
    v_exp_f32 v117, v117
    v_exp_f32 v118, v118
    v_exp_f32 v119, v119
    v_exp_f32 v120, v120
    v_exp_f32 v121, v121
    buffer_load_dwordx4 v[220:223], v0, s[4:7], s94 offen offset:3072 sc1
    v_exp_f32 v122, v122
    v_exp_f32 v123, v123
    v_exp_f32 v124, v124
    v_exp_f32 v125, v125
    v_exp_f32 v126, v126
    v_exp_f32 v127, v127
    v_pk_add_f32 v[48:49], v[96:97], v[98:99]
    v_pk_add_f32 v[48:49], v[48:49], v[100:101]
    v_pk_add_f32 v[48:49], v[48:49], v[102:103]
    v_add_f32_e64 v56, v48, v49
    buffer_load_dwordx4 v[224:227], v11, s[4:7], s76 offen sc1
    v_pk_add_f32 v[50:51], v[104:105], v[106:107]
    v_pk_add_f32 v[50:51], v[50:51], v[108:109]
    v_pk_add_f32 v[50:51], v[50:51], v[110:111]
    v_add_f32_e64 v57, v50, v51
    v_pk_add_f32 v[52:53], v[112:113], v[114:115]
    v_pk_add_f32 v[52:53], v[52:53], v[116:117]
    v_pk_add_f32 v[52:53], v[52:53], v[118:119]
    v_add_f32_e64 v58, v52, v53
    v_pk_add_f32 v[54:55], v[120:121], v[122:123]
    v_pk_add_f32 v[54:55], v[54:55], v[124:125]
    v_pk_add_f32 v[54:55], v[54:55], v[126:127]
    v_add_f32 v59, v54, v55
    v_permlane32_swap_b32 v56, v57
    s_nop 0
    v_permlane32_swap_b32 v58, v59
    buffer_load_dwordx2 v[60:61], v18, s[4:7], 0 offen sc1
    v_add_f32 v56, v56, v57
    v_add_f32 v58, v58, v59
    v_rcp_f32 v56, v56
    v_rcp_f32 v58, v58
    v_mov_b32 v57, v56
    v_mov_b32 v59, v58
    s_nop 0
    v_permlane32_swap_b32 v56, v57
    v_permlane32_swap_b32_e64 v58, v59
    v_pk_mul_f32 v[96:97], v[96:97], v[56:57] op_sel:[0,0] op_sel_hi:[1,0]
    v_pk_mul_f32 v[98:99], v[98:99], v[56:57] op_sel:[0,0] op_sel_hi:[1,0]
    v_pk_mul_f32 v[100:101], v[100:101], v[56:57] op_sel:[0,0] op_sel_hi:[1,0]
    v_pk_mul_f32 v[102:103], v[102:103], v[56:57] op_sel:[0,0] op_sel_hi:[1,0]
    v_pk_mul_f32 v[104:105], v[104:105], v[56:57] op_sel:[0,1] op_sel_hi:[1,1]
    v_pk_mul_f32 v[106:107], v[106:107], v[56:57] op_sel:[0,1] op_sel_hi:[1,1]
    v_pk_mul_f32 v[108:109], v[108:109], v[56:57] op_sel:[0,1] op_sel_hi:[1,1]
    v_pk_mul_f32 v[110:111], v[110:111], v[56:57] op_sel:[0,1] op_sel_hi:[1,1]
    v_cvt_pk_bf16_f32 v24, v96, v97
    v_cvt_pk_bf16_f32 v25, v98, v99
    v_cvt_pk_bf16_f32 v26, v100, v101
    v_cvt_pk_bf16_f32 v27, v102, v103
    v_cvt_pk_bf16_f32 v28, v104, v105
    v_cvt_pk_bf16_f32 v29, v106, v107
    v_cvt_pk_bf16_f32 v30, v108, v109
    v_cvt_pk_bf16_f32 v31, v110, v111
    v_pk_mul_f32 v[112:113], v[112:113], v[58:59] op_sel:[0,0] op_sel_hi:[1,0]
    v_pk_mul_f32 v[114:115], v[114:115], v[58:59] op_sel:[0,0] op_sel_hi:[1,0]
    v_pk_mul_f32 v[116:117], v[116:117], v[58:59] op_sel:[0,0] op_sel_hi:[1,0]
    v_pk_mul_f32 v[118:119], v[118:119], v[58:59] op_sel:[0,0] op_sel_hi:[1,0]
    v_pk_mul_f32 v[120:121], v[120:121], v[58:59] op_sel:[0,1] op_sel_hi:[1,1]
    v_pk_mul_f32 v[122:123], v[122:123], v[58:59] op_sel:[0,1] op_sel_hi:[1,1]
    v_pk_mul_f32 v[124:125], v[124:125], v[58:59] op_sel:[0,1] op_sel_hi:[1,1]
    v_pk_mul_f32 v[126:127], v[126:127], v[58:59] op_sel:[0,1] op_sel_hi:[1,1]
    v_cvt_pk_bf16_f32 v32, v112, v113
    v_cvt_pk_bf16_f32 v33, v114, v115
    v_cvt_pk_bf16_f32 v34, v116, v117
    v_cvt_pk_bf16_f32 v35, v118, v119
    v_cvt_pk_bf16_f32 v36, v120, v121
    v_cvt_pk_bf16_f32 v37, v122, v123
    v_cvt_pk_bf16_f32 v38, v124, v125
    v_cvt_pk_bf16_f32 v39, v126, v127
L_p2a_0:
    ds_read_b128 a[252:255], v20 offset:27648
    s_waitcnt vmcnt(7)
    v_max3_u32 v48, v192, v196, v200
    s_waitcnt vmcnt(5)
    v_max3_u32 v48, v204, v208, v48
    s_waitcnt vmcnt(3)
    v_max3_u32 v48, v212, v216, v48
    s_waitcnt vmcnt(1)
    v_max3_u32 v48, v220, v224, v48
    v_cmp_eq_u32_e64 vcc, -1, v48
    s_cbranch_vccnz gstub_12
gback_13:
    s_waitcnt lgkmcnt(0)
    v_mfma_f32_16x16x32_bf16 v[64:67], a[252:255], v[224:227], 0
    s_waitcnt vmcnt(0)
    v_cmp_ne_u64_e64 vcc, s[28:29], v[60:61]
    s_cbranch_vccnz fstub_14
fback_15:
    v_mfma_f32_16x16x32_bf16 v[68:71], a[252:255], v[192:195], 0
    v_mfma_f32_16x16x32_bf16 v[68:71], a[252:255], v[196:199], v[68:71]
    v_mfma_f32_16x16x32_bf16 v[68:71], a[252:255], v[200:203], v[68:71]
    v_mfma_f32_16x16x32_bf16 v[68:71], a[252:255], v[204:207], v[68:71]
    v_mfma_f32_16x16x32_bf16 v[68:71], a[252:255], v[208:211], v[68:71]
    s_add_u32 m0, s11, 101376
    s_add_u32 s37, s34, 101376
    buffer_load_dwordx4 v0, s[4:7], s37 offen lds
    v_mfma_f32_16x16x32_bf16 v[68:71], a[252:255], v[212:215], v[68:71]
    v_mfma_f32_16x16x32_bf16 v[68:71], a[252:255], v[216:219], v[68:71]
    v_mfma_f32_16x16x32_bf16 v[68:71], a[252:255], v[220:223], v[68:71]
    v_add_f32_dpp v64, v64, v64 row_ror:1 row_mask:0xf bank_mask:0xf
    v_add_f32_dpp v65, v65, v65 row_ror:1 row_mask:0xf bank_mask:0xf
    v_add_f32_dpp v66, v66, v66 row_ror:1 row_mask:0xf bank_mask:0xf
    v_add_f32_dpp v67, v67, v67 row_ror:1 row_mask:0xf bank_mask:0xf
    buffer_load_dwordx4 v0, s[4:7], s37 offen offset:1024 lds
    v_add_f32_dpp v64, v64, v64 row_ror:2 row_mask:0xf bank_mask:0xf
    v_add_f32_dpp v65, v65, v65 row_ror:2 row_mask:0xf bank_mask:0xf
    v_add_f32_dpp v66, v66, v66 row_ror:2 row_mask:0xf bank_mask:0xf
    v_add_f32_dpp v67, v67, v67 row_ror:2 row_mask:0xf bank_mask:0xf
    v_add_f32_dpp v64, v64, v64 row_ror:4 row_mask:0xf bank_mask:0xf
    v_add_f32_dpp v65, v65, v65 row_ror:4 row_mask:0xf bank_mask:0xf
    v_add_f32_dpp v66, v66, v66 row_ror:4 row_mask:0xf bank_mask:0xf
    v_add_f32_dpp v67, v67, v67 row_ror:4 row_mask:0xf bank_mask:0xf
    v_cvt_pk_bf16_f32 v72, v64, v65
    v_cvt_pk_bf16_f32 v73, v66, v67
    buffer_load_dwordx4 v0, s[4:7], s37 offen offset:2048 lds
    ds_write_b64 v12, v[72:73] offset:256
    v_cvt_pk_bf16_f32 v74, v68, v69
    v_cvt_pk_bf16_f32 v75, v70, v71
    ds_write_b64 v12, v[74:75] offset:0
    buffer_load_dwordx4 v0, s[4:7], s37 offen offset:3072 lds
    s_add_u32 m0, s11, 117760
    s_add_u32 s37, s34, 117760
    buffer_load_dwordx4 v0, s[4:7], s37 offen lds
    buffer_load_dwordx4 v0, s[4:7], s37 offen offset:1024 lds
    buffer_load_dwordx4 v0, s[4:7], s37 offen offset:2048 lds
    buffer_load_dwordx4 v0, s[4:7], s37 offen offset:3072 lds
    s_add_u32 m0, s35, 101376
    s_add_u32 s37, s36, 101376
    buffer_load_dword v63, s[4:7], s37 offen lds
    s_waitcnt lgkmcnt(0)
    s_barrier
    ds_read_b128 a[224:227], v20 offset:0
    ds_read_b128 a[232:235], v20 offset:2048
    ds_read_b128 a[228:231], v20 offset:1024
    ds_read_b128 a[236:239], v20 offset:3072
    s_waitcnt lgkmcnt(3)
    v_mfma_f32_32x32x16_bf16 v[64:79], a[224:227], v[24:27], 0
    s_waitcnt lgkmcnt(2)
    v_mfma_f32_32x32x16_bf16 v[80:95], a[232:235], v[32:35], 0
    s_waitcnt lgkmcnt(1)
    v_mfma_f32_32x32x16_bf16 v[64:79], a[228:231], v[28:31], v[64:79]
    s_waitcnt lgkmcnt(0)
    v_mfma_f32_32x32x16_bf16 v[80:95], a[236:239], v[36:39], v[80:95]
    v_accvgpr_read_b32 v32, a32
    v_accvgpr_read_b32 v33, a33
    v_accvgpr_read_b32 v34, a34
    v_accvgpr_read_b32 v35, a35
    v_accvgpr_read_b32 v36, a36
    v_accvgpr_read_b32 v37, a37
    v_accvgpr_read_b32 v38, a38
    v_accvgpr_read_b32 v39, a39
    v_add_u32 v24, s99, v20
    v_add_u32 v25, s100, v20
    v_add_u32 v26, s101, v20
    v_add_u32 v27, s3, v20
    s_add_u32 s39, s3, 135168
    v_add_u32_e64 v28, s39, v1
    s_and_b32 s39, s32, 1
    s_lshl_b32 s39, s39, 8
    s_add_u32 s39, s39, 135168
    v_add_u32_e64 v29, s39, v1
    v_add_f32 v72, 0x358637bd, v72
    v_rcp_f32 v72, v72
    s_nop 0
    v_pk_mul_f32 v[64:65], v[64:65], v[72:73] op_sel_hi:[1,0]
    v_pk_mul_f32 v[66:67], v[66:67], v[72:73] op_sel_hi:[1,0]
    v_pk_mul_f32 v[68:69], v[68:69], v[72:73] op_sel_hi:[1,0]
    v_pk_mul_f32 v[70:71], v[70:71], v[72:73] op_sel_hi:[1,0]
    v_cvt_pk_bf16_f32 v48, v64, v65
    v_cvt_pk_bf16_f32 v49, v66, v67
    v_cvt_pk_bf16_f32 v50, v68, v69
    v_cvt_pk_bf16_f32 v51, v70, v71
    buffer_store_dwordx4 v[48:51], v0, s[4:7], s67 offen sc1
    v_add_f32 v88, 0x358637bd, v88
    v_rcp_f32 v88, v88
    s_nop 0
    v_pk_mul_f32 v[80:81], v[80:81], v[88:89] op_sel_hi:[1,0]
    v_pk_mul_f32 v[82:83], v[82:83], v[88:89] op_sel_hi:[1,0]
    v_pk_mul_f32 v[84:85], v[84:85], v[88:89] op_sel_hi:[1,0]
    v_pk_mul_f32 v[86:87], v[86:87], v[88:89] op_sel_hi:[1,0]
    v_cvt_pk_bf16_f32 v52, v80, v81
    v_cvt_pk_bf16_f32 v53, v82, v83
    v_cvt_pk_bf16_f32 v54, v84, v85
    v_cvt_pk_bf16_f32 v55, v86, v87
    buffer_store_dwordx4 v[52:55], v0, s[4:7], s67 offen offset:1024 sc1
    s_add_u32 m0, s11, 0
    s_add_u32 s37, s34, 135168
    buffer_load_dwordx4 v0, s[4:7], s37 offen lds
    buffer_load_dwordx4 v0, s[4:7], s37 offen offset:1024 lds
    buffer_load_dwordx4 v0, s[4:7], s37 offen offset:2048 lds
    buffer_load_dwordx4 v0, s[4:7], s37 offen offset:3072 lds
    s_lshr_b32 s39, s2, 3
    s_lshl_b32 s39, s39, 2
    s_add_u32 s39, s39, s32
    s_lshl_b32 s39, s39, 8
    s_add_u32 s39, s39, L_p3_0-interleave_layers__linear_kernel_hedgehog__geglu_ffn__prompt_kernel
    v_and_b32 v18, 0x80, v0
    v_add_u32 v18, s39, v18
    v_min_u32 v18, L_codeend-interleave_layers__linear_kernel_hedgehog__geglu_ffn__prompt_kernel-4, v18
    global_load_dword v21, v18, s[12:13]
    v_permlane32_swap_b32 v32, v34
    v_permlane32_swap_b32 v33, v35
    v_permlane32_swap_b32 v36, v38
    v_permlane32_swap_b32_e64 v37, v39
    s_waitcnt vmcnt(5)
    s_barrier
    s_cmp_lg_u32 s32, 0
    s_cbranch_scc1 hop_16
    s_mov_b64 exec, 1
    s_cmp_lg_u32 s8, 0
    s_cbranch_scc1 ss_18
    buffer_store_dwordx2 v[16:17], off, s[4:7], s77
sb_19:
    s_mov_b64 exec, -1
    s_mov_b32 s74, 0
poll_20:
    buffer_load_dwordx2 v[60:61], v19, s[4:7], 0 offen sc1
    s_waitcnt vmcnt(0)
    v_cmp_ne_u64 vcc, s[28:29], v[60:61]
    s_cbranch_vccz polled_21
    s_add_u32 s74, s74, 1
    s_cmp_lt_u32 s74, 0x20000
    s_cbranch_scc1 poll_20
    s_mov_b32 s74, 16
    s_branch L_timeout
polled_21:
hop_16:
    s_barrier
L_p2_0:
    v_lshlrev_b32_e64 v64, 16, v32
    buffer_load_dwordx4 v[192:195], v0, s[4:7], s68 offen sc1
    v_and_b32 v65, 0xffff0000, v32
    v_lshlrev_b32_e64 v66, 16, v33
    v_and_b32 v67, 0xffff0000, v33
    buffer_load_dwordx4 v[196:199], v0, s[4:7], s68 offen offset:1024 sc1
    v_lshlrev_b32_e64 v68, 16, v34
    v_and_b32 v69, 0xffff0000, v34
    v_lshlrev_b32_e64 v70, 16, v35
    buffer_load_dwordx4 v[200:203], v0, s[4:7], s68 offen offset:2048 sc1
    v_and_b32 v71, 0xffff0000, v35
    v_mov_b64 v[72:73], 0
    v_mov_b64 v[74:75], 0
    buffer_load_dwordx4 v[204:207], v0, s[4:7], s68 offen offset:3072 sc1
    v_mov_b64 v[76:77], 0
    v_mov_b64 v[78:79], 0
    v_lshlrev_b32_e64 v96, 16, v36
    s_add_u32 s93, s68, 4096
    buffer_load_dwordx4 v[208:211], v0, s[4:7], s93 offen sc1
    v_and_b32 v97, 0xffff0000, v36
    v_lshlrev_b32_e64 v98, 16, v37
    v_and_b32 v99, 0xffff0000, v37
    buffer_load_dwordx4 v[212:215], v0, s[4:7], s93 offen offset:1024 sc1
    v_lshlrev_b32_e64 v100, 16, v38
    v_and_b32 v101, 0xffff0000, v38
    v_lshlrev_b32_e64 v102, 16, v39
    buffer_load_dwordx4 v[216:219], v0, s[4:7], s93 offen offset:2048 sc1
    v_and_b32 v103, 0xffff0000, v39
    v_mov_b64 v[104:105], 0
    v_mov_b64 v[106:107], 0
    buffer_load_dwordx4 v[220:223], v0, s[4:7], s93 offen offset:3072 sc1
    v_mov_b64 v[108:109], 0
    v_mov_b64_e64 v[110:111], 0
    s_waitcnt vmcnt(7)
    v_mfma_f32_32x32x16_bf16 v[64:79], v[128:131], v[192:195], v[64:79]
    buffer_load_dwordx4 v[224:227], v0, s[4:7], s96 offen sc1
    v_mfma_f32_32x32x16_bf16 v[80:95], v[160:163], v[192:195], 0
    s_waitcnt vmcnt(7)
    v_mfma_f32_32x32x16_bf16 v[64:79], v[132:135], v[196:199], v[64:79]
    buffer_load_dwordx4 v[228:231], v0, s[4:7], s96 offen offset:1024 sc1
    v_mfma_f32_32x32x16_bf16 v[80:95], v[164:167], v[196:199], v[80:95]
    s_waitcnt vmcnt(7)
    v_mfma_f32_32x32x16_bf16 v[64:79], v[136:139], v[200:203], v[64:79]
    buffer_load_dwordx4 v[232:235], v0, s[4:7], s96 offen offset:2048 sc1
    v_mfma_f32_32x32x16_bf16 v[80:95], v[168:171], v[200:203], v[80:95]
    s_waitcnt vmcnt(7)
    v_mfma_f32_32x32x16_bf16 v[64:79], v[140:143], v[204:207], v[64:79]
    buffer_load_dwordx4 v[236:239], v0, s[4:7], s96 offen offset:3072 sc1
    v_mfma_f32_32x32x16_bf16 v[80:95], v[172:175], v[204:207], v[80:95]
    s_waitcnt vmcnt(7)
    v_mfma_f32_32x32x16_bf16 v[64:79], v[144:147], v[208:211], v[64:79]
    s_add_u32 s93, s96, 4096
    buffer_load_dwordx4 v[240:243], v0, s[4:7], s93 offen sc1
    v_mfma_f32_32x32x16_bf16 v[80:95], v[176:179], v[208:211], v[80:95]
    s_waitcnt vmcnt(7)
    v_mfma_f32_32x32x16_bf16 v[64:79], v[148:151], v[212:215], v[64:79]
    buffer_load_dwordx4 v[244:247], v0, s[4:7], s93 offen offset:1024 sc1
    v_mfma_f32_32x32x16_bf16 v[80:95], v[180:183], v[212:215], v[80:95]
    s_waitcnt vmcnt(7)
    v_mfma_f32_32x32x16_bf16 v[64:79], v[152:155], v[216:219], v[64:79]
    buffer_load_dwordx4 v[248:251], v0, s[4:7], s93 offen offset:2048 sc1
    v_mfma_f32_32x32x16_bf16 v[80:95], v[184:187], v[216:219], v[80:95]
    s_waitcnt vmcnt(7)
    v_mfma_f32_32x32x16_bf16 v[64:79], v[156:159], v[220:223], v[64:79]
    buffer_load_dwordx4 v[252:255], v0, s[4:7], s93 offen offset:3072 sc1
    v_mfma_f32_32x32x16_bf16 v[80:95], v[188:191], v[220:223], v[80:95]
    s_waitcnt vmcnt(7)
    v_mfma_f32_32x32x16_bf16 v[96:111], v[128:131], v[224:227], v[96:111]
    v_mfma_f32_32x32x16_bf16 v[112:127], v[160:163], v[224:227], 0
    s_nop 6
    ds_write_b128 v24, v[72:75]
    s_waitcnt vmcnt(6)
    v_mfma_f32_32x32x16_bf16 v[96:111], v[132:135], v[228:231], v[96:111]
    ds_write_b128 v24, v[76:79] offset:1024
    v_mfma_f32_32x32x16_bf16 v[112:127], v[164:167], v[228:231], v[112:127]
    ds_write_b128 v25, v[80:83]
    s_waitcnt vmcnt(5)
    v_mfma_f32_32x32x16_bf16 v[96:111], v[136:139], v[232:235], v[96:111]
    ds_write_b128 v25, v[84:87] offset:1024
    v_mfma_f32_32x32x16_bf16 v[112:127], v[168:171], v[232:235], v[112:127]
    ds_write_b128 v26, v[88:91]
    s_waitcnt vmcnt(4)
    v_mfma_f32_32x32x16_bf16 v[96:111], v[140:143], v[236:239], v[96:111]
    s_add_u32 m0, s11, 16384
    s_add_u32 s37, s34, 151552
    buffer_load_dwordx4 v0, s[4:7], s37 offen lds
    ds_write_b128 v26, v[92:95] offset:1024
    v_mfma_f32_32x32x16_bf16 v[112:127], v[172:175], v[236:239], v[112:127]
    buffer_load_dwordx4 v0, s[4:7], s37 offen offset:1024 lds
    s_waitcnt lgkmcnt(0)
    s_barrier
    ds_read_b128 v[72:75], v27 offset:0
    ds_read_b128 v[76:79], v27 offset:1024
    s_waitcnt vmcnt(5)
    v_mfma_f32_32x32x16_bf16 v[96:111], v[144:147], v[240:243], v[96:111]
    buffer_load_dwordx4 v0, s[4:7], s37 offen offset:2048 lds
    ds_read_b128 v[80:83], v27 offset:2048
    ds_read_b128 v[84:87], v27 offset:3072
    ds_read_b128 v[88:91], v27 offset:4096
    ds_read_b128 v[92:95], v27 offset:5120
    s_waitcnt lgkmcnt(5)
    v_add_f32_e64 v64, v64, v72
    v_mfma_f32_32x32x16_bf16 v[112:127], v[176:179], v[240:243], v[112:127]
    buffer_load_dwordx4 v0, s[4:7], s37 offen offset:3072 lds
    v_add_f32 v65, v65, v73
    v_add_f32 v66, v66, v74
    v_add_f32 v67, v67, v75
    s_waitcnt lgkmcnt(4)
    v_add_f32 v68, v68, v76
    s_waitcnt vmcnt(6)
    v_mfma_f32_32x32x16_bf16 v[96:111], v[148:151], v[244:247], v[96:111]
    s_add_u32 m0, s35, 0
    s_add_u32 s37, s36, 135168
    buffer_load_dword v63, s[4:7], s37 offen lds
    v_add_f32 v69, v69, v77
    v_add_f32 v70, v70, v78
    v_add_f32 v71, v71, v79
    v_mfma_f32_32x32x16_bf16 v[112:127], v[180:183], v[244:247], v[112:127]
    s_add_u32 m0, s11, 33792
    s_add_u32 s37, s34, 168960
    buffer_load_dwordx4 v0, s[4:7], s37 offen lds
    s_waitcnt lgkmcnt(3)
    v_add_f32_e64 v64, v64, v80
    s_waitcnt vmcnt(7)
    v_mfma_f32_32x32x16_bf16 v[96:111], v[152:155], v[248:251], v[96:111]
    buffer_load_dwordx4 v0, s[4:7], s37 offen offset:1024 lds
    v_add_f32 v65, v65, v81
    v_add_f32 v66, v66, v82
    v_add_f32 v67, v67, v83
    s_waitcnt lgkmcnt(2)
    v_add_f32_e64 v68, v68, v84
    v_mfma_f32_32x32x16_bf16 v[112:127], v[184:187], v[248:251], v[112:127]
    buffer_load_dwordx4 v0, s[4:7], s37 offen offset:2048 lds
    v_add_f32 v69, v69, v85
    v_add_f32 v70, v70, v86
    v_add_f32 v71, v71, v87
    s_waitcnt lgkmcnt(1)
    v_add_f32 v64, v64, v88
    s_waitcnt vmcnt(8)
    v_mfma_f32_32x32x16_bf16 v[96:111], v[156:159], v[252:255], v[96:111]
    buffer_load_dwordx4 v0, s[4:7], s37 offen offset:3072 lds
    v_add_f32 v65, v65, v89
    v_add_f32 v66, v66, v90
    v_add_f32 v67, v67, v91
    s_waitcnt lgkmcnt(0)
    v_add_f32_e64 v68, v68, v92
    v_mfma_f32_32x32x16_bf16 v[112:127], v[188:191], v[252:255], v[112:127]
    v_add_f32 v69, v69, v93
    v_add_f32 v70, v70, v94
    v_add_f32 v71, v71, v95
    s_barrier
    v_cvt_pk_bf16_f32 v72, v64, v65
    v_cvt_pk_bf16_f32 v73, v66, v67
    v_cvt_pk_bf16_f32 v74, v68, v69
    v_cvt_pk_bf16_f32 v75, v70, v71
    buffer_store_dwordx4 v[72:75], v0, s[4:7], s69 offen sc1
    v_mov_b64 v[64:65], 0
    v_dot2c_f32_bf16 v64, s80, v72
    ds_write_b128 v24, v[104:107]
    v_dot2c_f32_bf16 v65, v72, v72
    v_dot2c_f32_bf16 v64, s80, v73
    ds_write_b128 v24, v[108:111] offset:1024
    v_dot2c_f32_bf16 v65, v73, v73
    v_dot2c_f32_bf16 v64, s80, v74
    ds_write_b128 v25, v[112:115]
    v_dot2c_f32_bf16 v65, v74, v74
    v_dot2c_f32_bf16 v64, s80, v75
    ds_write_b128 v25, v[116:119] offset:1024
    v_dot2c_f32_bf16 v65, v75, v75
    s_nop 2
    v_permlane32_swap_b32_e64 v64, v65
    ds_write_b128 v26, v[120:123]
    v_add_f32_e64 v64, v64, v65
    ds_write_b128 v26, v[124:127] offset:1024
    s_waitcnt lgkmcnt(0)
    s_barrier
    ds_read_b128 v[104:107], v27 offset:0
    ds_read_b128 v[108:111], v27 offset:1024
    ds_read_b128 v[112:115], v27 offset:2048
    ds_read_b128 v[116:119], v27 offset:3072
    ds_read_b128 v[120:123], v27 offset:4096
    ds_read_b128 v[124:127], v27 offset:5120
    s_waitcnt lgkmcnt(5)
    v_pk_add_f32 v[96:97], v[96:97], v[104:105]
    v_pk_add_f32 v[98:99], v[98:99], v[106:107]
    s_waitcnt lgkmcnt(4)
    v_pk_add_f32 v[100:101], v[100:101], v[108:109]
    v_pk_add_f32 v[102:103], v[102:103], v[110:111]
    s_waitcnt lgkmcnt(3)
    v_pk_add_f32 v[96:97], v[96:97], v[112:113]
    v_pk_add_f32 v[98:99], v[98:99], v[114:115]
    s_waitcnt lgkmcnt(2)
    v_pk_add_f32 v[100:101], v[100:101], v[116:117]
    v_pk_add_f32 v[102:103], v[102:103], v[118:119]
    s_waitcnt lgkmcnt(1)
    v_pk_add_f32 v[96:97], v[96:97], v[120:121]
    v_pk_add_f32 v[98:99], v[98:99], v[122:123]
    s_waitcnt lgkmcnt(0)
    v_pk_add_f32 v[100:101], v[100:101], v[124:125]
    v_pk_add_f32 v[102:103], v[102:103], v[126:127]
    v_cvt_pk_bf16_f32 v104, v96, v97
    v_cvt_pk_bf16_f32 v105, v98, v99
    v_cvt_pk_bf16_f32 v106, v100, v101
    v_cvt_pk_bf16_f32 v107, v102, v103
    buffer_store_dwordx4 v[104:107], v0, s[4:7], s70 offen sc1
    v_mov_b64 v[96:97], 0
    v_dot2c_f32_bf16 v96, s80, v104
    v_dot2c_f32_bf16 v97, v104, v104
    v_dot2c_f32_bf16 v96, s80, v105
    v_dot2c_f32_bf16 v97, v105, v105
    v_dot2c_f32_bf16 v96, s80, v106
    v_dot2c_f32_bf16 v97, v106, v106
    v_dot2c_f32_bf16 v96, s80, v107
    v_dot2c_f32_bf16 v97, v107, v107
    s_nop 2
    v_permlane32_swap_b32 v96, v97
    v_add_f32 v96, v96, v97
    ds_write_b32 v28, v64
    ds_write_b32 v28, v96 offset:256
    s_add_u32 m0, s11, 50176
    s_add_u32 s37, s34, 185344
    buffer_load_dwordx4 v0, s[4:7], s37 offen lds
    buffer_load_dwordx4 v0, s[4:7], s37 offen offset:1024 lds
    buffer_load_dwordx4 v0, s[4:7], s37 offen offset:2048 lds
    buffer_load_dwordx4 v0, s[4:7], s37 offen offset:3072 lds
    s_add_u32 m0, s35, 33792
    s_add_u32 s37, s36, 168960
    buffer_load_dword v63, s[4:7], s37 offen lds
    s_waitcnt vmcnt(5) lgkmcnt(0)
    s_barrier
    s_cmp_lg_u32 s32, 0
    s_cbranch_scc1 hop_23
    s_mov_b64 exec, 1
    s_cmp_lg_u32 s8, 0
    s_cbranch_scc1 ss_25
    buffer_store_dwordx2 v[16:17], off, s[4:7], s77 offset:128
sb_26:
    s_mov_b64 exec, -1
    s_mov_b32 s74, 0
poll_27:
    buffer_load_dwordx2 v[60:61], v19, s[4:7], 0 offen offset:128 sc1
    s_waitcnt vmcnt(0)
    v_cmp_ne_u64_e64 vcc, s[28:29], v[60:61]
    s_cbranch_vccz polled_28
    s_add_u32 s74, s74, 1
    s_cmp_lt_u32 s74, 0x20000
    s_cbranch_scc1 poll_27
    s_mov_b32 s74, 17
    s_branch L_timeout
polled_28:
hop_23:
    s_cmp_lt_u32 s32, 2
    s_cbranch_scc1 sto_30
    ds_read_b32 v48, v29 offset:0
    ds_read_b32 v49, v29 offset:6144
    ds_read_b32 v50, v29 offset:12288
    ds_read_b32 v51, v29 offset:18432
    s_waitcnt lgkmcnt(2)
    v_add_f32 v48, v48, v49
    s_waitcnt lgkmcnt(0)
    v_add_f32 v50, v50, v51
    v_add_f32 v48, v48, v50
    buffer_store_dword v48, v1, s[4:7], s71 offen sc1
    s_waitcnt vmcnt(0)
    s_mov_b64 exec, 1
    s_cmp_lg_u32 s8, 0
    s_cbranch_scc1 ss_32
    buffer_store_dwordx2 v[16:17], off, s[4:7], s9 offset:384
sb_33:
    s_mov_b64 exec, -1
sto_30:
    s_waitcnt vmcnt(0)
    s_barrier
L_p3_0:
    buffer_load_dwordx4 v[128:131], v0, s[4:7], s65 offen sc1
    buffer_load_dwordx4 v[132:135], v0, s[4:7], s65 offen offset:1024 sc1
    buffer_load_dwordx4 v[136:139], v0, s[4:7], s65 offen offset:2048 sc1
    buffer_load_dwordx4 v[140:143], v0, s[4:7], s65 offen offset:3072 sc1
    s_add_u32 s93, s65, 4096
    buffer_load_dwordx4 v[144:147], v0, s[4:7], s93 offen sc1
    buffer_load_dwordx4 v[148:151], v0, s[4:7], s93 offen offset:1024 sc1
    buffer_load_dwordx4 v[152:155], v0, s[4:7], s93 offen offset:2048 sc1
    ds_read_b128 a[240:243], v5 offset:0
    ds_read_b128 a[244:247], v2 offset:0
    ds_read_b128 a[248:251], v5 offset:1024
    ds_read_b128 a[252:255], v2 offset:1024
    ds_read_b128 a[224:227], v3 offset:0
    ds_read_b128 a[228:231], v5 offset:2048
    s_waitcnt vmcnt(6) lgkmcnt(3)
    v_mfma_f32_32x32x16_bf16 v[64:79], a[240:243], v[128:131], 0
    ds_read_b128 a[232:235], v2 offset:2048
    buffer_load_dwordx4 v[156:159], v0, s[4:7], s93 offen offset:3072 sc1
    v_mfma_f32_32x32x16_bf16 v[80:95], a[244:247], v[128:131], 0
    ds_read_b128 a[236:239], v3 offset:1024
    s_add_u32 s93, s65, 8192
    buffer_load_dwordx4 v[160:163], v0, s[4:7], s93 offen sc1
    s_waitcnt vmcnt(7)
    v_mfma_f32_32x32x16_bf16 v[64:79], a[248:251], v[132:135], v[64:79]
    ds_read_b128 a[240:243], v5 offset:3072
    buffer_load_dwordx4 v[164:167], v0, s[4:7], s93 offen offset:1024 sc1
    s_waitcnt lgkmcnt(3)
    v_mfma_f32_32x32x16_bf16 v[80:95], a[252:255], v[132:135], v[80:95]
    ds_read_b128 a[244:247], v2 offset:3072
    buffer_load_dwordx4 v[168:171], v0, s[4:7], s93 offen offset:2048 sc1
    v_mfma_f32_32x32x16_bf16 v[96:111], a[224:227], v[128:131], 0
    ds_read_b128 a[248:251], v5 offset:4096
    s_waitcnt vmcnt(8)
    v_mfma_f32_32x32x16_bf16 v[64:79], a[228:231], v[136:139], v[64:79]
    ds_read_b128 a[252:255], v2 offset:4096
    buffer_load_dwordx4 v[172:175], v0, s[4:7], s93 offen offset:3072 sc1
    s_waitcnt lgkmcnt(3)
    v_mfma_f32_32x32x16_bf16 v[80:95], a[232:235], v[136:139], v[80:95]
    ds_read_b128 a[224:227], v3 offset:2048
    s_add_u32 s93, s65, 12288
    buffer_load_dwordx4 v[176:179], v0, s[4:7], s93 offen sc1
    buffer_load_dwordx2 v[60:61], v62, s[4:7], s10 offen offset:384 sc1
    v_mfma_f32_32x32x16_bf16 v[96:111], a[236:239], v[132:135], v[96:111]
    ds_read_b128 a[228:231], v5 offset:5120
    s_waitcnt vmcnt(10)
    v_mfma_f32_32x32x16_bf16 v[64:79], a[240:243], v[140:143], v[64:79]
    ds_read_b128 a[232:235], v2 offset:5120
    buffer_load_dwordx4 v[180:183], v0, s[4:7], s93 offen offset:1024 sc1
    s_waitcnt lgkmcnt(3)
    v_mfma_f32_32x32x16_bf16 v[80:95], a[244:247], v[140:143], v[80:95]
    ds_read_b128 a[236:239], v3 offset:3072
    buffer_load_dwordx4 v[184:187], v0, s[4:7], s93 offen offset:2048 sc1
    s_waitcnt vmcnt(11)
    v_mfma_f32_32x32x16_bf16 v[64:79], a[248:251], v[144:147], v[64:79]
    ds_read_b128 a[240:243], v5 offset:6144
    buffer_load_dwordx4 v[188:191], v0, s[4:7], s93 offen offset:3072 sc1
    v_mfma_f32_32x32x16_bf16 v[80:95], a[252:255], v[144:147], v[80:95]
    ds_read_b128 a[244:247], v2 offset:6144
    s_waitcnt lgkmcnt(3)
    v_mfma_f32_32x32x16_bf16 v[96:111], a[224:227], v[136:139], v[96:111]
    ds_read_b128 a[248:251], v5 offset:7168
    s_waitcnt vmcnt(11)
    v_mfma_f32_32x32x16_bf16 v[64:79], a[228:231], v[148:151], v[64:79]
    ds_read_b128 a[252:255], v2 offset:7168
    s_add_u32 s93, s65, 16384
    buffer_load_dwordx4 v[192:195], v0, s[4:7], s93 offen sc1
    v_mfma_f32_32x32x16_bf16 v[80:95], a[232:235], v[148:151], v[80:95]
    ds_read_b128 a[224:227], v3 offset:4096
    s_waitcnt lgkmcnt(3)
    v_mfma_f32_32x32x16_bf16 v[96:111], a[236:239], v[140:143], v[96:111]
    ds_read_b128 a[228:231], v5 offset:8192
    s_waitcnt vmcnt(11)
    v_mfma_f32_32x32x16_bf16 v[64:79], a[240:243], v[152:155], v[64:79]
    ds_read_b128 a[232:235], v2 offset:8192
    buffer_load_dwordx4 v[196:199], v0, s[4:7], s93 offen offset:1024 sc1
    v_mfma_f32_32x32x16_bf16 v[80:95], a[244:247], v[152:155], v[80:95]
    ds_read_b128 a[236:239], v3 offset:5120
    s_waitcnt vmcnt(11) lgkmcnt(3)
    v_mfma_f32_32x32x16_bf16 v[64:79], a[248:251], v[156:159], v[64:79]
    ds_read_b128 a[240:243], v5 offset:9216
    buffer_load_dwordx4 v[200:203], v0, s[4:7], s93 offen offset:2048 sc1
    v_mfma_f32_32x32x16_bf16 v[80:95], a[252:255], v[156:159], v[80:95]
    ds_read_b128 a[244:247], v2 offset:9216
    v_mfma_f32_32x32x16_bf16 v[96:111], a[224:227], v[144:147], v[96:111]
    ds_read_b128 a[248:251], v5 offset:10240
    s_waitcnt vmcnt(11) lgkmcnt(3)
    v_mfma_f32_32x32x16_bf16 v[64:79], a[228:231], v[160:163], v[64:79]
    ds_read_b128 a[252:255], v2 offset:10240
    buffer_load_dwordx4 v[204:207], v0, s[4:7], s93 offen offset:3072 sc1
    v_mfma_f32_32x32x16_bf16 v[80:95], a[232:235], v[160:163], v[80:95]
    ds_read_b128 a[224:227], v3 offset:6144
    v_mfma_f32_32x32x16_bf16 v[96:111], a[236:239], v[148:151], v[96:111]
    ds_read_b128 a[228:231], v5 offset:11264
    s_waitcnt vmcnt(11) lgkmcnt(3)
    v_mfma_f32_32x32x16_bf16 v[64:79], a[240:243], v[164:167], v[64:79]
    ds_read_b128 a[232:235], v2 offset:11264
    s_add_u32 s93, s65, 20480
    buffer_load_dwordx4 v[208:211], v0, s[4:7], s93 offen sc1
    v_mfma_f32_32x32x16_bf16 v[80:95], a[244:247], v[164:167], v[80:95]
    ds_read_b128 a[236:239], v3 offset:7168
    s_waitcnt vmcnt(11)
    v_mfma_f32_32x32x16_bf16 v[64:79], a[248:251], v[168:171], v[64:79]
    ds_read_b128 a[240:243], v5 offset:12288
    buffer_load_dwordx4 v[212:215], v0, s[4:7], s93 offen offset:1024 sc1
    s_waitcnt lgkmcnt(3)
    v_mfma_f32_32x32x16_bf16 v[80:95], a[252:255], v[168:171], v[80:95]
    ds_read_b128 a[244:247], v2 offset:12288
    v_mfma_f32_32x32x16_bf16 v[96:111], a[224:227], v[152:155], v[96:111]
    ds_read_b128 a[248:251], v5 offset:13312
    s_waitcnt vmcnt(11)
    v_mfma_f32_32x32x16_bf16 v[64:79], a[228:231], v[172:175], v[64:79]
    ds_read_b128 a[252:255], v2 offset:13312
    buffer_load_dwordx4 v[216:219], v0, s[4:7], s93 offen offset:2048 sc1
    s_waitcnt lgkmcnt(3)
    v_mfma_f32_32x32x16_bf16 v[80:95], a[232:235], v[172:175], v[80:95]
    ds_read_b128 a[224:227], v3 offset:8192
    v_mfma_f32_32x32x16_bf16 v[96:111], a[236:239], v[156:159], v[96:111]
    ds_read_b128 a[228:231], v5 offset:14336
    s_waitcnt vmcnt(11)
    v_mfma_f32_32x32x16_bf16 v[64:79], a[240:243], v[176:179], v[64:79]
    ds_read_b128 a[232:235], v2 offset:14336
    buffer_load_dwordx4 v[220:223], v0, s[4:7], s93 offen offset:3072 sc1
    s_waitcnt lgkmcnt(3)
    v_mfma_f32_32x32x16_bf16 v[80:95], a[244:247], v[176:179], v[80:95]
    ds_read_b128 a[236:239], v3 offset:9216
    s_waitcnt vmcnt(10)
    v_mfma_f32_32x32x16_bf16 v[64:79], a[248:251], v[180:183], v[64:79]
    ds_read_b128 a[240:243], v5 offset:15360
    v_cmp_ne_u64_e64 vcc, s[28:29], v[60:61]
    s_cbranch_vccnz fstub_34
fback_35:
    buffer_load_dword v24, v1, s[4:7], s66 offen sc1
    buffer_load_dword v25, v1, s[4:7], s66 offen offset:256 sc1
    buffer_load_dword v26, v1, s[4:7], s66 offen offset:512 sc1
    buffer_load_dword v27, v1, s[4:7], s66 offen offset:768 sc1
    v_mfma_f32_32x32x16_bf16 v[80:95], a[252:255], v[180:183], v[80:95]
    ds_read_b128 a[244:247], v2 offset:15360
    s_waitcnt lgkmcnt(3)
    v_mfma_f32_32x32x16_bf16 v[96:111], a[224:227], v[160:163], v[96:111]
    ds_read_b128 a[248:251], v5 offset:16384
    s_waitcnt vmcnt(13)
    v_mfma_f32_32x32x16_bf16 v[64:79], a[228:231], v[184:187], v[64:79]
    ds_read_b128 a[252:255], v2 offset:16384
    buffer_load_dword v28, v1, s[4:7], s66 offen offset:1024 sc1
    buffer_load_dword v29, v1, s[4:7], s66 offen offset:1280 sc1
    buffer_load_dword v30, v1, s[4:7], s66 offen offset:1536 sc1
    buffer_load_dword v31, v1, s[4:7], s66 offen offset:1792 sc1
    v_mfma_f32_32x32x16_bf16 v[80:95], a[232:235], v[184:187], v[80:95]
    ds_read_b128 a[224:227], v3 offset:10240
    s_waitcnt lgkmcnt(3)
    v_mfma_f32_32x32x16_bf16 v[96:111], a[236:239], v[164:167], v[96:111]
    ds_read_b128 a[228:231], v5 offset:17408
    s_waitcnt vmcnt(16)
    v_mfma_f32_32x32x16_bf16 v[64:79], a[240:243], v[188:191], v[64:79]
    ds_read_b128 a[232:235], v2 offset:17408
    s_add_u32 s93, s65, 24576
    buffer_load_dwordx4 v[224:227], v0, s[4:7], s93 offen sc1
    v_mfma_f32_32x32x16_bf16 v[80:95], a[244:247], v[188:191], v[80:95]
    ds_read_b128 a[236:239], v3 offset:11264
    s_waitcnt vmcnt(16) lgkmcnt(3)
    v_mfma_f32_32x32x16_bf16 v[64:79], a[248:251], v[192:195], v[64:79]
    ds_read_b128 a[240:243], v5 offset:18432
    buffer_load_dwordx4 v[228:231], v0, s[4:7], s93 offen offset:1024 sc1
    v_mfma_f32_32x32x16_bf16 v[80:95], a[252:255], v[192:195], v[80:95]
    ds_read_b128 a[244:247], v2 offset:18432
    v_mfma_f32_32x32x16_bf16 v[96:111], a[224:227], v[168:171], v[96:111]
    ds_read_b128 a[248:251], v5 offset:19456
    s_waitcnt vmcnt(16) lgkmcnt(3)
    v_mfma_f32_32x32x16_bf16 v[64:79], a[228:231], v[196:199], v[64:79]
    ds_read_b128 a[252:255], v2 offset:19456
    buffer_load_dwordx4 v[232:235], v0, s[4:7], s93 offen offset:2048 sc1
    v_mfma_f32_32x32x16_bf16 v[80:95], a[232:235], v[196:199], v[80:95]
    ds_read_b128 a[224:227], v3 offset:12288
    v_mfma_f32_32x32x16_bf16 v[96:111], a[236:239], v[172:175], v[96:111]
    ds_read_b128 a[228:231], v5 offset:20480
    s_waitcnt vmcnt(16) lgkmcnt(3)
    v_mfma_f32_32x32x16_bf16 v[64:79], a[240:243], v[200:203], v[64:79]
    ds_read_b128 a[232:235], v2 offset:20480
    buffer_load_dwordx4 v[236:239], v0, s[4:7], s93 offen offset:3072 sc1
    v_mfma_f32_32x32x16_bf16 v[80:95], a[244:247], v[200:203], v[80:95]
    ds_read_b128 a[236:239], v3 offset:13312
    s_waitcnt vmcnt(16)
    v_mfma_f32_32x32x16_bf16 v[64:79], a[248:251], v[204:207], v[64:79]
    ds_read_b128 a[240:243], v5 offset:21504
    s_add_u32 s93, s65, 28672
    buffer_load_dwordx4 v[240:243], v0, s[4:7], s93 offen sc1
    s_waitcnt lgkmcnt(3)
    v_mfma_f32_32x32x16_bf16 v[80:95], a[252:255], v[204:207], v[80:95]
    ds_read_b128 a[244:247], v2 offset:21504
    v_mfma_f32_32x32x16_bf16 v[96:111], a[224:227], v[176:179], v[96:111]
    ds_read_b128 a[248:251], v5 offset:22528
    s_waitcnt vmcnt(16)
    v_mfma_f32_32x32x16_bf16 v[64:79], a[228:231], v[208:211], v[64:79]
    ds_read_b128 a[252:255], v2 offset:22528
    buffer_load_dwordx4 v[244:247], v0, s[4:7], s93 offen offset:1024 sc1
    s_waitcnt lgkmcnt(3)
    v_mfma_f32_32x32x16_bf16 v[80:95], a[232:235], v[208:211], v[80:95]
    ds_read_b128 a[224:227], v3 offset:14336
    v_mfma_f32_32x32x16_bf16 v[96:111], a[236:239], v[180:183], v[96:111]
    ds_read_b128 a[228:231], v5 offset:23552
    s_waitcnt vmcnt(16)
    v_mfma_f32_32x32x16_bf16 v[64:79], a[240:243], v[212:215], v[64:79]
    ds_read_b128 a[232:235], v2 offset:23552
    buffer_load_dwordx4 v[248:251], v0, s[4:7], s93 offen offset:2048 sc1
    s_waitcnt lgkmcnt(3)
    v_mfma_f32_32x32x16_bf16 v[80:95], a[244:247], v[212:215], v[80:95]
    ds_read_b128 a[236:239], v3 offset:15360
    s_waitcnt vmcnt(16)
    v_mfma_f32_32x32x16_bf16 v[64:79], a[248:251], v[216:219], v[64:79]
    ds_read_b128 a[240:243], v5 offset:24576
    buffer_load_dwordx4 v[252:255], v0, s[4:7], s93 offen offset:3072 sc1
    v_mfma_f32_32x32x16_bf16 v[80:95], a[252:255], v[216:219], v[80:95]
    ds_read_b128 a[244:247], v2 offset:24576
    s_waitcnt lgkmcnt(3)
    v_mfma_f32_32x32x16_bf16 v[96:111], a[224:227], v[184:187], v[96:111]
    ds_read_b128 a[248:251], v5 offset:25600
    s_waitcnt vmcnt(16)
    v_mfma_f32_32x32x16_bf16 v[64:79], a[228:231], v[220:223], v[64:79]
    ds_read_b128 a[252:255], v2 offset:25600
    s_add_u32 m0, s11, 67584
    s_add_u32 s37, s34, 202752
    buffer_load_dwordx4 v0, s[4:7], s37 offen lds
    v_mfma_f32_32x32x16_bf16 v[80:95], a[232:235], v[220:223], v[80:95]
    ds_read_b128 a[224:227], v3 offset:16384
    s_waitcnt lgkmcnt(3)
    v_mfma_f32_32x32x16_bf16 v[96:111], a[236:239], v[188:191], v[96:111]
    ds_read_b128 a[228:231], v5 offset:26624
    s_waitcnt vmcnt(8)
    v_mfma_f32_32x32x16_bf16 v[64:79], a[240:243], v[224:227], v[64:79]
    ds_read_b128 a[232:235], v2 offset:26624
    buffer_load_dwordx4 v0, s[4:7], s37 offen offset:1024 lds
    v_mfma_f32_32x32x16_bf16 v[80:95], a[244:247], v[224:227], v[80:95]
    ds_read_b128 a[236:239], v3 offset:17408
    buffer_load_dwordx4 v0, s[4:7], s37 offen offset:2048 lds
    v_add_f32 v24, v24, v25
    v_add_f32 v26, v26, v27
    v_add_f32 v28, v28, v29
    s_waitcnt vmcnt(9) lgkmcnt(3)
    v_mfma_f32_32x32x16_bf16 v[64:79], a[248:251], v[228:231], v[64:79]
    ds_read_b128 a[240:243], v5 offset:27648
    buffer_load_dwordx4 v0, s[4:7], s37 offen offset:3072 lds
    v_add_f32 v30, v30, v31
    v_add_f32 v24, v24, v26
    v_add_f32 v28, v28, v30
    v_add_f32 v24, v24, v28
    v_mfma_f32_32x32x16_bf16 v[80:95], a[252:255], v[228:231], v[80:95]
    ds_read_b128 a[244:247], v2 offset:27648
    s_add_u32 m0, s11, 83968
    s_add_u32 s37, s34, 219136
    buffer_load_dwordx4 v0, s[4:7], s37 offen lds
    v_mul_f32 v24, 0x3b000000, v24
    v_mov_b32_e64 v25, v24
    v_mfma_f32_32x32x16_bf16 v[96:111], a[224:227], v[192:195], v[96:111]
    ds_read_b128 a[248:251], v5 offset:28672
    v_permlane32_swap_b32_e64 v24, v25
    v_fma_f32 v25, -v24, v24, v25
    v_max_f32 v25, 0, v25
    s_waitcnt vmcnt(10) lgkmcnt(3)
    v_mfma_f32_32x32x16_bf16 v[64:79], a[228:231], v[232:235], v[64:79]
    ds_read_b128 a[252:255], v2 offset:28672
    buffer_load_dwordx4 v0, s[4:7], s37 offen offset:1024 lds
    v_add_f32 v46, 0x3727c5ac, v25
    v_rsq_f32_e64 v47, v46
    v_cvt_pk_bf16_f32 v40, -v24, -v24
    v_mfma_f32_32x32x16_bf16 v[80:95], a[232:235], v[232:235], v[80:95]
    ds_read_b128 a[224:227], v3 offset:18432
    v_mov_b32 v41, v40
    v_mov_b32 v42, v40
    v_mov_b32_e64 v43, v40
    v_mul_f32 v44, 0xc0135761, v47
    v_mul_f32_e64 v45, v47, v47
    v_mfma_f32_32x32x16_bf16 v[96:111], a[236:239], v[196:199], v[96:111]
    ds_read_b128 a[228:231], v5 offset:29696
    v_mul_f32 v45, 0x3d372713, v45
    v_mul_f32 v45, v45, v44
    s_waitcnt vmcnt(10) lgkmcnt(3)
    v_mfma_f32_32x32x16_bf16 v[64:79], a[240:243], v[236:239], v[64:79]
    ds_read_b128 a[232:235], v2 offset:29696
    buffer_load_dwordx4 v0, s[4:7], s37 offen offset:2048 lds
    v_mfma_f32_32x32x16_bf16 v[80:95], a[244:247], v[236:239], v[80:95]
    ds_read_b128 a[236:239], v3 offset:19456
    s_waitcnt vmcnt(10)
    v_mfma_f32_32x32x16_bf16 v[64:79], a[248:251], v[240:243], v[64:79]
    ds_read_b128 a[240:243], v5 offset:30720
    buffer_load_dwordx4 v0, s[4:7], s37 offen offset:3072 lds
    s_waitcnt lgkmcnt(3)
    v_mfma_f32_32x32x16_bf16 v[80:95], a[252:255], v[240:243], v[80:95]
    ds_read_b128 a[244:247], v2 offset:30720
    v_mfma_f32_32x32x16_bf16 v[96:111], a[224:227], v[200:203], v[96:111]
    ds_read_b128 a[248:251], v5 offset:31744
    s_waitcnt vmcnt(10)
    v_mfma_f32_32x32x16_bf16 v[64:79], a[228:231], v[244:247], v[64:79]
    ds_read_b128 a[252:255], v2 offset:31744
    s_add_u32 m0, s35, 67584
    s_add_u32 s37, s36, 202752
    buffer_load_dword v63, s[4:7], s37 offen lds
    s_waitcnt lgkmcnt(3)
    v_mfma_f32_32x32x16_bf16 v[80:95], a[232:235], v[244:247], v[80:95]
    ds_read_b128 a[224:227], v3 offset:20480
    v_mfma_f32_32x32x16_bf16 v[96:111], a[236:239], v[204:207], v[96:111]
    ds_read_b128 a[228:231], v5 offset:32768
    s_waitcnt vmcnt(10)
    v_mfma_f32_32x32x16_bf16 v[64:79], a[240:243], v[248:251], v[64:79]
    ds_read_b128 a[232:235], v2 offset:32768
    s_waitcnt lgkmcnt(3)
    v_mfma_f32_32x32x16_bf16 v[80:95], a[244:247], v[248:251], v[80:95]
    s_waitcnt vmcnt(9)
    v_mfma_f32_32x32x16_bf16 v[64:79], a[248:251], v[252:255], v[64:79]
    s_waitcnt lgkmcnt(0)
    s_barrier
    ds_read_b128 a[236:239], v3 offset:21504
    ds_read_b128 a[240:243], v3 offset:22528
    v_mfma_f32_32x32x16_bf16 v[80:95], a[252:255], v[252:255], v[80:95]
    ds_read_b128 a[244:247], v3 offset:23552
    v_mfma_f32_32x32x16_bf16 v[96:111], a[224:227], v[208:211], v[96:111]
    ds_read_b128 a[248:251], v3 offset:24576
    v_mfma_f32_32x32x16_bf16 v[64:79], a[228:231], v[40:43], v[64:79]
    ds_read_b128 a[252:255], v3 offset:25600
    s_add_u32 m0, s11, 101376
    s_add_u32 s37, s34, 236544
    buffer_load_dwordx4 v0, s[4:7], s37 offen lds
    v_mfma_f32_32x32x16_bf16 v[80:95], a[232:235], v[40:43], v[80:95]
    ds_read_b128 a[224:227], v3 offset:26624
    s_waitcnt lgkmcnt(3)
    v_mfma_f32_32x32x16_bf16 v[96:111], a[236:239], v[212:215], v[96:111]
    ds_read_b128 a[228:231], v3 offset:27648
    buffer_load_dwordx4 v0, s[4:7], s37 offen offset:1024 lds
    v_mfma_f32_32x32x16_bf16 v[96:111], a[240:243], v[216:219], v[96:111]
    ds_read_b128 a[232:235], v3 offset:28672
    v_mul_f32 v48, v64, v64
    v_mul_f32 v49, v65, v65
    v_mul_f32 v50, v66, v66
    v_mul_f32 v51, v67, v67
    v_mul_f32_e64 v52, v68, v68
    v_mfma_f32_32x32x16_bf16 v[96:111], a[244:247], v[220:223], v[96:111]
    ds_read_b128 a[236:239], v3 offset:29696
    buffer_load_dwordx4 v0, s[4:7], s37 offen offset:2048 lds
    v_mul_f32 v53, v69, v69
    v_mul_f32 v54, v70, v70
    v_mul_f32 v55, v71, v71
    s_waitcnt lgkmcnt(3)
    v_mfma_f32_32x32x16_bf16 v[96:111], a[248:251], v[224:227], v[96:111]
    ds_read_b128 a[240:243], v3 offset:30720
    v_fma_f32 v48, v48, v45, v44
    v_fma_f32 v49, v49, v45, v44
    v_fma_f32 v50, v50, v45, v44
    v_fma_f32 v51, v51, v45, v44
    v_fma_f32 v52, v52, v45, v44
    v_mfma_f32_32x32x16_bf16 v[96:111], a[252:255], v[228:231], v[96:111]
    ds_read_b128 a[244:247], v3 offset:31744
    buffer_load_dwordx4 v0, s[4:7], s37 offen offset:3072 lds
    v_fma_f32 v53, v53, v45, v44
    v_fma_f32 v54, v54, v45, v44
    v_fma_f32 v55, v55, v45, v44
    v_mul_f32_e64 v48, v48, v64
    v_mfma_f32_32x32x16_bf16 v[96:111], a[224:227], v[232:235], v[96:111]
    ds_read_b128 a[248:251], v3 offset:32768
    v_mul_f32 v49, v49, v65
    v_mul_f32 v50, v50, v66
    v_mul_f32 v51, v51, v67
    v_mul_f32_e64 v52, v52, v68
    s_waitcnt lgkmcnt(3)
    v_mfma_f32_32x32x16_bf16 v[96:111], a[228:231], v[236:239], v[96:111]
    s_add_u32 m0, s11, 117760
    s_add_u32 s37, s34, 252928
    buffer_load_dwordx4 v0, s[4:7], s37 offen lds
    v_mul_f32 v53, v53, v69
    v_mul_f32 v54, v54, v70
    v_mul_f32_e64 v55, v55, v71
    v_mfma_f32_32x32x16_bf16 v[96:111], a[232:235], v[240:243], v[96:111]
    s_waitcnt lgkmcnt(0)
    s_waitcnt vmcnt(5)
    s_barrier
    ds_read_b128 a[252:255], v4 offset:0
    ds_read_b128 a[224:227], v4 offset:1024
    v_mfma_f32_32x32x16_bf16 v[96:111], a[236:239], v[244:247], v[96:111]
    ds_read_b128 a[228:231], v4 offset:2048
    buffer_load_dwordx4 v0, s[4:7], s37 offen offset:1024 lds
    v_exp_f32 v48, v48
    v_mul_f32_e64 v72, v64, v72
    v_mfma_f32_32x32x16_bf16 v[96:111], a[240:243], v[248:251], v[96:111]
    ds_read_b128 a[232:235], v4 offset:3072
    v_exp_f32 v49, v49
    v_mul_f32 v73, v65, v73
    v_exp_f32_e64 v50, v50
    v_mfma_f32_32x32x16_bf16 v[96:111], a[244:247], v[252:255], v[96:111]
    ds_read_b128 a[236:239], v4 offset:4096
    buffer_load_dwordx4 v0, s[4:7], s37 offen offset:2048 lds
    v_mul_f32 v74, v66, v74
    v_exp_f32 v51, v51
    v_mul_f32_e64 v75, v67, v75
    v_mfma_f32_32x32x16_bf16 v[96:111], a[248:251], v[40:43], v[96:111]
    ds_read_b128 a[240:243], v4 offset:5120
    v_exp_f32 v52, v52
    v_mul_f32_e64 v76, v68, v76
    s_waitcnt lgkmcnt(3)
    v_mfma_f32_32x32x16_bf16 v[112:127], a[252:255], v[128:131], 0
    ds_read_b128 a[244:247], v4 offset:6144
    buffer_load_dwordx4 v0, s[4:7], s37 offen offset:3072 lds
    v_exp_f32 v53, v53
    v_mul_f32 v77, v69, v77
    v_mfma_f32_32x32x16_bf16 v[112:127], a[224:227], v[132:135], v[112:127]
    ds_read_b128 a[248:251], v4 offset:7168
    v_exp_f32 v54, v54
    v_mul_f32 v78, v70, v78
    v_exp_f32_e64 v55, v55
    v_mfma_f32_32x32x16_bf16 v[112:127], a[228:231], v[136:139], v[112:127]
    ds_read_b128 a[252:255], v4 offset:8192
    s_add_u32 m0, s35, 101376
    s_add_u32 s37, s36, 236544
    buffer_load_dword v63, s[4:7], s37 offen lds
    v_mul_f32 v79, v71, v79
    s_waitcnt lgkmcnt(3)
    v_mfma_f32_32x32x16_bf16 v[112:127], a[232:235], v[140:143], v[112:127]
    ds_read_b128 a[224:227], v4 offset:9216
    v_fma_f32 v48, v48, v46, v46
    v_fma_f32 v49, v49, v46, v46
    v_fma_f32 v50, v50, v46, v46
    v_fma_f32 v51, v51, v46, v46
    v_fma_f32 v52, v52, v46, v46
    v_mfma_f32_32x32x16_bf16 v[112:127], a[236:239], v[144:147], v[112:127]
    ds_read_b128 a[228:231], v4 offset:10240
    s_add_u32 m0, s11, 0
    s_add_u32 s37, s34, 270336
    buffer_load_dwordx4 v0, s[4:7], s37 offen lds
    v_fma_f32 v53, v53, v46, v46
    v_fma_f32 v54, v54, v46, v46
    v_mfma_f32_32x32x16_bf16 v[112:127], a[240:243], v[148:151], v[112:127]
    ds_read_b128 a[232:235], v4 offset:11264
    v_fma_f32 v55, v55, v46, v46
    v_rcp_f32_e64 v48, v48
    s_waitcnt lgkmcnt(3)
    v_mfma_f32_32x32x16_bf16 v[112:127], a[244:247], v[152:155], v[112:127]
    ds_read_b128 a[236:239], v4 offset:12288
    buffer_load_dwordx4 v0, s[4:7], s37 offen offset:1024 lds
    v_rcp_f32 v49, v49
    v_mul_f32 v72, v72, v48
    v_mfma_f32_32x32x16_bf16 v[112:127], a[248:251], v[156:159], v[112:127]
    ds_read_b128 a[240:243], v4 offset:13312
    v_rcp_f32 v50, v50
    v_mul_f32 v73, v73, v49
    v_rcp_f32_e64 v51, v51
    v_mfma_f32_32x32x16_bf16 v[112:127], a[252:255], v[160:163], v[112:127]
    ds_read_b128 a[244:247], v4 offset:14336
    buffer_load_dwordx4 v0, s[4:7], s37 offen offset:2048 lds
    v_mul_f32 v74, v74, v50
    v_rcp_f32_e64 v52, v52
    s_waitcnt lgkmcnt(3)
    v_mfma_f32_32x32x16_bf16 v[112:127], a[224:227], v[164:167], v[112:127]
    ds_read_b128 a[248:251], v4 offset:15360
    v_mul_f32 v75, v75, v51
    v_rcp_f32 v53, v53
    v_mul_f32_e64 v76, v76, v52
    v_mfma_f32_32x32x16_bf16 v[112:127], a[228:231], v[168:171], v[112:127]
    ds_read_b128 a[252:255], v4 offset:16384
    buffer_load_dwordx4 v0, s[4:7], s37 offen offset:3072 lds
    v_rcp_f32 v54, v54
    v_mul_f32 v77, v77, v53
    v_mfma_f32_32x32x16_bf16 v[112:127], a[232:235], v[172:175], v[112:127]
    ds_read_b128 a[224:227], v4 offset:17408
    v_rcp_f32 v55, v55
    v_mul_f32 v78, v78, v54
    v_cvt_pk_bf16_f32 v56, v72, v73
    s_waitcnt lgkmcnt(3)
    v_mfma_f32_32x32x16_bf16 v[112:127], a[236:239], v[176:179], v[112:127]
    ds_read_b128 a[228:231], v4 offset:18432
    s_add_u32 m0, s11, 16384
    s_add_u32 s37, s34, 286720
    buffer_load_dwordx4 v0, s[4:7], s37 offen lds
    v_mul_f32 v79, v79, v55
    v_cvt_pk_bf16_f32 v57, v74, v75
    v_mfma_f32_32x32x16_bf16 v[112:127], a[240:243], v[180:183], v[112:127]
    ds_read_b128 a[232:235], v4 offset:19456
    v_cvt_pk_bf16_f32 v58, v76, v77
    v_cvt_pk_bf16_f32 v59, v78, v79
    s_add_u32 s94, s73, 4096
    buffer_store_dwordx4 v[56:59], v0, s[4:7], s73 offen sc1
    v_mul_f32_e64 v48, v80, v80
    v_mfma_f32_32x32x16_bf16 v[112:127], a[244:247], v[184:187], v[112:127]
    ds_read_b128 a[236:239], v4 offset:20480
    buffer_load_dwordx4 v0, s[4:7], s37 offen offset:1024 lds
    v_mul_f32 v49, v81, v81
    v_mul_f32 v50, v82, v82
    v_mul_f32 v51, v83, v83
    s_waitcnt lgkmcnt(3)
    v_mfma_f32_32x32x16_bf16 v[112:127], a[248:251], v[188:191], v[112:127]
    ds_read_b128 a[240:243], v4 offset:21504
    v_mul_f32 v52, v84, v84
    v_mul_f32 v53, v85, v85
    v_mul_f32 v54, v86, v86
    v_mul_f32 v55, v87, v87
    v_fma_f32 v48, v48, v45, v44
    v_mfma_f32_32x32x16_bf16 v[112:127], a[252:255], v[192:195], v[112:127]
    ds_read_b128 a[244:247], v4 offset:22528
    buffer_load_dwordx4 v0, s[4:7], s37 offen offset:2048 lds
    v_fma_f32 v49, v49, v45, v44
    v_fma_f32 v50, v50, v45, v44
    v_fma_f32 v51, v51, v45, v44
    v_fma_f32 v52, v52, v45, v44
    v_mfma_f32_32x32x16_bf16 v[112:127], a[224:227], v[196:199], v[112:127]
    ds_read_b128 a[248:251], v4 offset:23552
    v_fma_f32 v53, v53, v45, v44
    v_fma_f32 v54, v54, v45, v44
    v_fma_f32 v55, v55, v45, v44
    v_mul_f32 v48, v48, v80
    s_waitcnt lgkmcnt(3)
    v_mfma_f32_32x32x16_bf16 v[112:127], a[228:231], v[200:203], v[112:127]
    ds_read_b128 a[252:255], v4 offset:24576
    buffer_load_dwordx4 v0, s[4:7], s37 offen offset:3072 lds
    v_mul_f32 v49, v49, v81
    v_mul_f32 v50, v50, v82
    v_mul_f32 v51, v51, v83
    v_mul_f32 v52, v52, v84
    v_mfma_f32_32x32x16_bf16 v[112:127], a[232:235], v[204:207], v[112:127]
    ds_read_b128 a[224:227], v4 offset:25600
    v_mul_f32 v53, v53, v85
    v_mul_f32 v54, v54, v86
    v_mul_f32 v55, v55, v87
    v_exp_f32 v48, v48
    v_mfma_f32_32x32x16_bf16 v[112:127], a[236:239], v[208:211], v[112:127]
    ds_read_b128 a[228:231], v4 offset:26624
    s_add_u32 m0, s35, 0
    s_add_u32 s37, s36, 270336
    buffer_load_dword v63, s[4:7], s37 offen lds
    v_mul_f32_e64 v88, v80, v88
    s_waitcnt lgkmcnt(3)
    v_mfma_f32_32x32x16_bf16 v[112:127], a[240:243], v[212:215], v[112:127]
    ds_read_b128 a[232:235], v4 offset:27648
    v_exp_f32 v49, v49
    v_mul_f32 v89, v81, v89
    v_exp_f32_e64 v50, v50
    v_mfma_f32_32x32x16_bf16 v[112:127], a[244:247], v[216:219], v[112:127]
    ds_read_b128 a[236:239], v4 offset:28672
    s_add_u32 m0, s11, 33792
    s_add_u32 s37, s34, 304128
    buffer_load_dwordx4 v0, s[4:7], s37 offen lds
    v_mul_f32_e64 v90, v82, v90
    v_mfma_f32_32x32x16_bf16 v[112:127], a[248:251], v[220:223], v[112:127]
    ds_read_b128 a[240:243], v4 offset:29696
    v_exp_f32 v51, v51
    v_mul_f32_e64 v91, v83, v91
    s_waitcnt lgkmcnt(3)
    v_mfma_f32_32x32x16_bf16 v[112:127], a[252:255], v[224:227], v[112:127]
    ds_read_b128 a[244:247], v4 offset:30720
    buffer_load_dwordx4 v0, s[4:7], s37 offen offset:1024 lds
    v_exp_f32 v52, v52
    v_mul_f32 v92, v84, v92
    v_mfma_f32_32x32x16_bf16 v[112:127], a[224:227], v[228:231], v[112:127]
    ds_read_b128 a[248:251], v4 offset:31744
    v_exp_f32 v53, v53
    v_mul_f32 v93, v85, v93
    v_exp_f32_e64 v54, v54
    v_mfma_f32_32x32x16_bf16 v[112:127], a[228:231], v[232:235], v[112:127]
    ds_read_b128 a[252:255], v4 offset:32768
    buffer_load_dwordx4 v0, s[4:7], s37 offen offset:2048 lds
    v_mul_f32 v94, v86, v94
    v_exp_f32_e64 v55, v55
    s_waitcnt lgkmcnt(3)
    v_mfma_f32_32x32x16_bf16 v[112:127], a[232:235], v[236:239], v[112:127]
    v_mul_f32_e64 v95, v87, v95
    v_fma_f32 v48, v48, v46, v46
    v_fma_f32 v49, v49, v46, v46
    v_fma_f32 v50, v50, v46, v46
    v_fma_f32 v51, v51, v46, v46
    v_fma_f32 v52, v52, v46, v46
    v_mfma_f32_32x32x16_bf16 v[112:127], a[236:239], v[240:243], v[112:127]
    s_waitcnt lgkmcnt(0)
    s_waitcnt vmcnt(13)
    s_barrier
    ds_read_b128 a[224:227], v5 offset:0
    ds_read_b128 a[228:231], v5 offset:1024
    buffer_load_dwordx4 v0, s[4:7], s37 offen offset:3072 lds
    v_mfma_f32_32x32x16_bf16 v[112:127], a[240:243], v[244:247], v[112:127]
    ds_read_b128 a[232:235], v5 offset:2048
    v_fma_f32 v53, v53, v46, v46
    v_fma_f32 v54, v54, v46, v46
    v_fma_f32 v55, v55, v46, v46
    v_rcp_f32 v48, v48
    v_mfma_f32_32x32x16_bf16 v[112:127], a[244:247], v[248:251], v[112:127]
    ds_read_b128 a[236:239], v5 offset:3072
    s_add_u32 m0, s11, 50176
    s_add_u32 s37, s34, 320512
    buffer_load_dwordx4 v0, s[4:7], s37 offen lds
    v_rcp_f32_e64 v49, v49
    v_mfma_f32_32x32x16_bf16 v[112:127], a[248:251], v[252:255], v[112:127]
    ds_read_b128 a[240:243], v5 offset:4096
    v_mul_f32 v88, v88, v48
    v_rcp_f32 v50, v50
    v_mul_f32_e64 v89, v89, v49
    v_mfma_f32_32x32x16_bf16 v[112:127], a[252:255], v[40:43], v[112:127]
    ds_read_b128 a[244:247], v5 offset:5120
    buffer_load_dwordx4 v0, s[4:7], s37 offen offset:1024 lds
    v_rcp_f32 v51, v51
    v_mul_f32_e64 v90, v90, v50
    s_waitcnt lgkmcnt(3)
    v_mfma_f32_32x32x16_bf16 v[64:79], a[224:227], v[128:131], 0
    ds_read_b128 a[248:251], v5 offset:6144
    v_rcp_f32 v52, v52
    v_mul_f32 v91, v91, v51
    v_rcp_f32_e64 v53, v53
    v_mfma_f32_32x32x16_bf16 v[64:79], a[228:231], v[132:135], v[64:79]
    ds_read_b128 a[252:255], v5 offset:7168
    buffer_load_dwordx4 v0, s[4:7], s37 offen offset:2048 lds
    v_mul_f32 v92, v92, v52
    v_rcp_f32 v54, v54
    v_mul_f32_e64 v93, v93, v53
    v_mfma_f32_32x32x16_bf16 v[64:79], a[232:235], v[136:139], v[64:79]
    ds_read_b128 a[224:227], v5 offset:8192
    v_rcp_f32 v55, v55
    v_mul_f32 v94, v94, v54
    v_cvt_pk_bf16_f32 v56, v88, v89
    s_waitcnt lgkmcnt(3)
    v_mfma_f32_32x32x16_bf16 v[64:79], a[236:239], v[140:143], v[64:79]
    ds_read_b128 a[228:231], v5 offset:9216
    buffer_load_dwordx4 v0, s[4:7], s37 offen offset:3072 lds
    v_mul_f32 v95, v95, v55
    v_cvt_pk_bf16_f32 v57, v90, v91
    v_cvt_pk_bf16_f32 v58, v92, v93
    v_cvt_pk_bf16_f32 v59, v94, v95
    v_mfma_f32_32x32x16_bf16 v[64:79], a[240:243], v[144:147], v[64:79]
    ds_read_b128 a[232:235], v5 offset:10240
    buffer_store_dwordx4 v[56:59], v0, s[4:7], s73 offen offset:1024 sc1
    v_mul_f32 v48, v96, v96
    v_mul_f32 v49, v97, v97
    v_mul_f32 v50, v98, v98
    v_mul_f32 v51, v99, v99
    v_mfma_f32_32x32x16_bf16 v[64:79], a[244:247], v[148:151], v[64:79]
    ds_read_b128 a[236:239], v5 offset:11264
    s_add_u32 m0, s35, 33792
    s_add_u32 s37, s36, 304128
    buffer_load_dword v63, s[4:7], s37 offen lds
    v_mul_f32 v52, v100, v100
    s_waitcnt lgkmcnt(3)
    v_mfma_f32_32x32x16_bf16 v[64:79], a[248:251], v[152:155], v[64:79]
    ds_read_b128 a[240:243], v5 offset:12288
    v_mul_f32 v53, v101, v101
    v_mul_f32 v54, v102, v102
    v_mul_f32_e64 v55, v103, v103
    v_fma_f32 v48, v48, v45, v44
    v_fma_f32 v49, v49, v45, v44
    v_mfma_f32_32x32x16_bf16 v[64:79], a[252:255], v[156:159], v[64:79]
    ds_read_b128 a[244:247], v5 offset:13312
    s_add_u32 s38, s95, 0
    s_and_b32 s38, s38, 3
    s_mul_i32 s38, s38, 7168
    s_add_u32 s38, s38, s83
    buffer_load_dwordx4 a[0:3], v13, s[4:7], s38 offen
    v_mfma_f32_32x32x16_bf16 v[64:79], a[224:227], v[160:163], v[64:79]
    ds_read_b128 a[248:251], v5 offset:14336
    v_fma_f32 v50, v50, v45, v44
    v_fma_f32 v51, v51, v45, v44
    v_fma_f32 v52, v52, v45, v44
    v_fma_f32 v53, v53, v45, v44
    s_waitcnt lgkmcnt(3)
    v_mfma_f32_32x32x16_bf16 v[64:79], a[228:231], v[164:167], v[64:79]
    ds_read_b128 a[252:255], v5 offset:15360
    buffer_load_dwordx4 a[4:7], v13, s[4:7], s38 offen offset:1024
    v_fma_f32 v54, v54, v45, v44
    v_fma_f32 v55, v55, v45, v44
    v_mul_f32 v48, v48, v96
    v_mul_f32 v49, v49, v97
    v_mfma_f32_32x32x16_bf16 v[64:79], a[232:235], v[168:171], v[64:79]
    ds_read_b128 a[224:227], v5 offset:16384
    v_mul_f32 v50, v50, v98
    v_mul_f32 v51, v51, v99
    v_mul_f32 v52, v52, v100
    v_mul_f32 v53, v53, v101
    v_mul_f32_e64 v54, v54, v102
    v_mfma_f32_32x32x16_bf16 v[64:79], a[236:239], v[172:175], v[64:79]
    ds_read_b128 a[228:231], v5 offset:17408
    buffer_load_dwordx4 a[8:11], v13, s[4:7], s38 offen offset:2048
    v_mul_f32 v55, v55, v103
    v_exp_f32_e64 v48, v48
    s_waitcnt lgkmcnt(3)
    v_mfma_f32_32x32x16_bf16 v[64:79], a[240:243], v[176:179], v[64:79]
    ds_read_b128 a[232:235], v5 offset:18432
    v_mul_f32 v104, v96, v104
    v_exp_f32 v49, v49
    v_mul_f32_e64 v105, v97, v105
    v_mfma_f32_32x32x16_bf16 v[64:79], a[244:247], v[180:183], v[64:79]
    ds_read_b128 a[236:239], v5 offset:19456
    buffer_load_dwordx4 a[12:15], v13, s[4:7], s38 offen offset:3072
    v_exp_f32 v50, v50
    v_mul_f32 v106, v98, v106
    v_mfma_f32_32x32x16_bf16 v[64:79], a[248:251], v[184:187], v[64:79]
    ds_read_b128 a[240:243], v5 offset:20480
    v_exp_f32 v51, v51
    v_mul_f32_e64 v107, v99, v107
    s_waitcnt lgkmcnt(3)
    v_mfma_f32_32x32x16_bf16 v[64:79], a[252:255], v[188:191], v[64:79]
    ds_read_b128 a[244:247], v5 offset:21504
    s_add_u32 s38, s38, 4096
    buffer_load_dwordx4 a[16:19], v13, s[4:7], s38 offen
    v_exp_f32 v52, v52
    v_mul_f32 v108, v100, v108
    v_mfma_f32_32x32x16_bf16 v[64:79], a[224:227], v[192:195], v[64:79]
    ds_read_b128 a[248:251], v5 offset:22528
    v_exp_f32 v53, v53
    v_mul_f32 v109, v101, v109
    v_exp_f32_e64 v54, v54
    v_mfma_f32_32x32x16_bf16 v[64:79], a[228:231], v[196:199], v[64:79]
    ds_read_b128 a[252:255], v5 offset:23552
    buffer_load_dwordx4 a[20:23], v13, s[4:7], s38 offen offset:1024
    v_mul_f32 v110, v102, v110
    v_exp_f32_e64 v55, v55
    s_waitcnt lgkmcnt(3)
    v_mfma_f32_32x32x16_bf16 v[64:79], a[232:235], v[200:203], v[64:79]
    ds_read_b128 a[224:227], v5 offset:24576
    v_mul_f32_e64 v111, v103, v111
    v_fma_f32 v48, v48, v46, v46
    v_fma_f32 v49, v49, v46, v46
    v_fma_f32 v50, v50, v46, v46
    v_fma_f32 v51, v51, v46, v46
    v_mfma_f32_32x32x16_bf16 v[64:79], a[236:239], v[204:207], v[64:79]
    ds_read_b128 a[228:231], v5 offset:25600
    buffer_load_dwordx4 a[24:27], v13, s[4:7], s38 offen offset:2048
    v_fma_f32 v52, v52, v46, v46
    v_fma_f32 v53, v53, v46, v46
    v_fma_f32 v54, v54, v46, v46
    v_fma_f32 v55, v55, v46, v46
    v_mfma_f32_32x32x16_bf16 v[64:79], a[240:243], v[208:211], v[64:79]
    ds_read_b128 a[232:235], v5 offset:26624
    v_rcp_f32 v48, v48
    v_rcp_f32_e64 v49, v49
    s_waitcnt lgkmcnt(3)
    v_mfma_f32_32x32x16_bf16 v[64:79], a[244:247], v[212:215], v[64:79]
    ds_read_b128 a[236:239], v5 offset:27648
    s_add_u32 s38, s95, 1
    s_and_b32 s38, s38, 3
    s_mul_i32 s38, s38, 7168
    s_add_u32 s38, s38, s83
    buffer_load_dwordx4 a[28:31], v13, s[4:7], s38 offen
    v_mfma_f32_32x32x16_bf16 v[64:79], a[248:251], v[216:219], v[64:79]
    ds_read_b128 a[240:243], v5 offset:28672
    v_mul_f32 v104, v104, v48
    v_rcp_f32 v50, v50
    v_mul_f32 v105, v105, v49
    v_mfma_f32_32x32x16_bf16 v[64:79], a[252:255], v[220:223], v[64:79]
    ds_read_b128 a[244:247], v5 offset:29696
    buffer_load_dwordx4 a[32:35], v13, s[4:7], s38 offen offset:1024
    v_rcp_f32 v51, v51
    v_mul_f32_e64 v106, v106, v50
    s_waitcnt lgkmcnt(3)
    v_mfma_f32_32x32x16_bf16 v[64:79], a[224:227], v[224:227], v[64:79]
    ds_read_b128 a[248:251], v5 offset:30720
    v_rcp_f32 v52, v52
    v_mul_f32 v107, v107, v51
    v_rcp_f32 v53, v53
    v_mul_f32 v108, v108, v52
    v_rcp_f32 v54, v54
    v_mul_f32 v109, v109, v53
    v_rcp_f32 v55, v55
    v_mul_f32 v110, v110, v54
    v_cvt_pk_bf16_f32 v56, v104, v105
    v_mul_f32_e64 v111, v111, v55
    v_cvt_pk_bf16_f32 v57, v106, v107
    v_cvt_pk_bf16_f32 v58, v108, v109
    v_cvt_pk_bf16_f32 v59, v110, v111
    buffer_store_dwordx4 v[56:59], v0, s[4:7], s73 offen offset:2048 sc1
    v_mfma_f32_32x32x16_bf16 v[64:79], a[228:231], v[228:231], v[64:79]
    ds_read_b128 a[252:255], v5 offset:31744
    buffer_load_dwordx4 a[36:39], v13, s[4:7], s38 offen offset:2048
    v_mul_f32 v48, v112, v112
    v_mul_f32 v49, v113, v113
    v_mul_f32 v50, v114, v114
    v_mul_f32 v51, v115, v115
    v_mfma_f32_32x32x16_bf16 v[64:79], a[232:235], v[232:235], v[64:79]
    ds_read_b128 a[224:227], v5 offset:32768
    v_mul_f32 v52, v116, v116
    v_mul_f32 v53, v117, v117
    v_mul_f32 v54, v118, v118
    v_mul_f32_e64 v55, v119, v119
    s_waitcnt lgkmcnt(3)
    v_mfma_f32_32x32x16_bf16 v[64:79], a[236:239], v[236:239], v[64:79]
    buffer_load_dwordx4 a[40:43], v13, s[4:7], s38 offen offset:3072
    v_fma_f32 v48, v48, v45, v44
    v_fma_f32 v49, v49, v45, v44
    v_fma_f32 v50, v50, v45, v44
    v_fma_f32 v51, v51, v45, v44
    v_fma_f32 v52, v52, v45, v44
    v_mfma_f32_32x32x16_bf16 v[64:79], a[240:243], v[240:243], v[64:79]
    s_waitcnt lgkmcnt(0)
    s_waitcnt vmcnt(22)
    s_barrier
    ds_read_b128 a[228:231], v2 offset:0
    ds_read_b128 a[232:235], v2 offset:1024
    v_fma_f32 v53, v53, v45, v44
    v_mfma_f32_32x32x16_bf16 v[64:79], a[244:247], v[244:247], v[64:79]
    ds_read_b128 a[236:239], v2 offset:2048
    s_add_u32 s38, s38, 4096
    buffer_load_dwordx4 a[44:47], v13, s[4:7], s38 offen
    v_fma_f32 v54, v54, v45, v44
    v_fma_f32 v55, v55, v45, v44
    v_mul_f32 v48, v48, v112
    v_mfma_f32_32x32x16_bf16 v[64:79], a[248:251], v[248:251], v[64:79]
    ds_read_b128 a[240:243], v2 offset:3072
    v_mul_f32 v49, v49, v113
    v_mul_f32 v50, v50, v114
    v_mul_f32 v51, v51, v115
    v_mul_f32 v52, v52, v116
    v_mul_f32_e64 v53, v53, v117
    v_mfma_f32_32x32x16_bf16 v[64:79], a[252:255], v[252:255], v[64:79]
    ds_read_b128 a[244:247], v2 offset:4096
    buffer_load_dwordx4 a[48:51], v13, s[4:7], s38 offen offset:1024
    v_mul_f32 v54, v54, v118
    v_mul_f32 v55, v55, v119
    v_exp_f32_e64 v48, v48
    v_mfma_f32_32x32x16_bf16 v[64:79], a[224:227], v[40:43], v[64:79]
    ds_read_b128 a[248:251], v2 offset:5120
    v_mul_f32 v120, v112, v120
    v_exp_f32 v49, v49
    v_mul_f32 v121, v113, v121
    s_waitcnt lgkmcnt(3)
    v_mfma_f32_32x32x16_bf16 v[80:95], a[228:231], v[128:131], 0
    ds_read_b128 a[252:255], v2 offset:6144
    buffer_load_dwordx4 a[52:55], v13, s[4:7], s38 offen offset:2048
    v_exp_f32 v50, v50
    v_mul_f32 v122, v114, v122
    v_mfma_f32_32x32x16_bf16 v[80:95], a[232:235], v[132:135], v[80:95]
    ds_read_b128 a[224:227], v2 offset:7168
    v_exp_f32 v51, v51
    v_mul_f32 v123, v115, v123
    v_exp_f32_e64 v52, v52
    v_mfma_f32_32x32x16_bf16 v[80:95], a[236:239], v[136:139], v[80:95]
    ds_read_b128 a[228:231], v2 offset:8192
    s_add_u32 s38, s95, 2
    s_and_b32 s38, s38, 3
    s_mul_i32 s38, s38, 7168
    s_add_u32 s38, s38, s83
    buffer_load_dwordx4 a[56:59], v13, s[4:7], s38 offen
    s_waitcnt lgkmcnt(3)
    v_mfma_f32_32x32x16_bf16 v[80:95], a[240:243], v[140:143], v[80:95]
    ds_read_b128 a[232:235], v2 offset:9216
    v_mul_f32 v124, v116, v124
    v_exp_f32 v53, v53
    v_mul_f32_e64 v125, v117, v125
    v_mfma_f32_32x32x16_bf16 v[80:95], a[244:247], v[144:147], v[80:95]
    ds_read_b128 a[236:239], v2 offset:10240
    buffer_load_dwordx4 a[60:63], v13, s[4:7], s38 offen offset:1024
    v_exp_f32 v54, v54
    v_mul_f32 v126, v118, v126
    v_mfma_f32_32x32x16_bf16 v[80:95], a[248:251], v[148:151], v[80:95]
    ds_read_b128 a[240:243], v2 offset:11264
    v_exp_f32 v55, v55
    v_mul_f32 v127, v119, v127
    v_fma_f32 v48, v48, v46, v46
    s_waitcnt lgkmcnt(3)
    v_mfma_f32_32x32x16_bf16 v[80:95], a[252:255], v[152:155], v[80:95]
    ds_read_b128 a[244:247], v2 offset:12288
    buffer_load_dwordx4 a[64:67], v13, s[4:7], s38 offen offset:2048
    v_fma_f32 v49, v49, v46, v46
    v_fma_f32 v50, v50, v46, v46
    v_fma_f32 v51, v51, v46, v46
    v_fma_f32 v52, v52, v46, v46
    v_mfma_f32_32x32x16_bf16 v[80:95], a[224:227], v[156:159], v[80:95]
    ds_read_b128 a[248:251], v2 offset:13312
    v_fma_f32 v53, v53, v46, v46
    v_fma_f32 v54, v54, v46, v46
    v_fma_f32 v55, v55, v46, v46
    v_rcp_f32 v48, v48
    v_mfma_f32_32x32x16_bf16 v[80:95], a[228:231], v[160:163], v[80:95]
    ds_read_b128 a[252:255], v2 offset:14336
    buffer_load_dwordx4 a[68:71], v13, s[4:7], s38 offen offset:3072
    v_rcp_f32 v49, v49
    v_mul_f32_e64 v120, v120, v48
    s_waitcnt lgkmcnt(3)
    v_mfma_f32_32x32x16_bf16 v[80:95], a[232:235], v[164:167], v[80:95]
    ds_read_b128 a[224:227], v2 offset:15360
    v_rcp_f32 v50, v50
    v_mul_f32 v121, v121, v49
    v_rcp_f32_e64 v51, v51
    v_mfma_f32_32x32x16_bf16 v[80:95], a[236:239], v[168:171], v[80:95]
    ds_read_b128 a[228:231], v2 offset:16384
    s_add_u32 s38, s38, 4096
    buffer_load_dwordx4 a[72:75], v13, s[4:7], s38 offen
    v_mul_f32 v122, v122, v50
    v_rcp_f32 v52, v52
    v_mfma_f32_32x32x16_bf16 v[80:95], a[240:243], v[172:175], v[80:95]
    ds_read_b128 a[232:235], v2 offset:17408
    v_mul_f32 v123, v123, v51
    v_rcp_f32 v53, v53
    v_mul_f32 v124, v124, v52
    s_waitcnt lgkmcnt(3)
    v_mfma_f32_32x32x16_bf16 v[80:95], a[244:247], v[176:179], v[80:95]
    ds_read_b128 a[236:239], v2 offset:18432
    buffer_load_dwordx4 a[76:79], v13, s[4:7], s38 offen offset:1024
    v_rcp_f32 v54, v54
    v_mul_f32 v125, v125, v53
    v_mfma_f32_32x32x16_bf16 v[80:95], a[248:251], v[180:183], v[80:95]
    ds_read_b128 a[240:243], v2 offset:19456
    v_rcp_f32 v55, v55
    v_mul_f32 v126, v126, v54
    v_cvt_pk_bf16_f32 v56, v120, v121
    v_mul_f32_e64 v127, v127, v55
    v_mfma_f32_32x32x16_bf16 v[80:95], a[252:255], v[184:187], v[80:95]
    ds_read_b128 a[244:247], v2 offset:20480
    buffer_load_dwordx4 a[80:83], v13, s[4:7], s38 offen offset:2048
    v_cvt_pk_bf16_f32 v57, v122, v123
    v_cvt_pk_bf16_f32 v58, v124, v125
    v_cvt_pk_bf16_f32 v59, v126, v127
    s_waitcnt lgkmcnt(3)
    v_mfma_f32_32x32x16_bf16 v[80:95], a[224:227], v[188:191], v[80:95]
    ds_read_b128 a[248:251], v2 offset:21504
    buffer_store_dwordx4 v[56:59], v0, s[4:7], s73 offen offset:3072 sc1
    v_mul_f32 v48, v64, v64
    v_mul_f32 v49, v65, v65
    v_mul_f32 v50, v66, v66
    v_mul_f32_e64 v51, v67, v67
    v_mfma_f32_32x32x16_bf16 v[80:95], a[228:231], v[192:195], v[80:95]
    ds_read_b128 a[252:255], v2 offset:22528
    s_waitcnt vmcnt(13)
    s_mov_b64 exec, 1
    s_cmp_lg_u32 s8, 0
    s_cbranch_scc1 ss_36
    buffer_store_dwordx2 v[16:17], off, s[4:7], s87
sb_37:
    s_mov_b64 exec, -1
    s_add_u32 s38, s95, 3
    s_and_b32 s38, s38, 3
    s_mul_i32 s38, s38, 7168
    s_add_u32 s38, s38, s83
    buffer_load_dwordx4 a[84:87], v13, s[4:7], s38 offen
    v_mfma_f32_32x32x16_bf16 v[80:95], a[232:235], v[196:199], v[80:95]
    ds_read_b128 a[224:227], v2 offset:23552
    v_mul_f32 v52, v68, v68
    v_mul_f32 v53, v69, v69
    v_mul_f32 v54, v70, v70
    v_mul_f32_e64 v55, v71, v71
    s_waitcnt lgkmcnt(3)
    v_mfma_f32_32x32x16_bf16 v[80:95], a[236:239], v[200:203], v[80:95]
    ds_read_b128 a[228:231], v2 offset:24576
    buffer_load_dwordx4 a[88:91], v13, s[4:7], s38 offen offset:1024
    v_fma_f32 v48, v48, v45, v44
    v_fma_f32 v49, v49, v45, v44
    v_fma_f32 v50, v50, v45, v44
    v_fma_f32 v51, v51, v45, v44
    v_mfma_f32_32x32x16_bf16 v[80:95], a[240:243], v[204:207], v[80:95]
    ds_read_b128 a[232:235], v2 offset:25600
    v_fma_f32 v52, v52, v45, v44
    v_fma_f32 v53, v53, v45, v44
    v_fma_f32 v54, v54, v45, v44
    v_fma_f32 v55, v55, v45, v44
    v_mul_f32_e64 v48, v48, v64
    v_mfma_f32_32x32x16_bf16 v[80:95], a[244:247], v[208:211], v[80:95]
    ds_read_b128 a[236:239], v2 offset:26624
    buffer_load_dwordx4 a[92:95], v13, s[4:7], s38 offen offset:2048
    v_mul_f32 v49, v49, v65
    v_mul_f32 v50, v50, v66
    v_mul_f32 v51, v51, v67
    s_waitcnt lgkmcnt(3)
    v_mfma_f32_32x32x16_bf16 v[80:95], a[248:251], v[212:215], v[80:95]
    ds_read_b128 a[240:243], v2 offset:27648
    v_mul_f32 v52, v52, v68
    v_mul_f32 v53, v53, v69
    v_mul_f32 v54, v54, v70
    v_mul_f32 v55, v55, v71
    v_mfma_f32_32x32x16_bf16 v[80:95], a[252:255], v[216:219], v[80:95]
    ds_read_b128 a[244:247], v2 offset:28672
    buffer_load_dwordx4 a[96:99], v13, s[4:7], s38 offen offset:3072
    v_exp_f32 v48, v48
    v_mul_f32 v72, v64, v72
    v_mfma_f32_32x32x16_bf16 v[80:95], a[224:227], v[220:223], v[80:95]
    ds_read_b128 a[248:251], v2 offset:29696
    v_exp_f32 v49, v49
    v_mul_f32_e64 v73, v65, v73
    s_waitcnt lgkmcnt(3)
    v_mfma_f32_32x32x16_bf16 v[80:95], a[228:231], v[224:227], v[80:95]
    ds_read_b128 a[252:255], v2 offset:30720
    s_add_u32 s38, s38, 4096
    buffer_load_dwordx4 a[100:103], v13, s[4:7], s38 offen
    v_exp_f32 v50, v50
    v_mul_f32 v74, v66, v74
    v_mfma_f32_32x32x16_bf16 v[80:95], a[232:235], v[228:231], v[80:95]
    ds_read_b128 a[224:227], v2 offset:31744
    v_exp_f32 v51, v51
    v_mul_f32 v75, v67, v75
    v_exp_f32_e64 v52, v52
    v_mfma_f32_32x32x16_bf16 v[80:95], a[236:239], v[232:235], v[80:95]
    ds_read_b128 a[228:231], v2 offset:32768
    buffer_load_dwordx4 a[104:107], v13, s[4:7], s38 offen offset:1024
    v_mul_f32 v76, v68, v76
    v_exp_f32_e64 v53, v53
    s_waitcnt lgkmcnt(3)
    v_mfma_f32_32x32x16_bf16 v[80:95], a[240:243], v[236:239], v[80:95]
    v_mul_f32 v77, v69, v77
    v_exp_f32 v54, v54
    v_mul_f32 v78, v70, v78
    v_exp_f32 v55, v55
    v_mfma_f32_32x32x16_bf16 v[80:95], a[244:247], v[240:243], v[80:95]
    s_waitcnt lgkmcnt(0)
    s_barrier
    ds_read_b128 a[232:235], v3 offset:0
    ds_read_b128 a[236:239], v3 offset:1024
    buffer_load_dwordx4 a[108:111], v13, s[4:7], s38 offen offset:2048
    v_mul_f32_e64 v79, v71, v79
    v_mfma_f32_32x32x16_bf16 v[80:95], a[248:251], v[244:247], v[80:95]
    ds_read_b128 a[240:243], v3 offset:2048
    v_fma_f32 v48, v48, v46, v46
    v_fma_f32 v49, v49, v46, v46
    v_fma_f32 v50, v50, v46, v46
    v_fma_f32 v51, v51, v46, v46
    v_fma_f32 v52, v52, v46, v46
    v_mfma_f32_32x32x16_bf16 v[80:95], a[252:255], v[248:251], v[80:95]
    ds_read_b128 a[244:247], v3 offset:3072
    s_add_u32 s38, s95, 0
    s_and_b32 s38, s38, 3
    s_mul_i32 s38, s38, 7168
    s_add_u32 s38, s38, s84
    buffer_load_dwordx4 a[112:115], v13, s[4:7], s38 offen
    v_mfma_f32_32x32x16_bf16 v[80:95], a[224:227], v[252:255], v[80:95]
    ds_read_b128 a[248:251], v3 offset:4096
    v_fma_f32 v53, v53, v46, v46
    v_fma_f32 v54, v54, v46, v46
    v_fma_f32 v55, v55, v46, v46
    v_rcp_f32 v48, v48
    v_mfma_f32_32x32x16_bf16 v[80:95], a[228:231], v[40:43], v[80:95]
    ds_read_b128 a[252:255], v3 offset:5120
    buffer_load_dwordx4 a[116:119], v13, s[4:7], s38 offen offset:1024
    v_rcp_f32 v49, v49
    v_mul_f32_e64 v72, v72, v48
    s_waitcnt lgkmcnt(3)
    v_mfma_f32_32x32x16_bf16 v[96:111], a[232:235], v[128:131], 0
    ds_read_b128 a[224:227], v3 offset:6144
    v_rcp_f32 v50, v50
    v_mul_f32 v73, v73, v49
    v_rcp_f32_e64 v51, v51
    v_mfma_f32_32x32x16_bf16 v[96:111], a[236:239], v[132:135], v[96:111]
    ds_read_b128 a[228:231], v3 offset:7168
    buffer_load_dwordx4 a[120:123], v13, s[4:7], s38 offen offset:2048
    v_mul_f32 v74, v74, v50
    v_rcp_f32 v52, v52
    v_mul_f32_e64 v75, v75, v51
    v_mfma_f32_32x32x16_bf16 v[96:111], a[240:243], v[136:139], v[96:111]
    ds_read_b128 a[232:235], v3 offset:8192
    buffer_load_dwordx4 v[32:35], v0, s[4:7], s69 offen sc1
    buffer_load_dwordx4 v[36:39], v0, s[4:7], s70 offen sc1
    v_rcp_f32 v53, v53
    s_waitcnt lgkmcnt(3)
    v_mfma_f32_32x32x16_bf16 v[96:111], a[244:247], v[140:143], v[96:111]
    ds_read_b128 a[236:239], v3 offset:9216
    buffer_load_dwordx4 a[124:127], v13, s[4:7], s38 offen offset:3072
    v_mul_f32 v76, v76, v52
    v_rcp_f32 v54, v54
    v_mul_f32 v77, v77, v53
    v_rcp_f32 v55, v55
    v_mul_f32_e64 v78, v78, v54
    v_cvt_pk_bf16_f32 v56, v72, v73
    v_mul_f32_e64 v79, v79, v55
    v_cvt_pk_bf16_f32 v57, v74, v75
    v_cvt_pk_bf16_f32 v58, v76, v77
    v_cvt_pk_bf16_f32 v59, v78, v79
    buffer_store_dwordx4 v[56:59], v0, s[4:7], s94 offen sc1
    v_mfma_f32_32x32x16_bf16 v[96:111], a[248:251], v[144:147], v[96:111]
    ds_read_b128 a[240:243], v3 offset:10240
    v_mul_f32 v48, v80, v80
    v_mul_f32 v49, v81, v81
    v_mul_f32 v50, v82, v82
    v_mul_f32 v51, v83, v83
    v_mul_f32_e64 v52, v84, v84
    v_mfma_f32_32x32x16_bf16 v[96:111], a[252:255], v[148:151], v[96:111]
    ds_read_b128 a[244:247], v3 offset:11264
    s_add_u32 s38, s38, 4096
    buffer_load_dwordx4 a[128:131], v13, s[4:7], s38 offen
    v_mul_f32 v53, v85, v85
    v_mul_f32_e64 v54, v86, v86
    s_waitcnt lgkmcnt(3)
    v_mfma_f32_32x32x16_bf16 v[96:111], a[224:227], v[152:155], v[96:111]
    ds_read_b128 a[248:251], v3 offset:12288
    v_mul_f32_e64 v55, v87, v87
    v_fma_f32 v48, v48, v45, v44
    v_fma_f32 v49, v49, v45, v44
    v_fma_f32 v50, v50, v45, v44
    v_fma_f32 v51, v51, v45, v44
    v_mfma_f32_32x32x16_bf16 v[96:111], a[228:231], v[156:159], v[96:111]
    ds_read_b128 a[252:255], v3 offset:13312
    buffer_load_dwordx4 a[132:135], v13, s[4:7], s38 offen offset:1024
    v_fma_f32 v52, v52, v45, v44
    v_fma_f32 v53, v53, v45, v44
    v_fma_f32 v54, v54, v45, v44
    v_fma_f32 v55, v55, v45, v44
    v_mfma_f32_32x32x16_bf16 v[96:111], a[232:235], v[160:163], v[96:111]
    ds_read_b128 a[224:227], v3 offset:14336
    buffer_load_dwordx2 v[60:61], v15, s[4:7], s92 offen sc1
    v_mul_f32 v48, v48, v80
    v_mul_f32 v49, v49, v81
    v_mul_f32 v50, v50, v82
    s_waitcnt lgkmcnt(3)
    v_mfma_f32_32x32x16_bf16 v[96:111], a[236:239], v[164:167], v[96:111]
    ds_read_b128 a[228:231], v3 offset:15360
    buffer_load_dwordx4 a[136:139], v13, s[4:7], s38 offen offset:2048
    v_mul_f32 v51, v51, v83
    v_mul_f32 v52, v52, v84
    v_mul_f32 v53, v53, v85
    v_mul_f32 v54, v54, v86
    v_mfma_f32_32x32x16_bf16 v[96:111], a[240:243], v[168:171], v[96:111]
    ds_read_b128 a[232:235], v3 offset:16384
    v_mul_f32 v55, v55, v87
    v_exp_f32 v48, v48
    v_mul_f32_e64 v88, v80, v88
    v_mfma_f32_32x32x16_bf16 v[96:111], a[244:247], v[172:175], v[96:111]
    ds_read_b128 a[236:239], v3 offset:17408
    s_add_u32 s38, s95, 1
    s_and_b32 s38, s38, 3
    s_mul_i32 s38, s38, 7168
    s_add_u32 s38, s38, s84
    buffer_load_dwordx4 a[140:143], v13, s[4:7], s38 offen
    s_waitcnt lgkmcnt(3)
    v_mfma_f32_32x32x16_bf16 v[96:111], a[248:251], v[176:179], v[96:111]
    ds_read_b128 a[240:243], v3 offset:18432
    v_exp_f32 v49, v49
    v_mul_f32 v89, v81, v89
    v_exp_f32_e64 v50, v50
    v_mfma_f32_32x32x16_bf16 v[96:111], a[252:255], v[180:183], v[96:111]
    ds_read_b128 a[244:247], v3 offset:19456
    buffer_load_dwordx4 a[144:147], v13, s[4:7], s38 offen offset:1024
    v_mul_f32 v90, v82, v90
    v_exp_f32 v51, v51
    v_mul_f32_e64 v91, v83, v91
    v_mfma_f32_32x32x16_bf16 v[96:111], a[224:227], v[184:187], v[96:111]
    ds_read_b128 a[248:251], v3 offset:20480
    v_exp_f32 v52, v52
    v_mul_f32_e64 v92, v84, v92
    s_waitcnt lgkmcnt(3)
    v_mfma_f32_32x32x16_bf16 v[96:111], a[228:231], v[188:191], v[96:111]
    ds_read_b128 a[252:255], v3 offset:21504
    buffer_load_dwordx4 a[148:151], v13, s[4:7], s38 offen offset:2048
    v_exp_f32 v53, v53
    v_mul_f32 v93, v85, v93
    v_mfma_f32_32x32x16_bf16 v[96:111], a[232:235], v[192:195], v[96:111]
    ds_read_b128 a[224:227], v3 offset:22528
    v_exp_f32 v54, v54
    v_mul_f32 v94, v86, v94
    v_exp_f32_e64 v55, v55
    v_mfma_f32_32x32x16_bf16 v[96:111], a[236:239], v[196:199], v[96:111]
    ds_read_b128 a[228:231], v3 offset:23552
    buffer_load_dwordx4 a[152:155], v13, s[4:7], s38 offen offset:3072
    v_mul_f32_e64 v95, v87, v95
    v_fma_f32 v48, v48, v46, v46
    v_fma_f32 v49, v49, v46, v46
    s_waitcnt lgkmcnt(3)
    v_mfma_f32_32x32x16_bf16 v[96:111], a[240:243], v[200:203], v[96:111]
    ds_read_b128 a[232:235], v3 offset:24576
    v_fma_f32 v50, v50, v46, v46
    v_fma_f32 v51, v51, v46, v46
    v_fma_f32 v52, v52, v46, v46
    v_fma_f32 v53, v53, v46, v46
    v_fma_f32 v54, v54, v46, v46
    v_mfma_f32_32x32x16_bf16 v[96:111], a[244:247], v[204:207], v[96:111]
    ds_read_b128 a[236:239], v3 offset:25600
    s_add_u32 s38, s38, 4096
    buffer_load_dwordx4 a[156:159], v13, s[4:7], s38 offen
    v_fma_f32 v55, v55, v46, v46
    v_rcp_f32 v48, v48
    v_mfma_f32_32x32x16_bf16 v[96:111], a[248:251], v[208:211], v[96:111]
    ds_read_b128 a[240:243], v3 offset:26624
    v_rcp_f32 v49, v49
    v_mul_f32_e64 v88, v88, v48
    s_waitcnt lgkmcnt(3)
    v_mfma_f32_32x32x16_bf16 v[96:111], a[252:255], v[212:215], v[96:111]
    ds_read_b128 a[244:247], v3 offset:27648
    buffer_load_dwordx4 a[160:163], v13, s[4:7], s38 offen offset:1024
    v_rcp_f32 v50, v50
    v_mul_f32 v89, v89, v49
    v_mfma_f32_32x32x16_bf16 v[96:111], a[224:227], v[216:219], v[96:111]
    ds_read_b128 a[248:251], v3 offset:28672
    v_rcp_f32 v51, v51
    v_mul_f32 v90, v90, v50
    v_rcp_f32_e64 v52, v52
    v_mfma_f32_32x32x16_bf16 v[96:111], a[228:231], v[220:223], v[96:111]
    ds_read_b128 a[252:255], v3 offset:29696
    buffer_load_dwordx4 a[164:167], v13, s[4:7], s38 offen offset:2048
    v_mul_f32 v91, v91, v51
    v_rcp_f32_e64 v53, v53
    s_waitcnt lgkmcnt(3)
    v_mfma_f32_32x32x16_bf16 v[96:111], a[232:235], v[224:227], v[96:111]
    ds_read_b128 a[224:227], v3 offset:30720
    v_mul_f32 v92, v92, v52
    v_rcp_f32 v54, v54
    v_mul_f32_e64 v93, v93, v53
    v_mfma_f32_32x32x16_bf16 v[96:111], a[236:239], v[228:231], v[96:111]
    ds_read_b128 a[228:231], v3 offset:31744
    s_add_u32 s38, s95, 2
    s_and_b32 s38, s38, 3
    s_mul_i32 s38, s38, 7168
    s_add_u32 s38, s38, s84
    buffer_load_dwordx4 a[168:171], v13, s[4:7], s38 offen
    v_mfma_f32_32x32x16_bf16 v[96:111], a[240:243], v[232:235], v[96:111]
    ds_read_b128 a[232:235], v3 offset:32768
    v_rcp_f32 v55, v55
    v_mul_f32_e64 v94, v94, v54
    v_cvt_pk_bf16_f32 v56, v88, v89
    s_waitcnt lgkmcnt(3)
    v_mfma_f32_32x32x16_bf16 v[96:111], a[244:247], v[236:239], v[96:111]
    buffer_load_dwordx4 a[172:175], v13, s[4:7], s38 offen offset:1024
    v_mul_f32 v95, v95, v55
    v_cvt_pk_bf16_f32 v57, v90, v91
    v_cvt_pk_bf16_f32 v58, v92, v93
    v_cvt_pk_bf16_f32 v59, v94, v95
    buffer_store_dwordx4 v[56:59], v0, s[4:7], s94 offen offset:1024 sc1
    v_mfma_f32_32x32x16_bf16 v[96:111], a[248:251], v[240:243], v[96:111]
    s_waitcnt vmcnt(14)
    s_mov_b64 exec, 1
    s_cmp_lg_u32 s8, 0
    s_cbranch_scc1 ss_38
    buffer_store_dwordx2 v[16:17], off, s[4:7], s87 offset:128
sb_39:
    s_mov_b64 exec, -1
    v_mfma_f32_32x32x16_bf16 v[96:111], a[252:255], v[244:247], v[96:111]
    buffer_load_dwordx4 a[176:179], v13, s[4:7], s38 offen offset:2048
    s_waitcnt lgkmcnt(2)
    v_mfma_f32_32x32x16_bf16 v[96:111], a[224:227], v[248:251], v[96:111]
    s_waitcnt lgkmcnt(1)
    v_mfma_f32_32x32x16_bf16 v[96:111], a[228:231], v[252:255], v[96:111]
    buffer_load_dwordx4 a[180:183], v13, s[4:7], s38 offen offset:3072
    s_waitcnt lgkmcnt(0)
    v_mfma_f32_32x32x16_bf16 v[96:111], a[232:235], v[40:43], v[96:111]
    s_add_u32 s38, s38, 4096
    buffer_load_dwordx4 a[184:187], v13, s[4:7], s38 offen
    buffer_load_dwordx4 a[188:191], v13, s[4:7], s38 offen offset:1024
    buffer_load_dwordx4 a[192:195], v13, s[4:7], s38 offen offset:2048
    s_add_u32 s38, s95, 3
    s_and_b32 s38, s38, 3
    s_mul_i32 s38, s38, 7168
    s_add_u32 s38, s38, s84
    buffer_load_dwordx4 a[196:199], v13, s[4:7], s38 offen
    buffer_load_dwordx4 a[200:203], v13, s[4:7], s38 offen offset:1024
    buffer_load_dwordx4 a[204:207], v13, s[4:7], s38 offen offset:2048
    buffer_load_dwordx4 a[208:211], v13, s[4:7], s38 offen offset:3072
    s_add_u32 s38, s38, 4096
    buffer_load_dwordx4 a[212:215], v13, s[4:7], s38 offen
    buffer_load_dwordx4 a[216:219], v13, s[4:7], s38 offen offset:1024
    buffer_load_dwordx4 a[220:223], v13, s[4:7], s38 offen offset:2048
    s_waitcnt vmcnt(24)
    v_cmp_ne_u64 vcc, s[28:29], v[60:61]
    s_cbranch_vccnz fstub_40
fback_41:
    v_pk_mul_f32 v[48:49], v[96:97], v[96:97]
    buffer_load_dwordx4 v[128:131], v0, s[4:7], s40 offen sc1
    v_pk_mul_f32 v[50:51], v[98:99], v[98:99]
    v_pk_mul_f32 v[52:53], v[100:101], v[100:101]
    v_pk_mul_f32 v[54:55], v[102:103], v[102:103]
    v_pk_fma_f32 v[48:49], v[48:49], v[44:45], v[44:45] op_sel:[0,1,0] op_sel_hi:[1,1,0]
    v_pk_fma_f32 v[50:51], v[50:51], v[44:45], v[44:45] op_sel:[0,1,0] op_sel_hi:[1,1,0]
    v_pk_fma_f32 v[52:53], v[52:53], v[44:45], v[44:45] op_sel:[0,1,0] op_sel_hi:[1,1,0]
    buffer_load_dwordx4 v[132:135], v0, s[4:7], s42 offen sc1
    v_pk_fma_f32 v[54:55], v[54:55], v[44:45], v[44:45] op_sel:[0,1,0] op_sel_hi:[1,1,0]
    v_pk_mul_f32 v[48:49], v[48:49], v[96:97]
    v_pk_mul_f32 v[50:51], v[50:51], v[98:99]
    v_pk_mul_f32 v[52:53], v[52:53], v[100:101]
    v_pk_mul_f32 v[54:55], v[54:55], v[102:103]
    v_exp_f32_e64 v48, v48
    buffer_load_dwordx4 v[136:139], v0, s[4:7], s44 offen sc1
    v_exp_f32 v49, v49
    v_exp_f32 v50, v50
    v_exp_f32_e64 v51, v51
    buffer_load_dwordx4 v[140:143], v0, s[4:7], s46 offen sc1
    v_exp_f32 v52, v52
    v_exp_f32 v53, v53
    v_exp_f32_e64 v54, v54
    buffer_load_dwordx4 v[144:147], v0, s[4:7], s40 offen offset:1024 sc1
    v_exp_f32_e64 v55, v55
    v_pk_mul_f32 v[104:105], v[96:97], v[104:105]
    v_pk_mul_f32 v[106:107], v[98:99], v[106:107]
    v_pk_mul_f32 v[108:109], v[100:101], v[108:109]
    v_pk_mul_f32 v[110:111], v[102:103], v[110:111]
    buffer_load_dwordx4 v[148:151], v0, s[4:7], s42 offen offset:1024 sc1
    v_pk_fma_f32 v[48:49], v[48:49], v[46:47], v[46:47] op_sel:[0,0,0] op_sel_hi:[1,0,0]
    v_pk_fma_f32 v[50:51], v[50:51], v[46:47], v[46:47] op_sel:[0,0,0] op_sel_hi:[1,0,0]
    v_pk_fma_f32 v[52:53], v[52:53], v[46:47], v[46:47] op_sel:[0,0,0] op_sel_hi:[1,0,0]
    v_pk_fma_f32 v[54:55], v[54:55], v[46:47], v[46:47] op_sel:[0,0,0] op_sel_hi:[1,0,0]
    v_rcp_f32_e64 v48, v48
    buffer_load_dwordx4 v[152:155], v0, s[4:7], s44 offen offset:1024 sc1
    v_rcp_f32 v49, v49
    v_rcp_f32 v50, v50
    v_rcp_f32_e64 v51, v51
    buffer_load_dwordx4 v[156:159], v0, s[4:7], s46 offen offset:1024 sc1
    v_rcp_f32 v52, v52
    v_rcp_f32 v53, v53
    v_rcp_f32_e64 v54, v54
    buffer_load_dwordx4 v[160:163], v0, s[4:7], s40 offen offset:2048 sc1
    v_rcp_f32_e64 v55, v55
    v_pk_mul_f32 v[104:105], v[104:105], v[48:49]
    v_pk_mul_f32 v[106:107], v[106:107], v[50:51]
    v_pk_mul_f32 v[108:109], v[108:109], v[52:53]
    v_pk_mul_f32 v[110:111], v[110:111], v[54:55]
    buffer_load_dwordx4 v[164:167], v0, s[4:7], s42 offen offset:2048 sc1
    v_cvt_pk_bf16_f32 v56, v104, v105
    v_cvt_pk_bf16_f32 v57, v106, v107
    v_cvt_pk_bf16_f32 v58, v108, v109
    v_cvt_pk_bf16_f32 v59, v110, v111
    buffer_store_dwordx4 v[56:59], v0, s[4:7], s94 offen offset:2048 sc1
    buffer_load_dwordx4 v[168:171], v0, s[4:7], s44 offen offset:2048 sc1
L_p4_0:
    v_lshlrev_b32_e64 v64, 16, v32
    v_and_b32 v65, 0xffff0000, v32
    v_lshlrev_b32_e64 v66, 16, v33
    v_and_b32 v67, 0xffff0000, v33
    v_lshlrev_b32_e64 v68, 16, v34
    v_and_b32 v69, 0xffff0000, v34
    v_lshlrev_b32_e64 v70, 16, v35
    v_and_b32 v71, 0xffff0000, v35
    v_mov_b64 v[72:73], 0
    v_mov_b64 v[74:75], 0
    v_mov_b64 v[76:77], 0
    v_mov_b64 v[78:79], 0
    v_lshlrev_b32_e64 v96, 16, v36
    v_and_b32 v97, 0xffff0000, v36
    v_lshlrev_b32_e64 v98, 16, v37
    v_and_b32 v99, 0xffff0000, v37
    v_lshlrev_b32_e64 v100, 16, v38
    v_and_b32 v101, 0xffff0000, v38
    v_lshlrev_b32_e64 v102, 16, v39
    v_and_b32 v103, 0xffff0000, v39
    v_mov_b64 v[104:105], 0
    v_mov_b64 v[106:107], 0
    v_mov_b64 v[108:109], 0
    v_mov_b64 v[110:111], 0
    v_add_u32 v24, s99, v20
    v_add_u32 v25, s100, v20
    v_add_u32 v26, s101, v20
    v_add_u32 v27, s3, v20
    s_add_u32 s39, s3, 135168
    v_add_u32_e64 v28, s39, v1
    s_and_b32 s39, s32, 1
    s_lshl_b32 s39, s39, 8
    s_add_u32 s39, s39, 135168
    v_add_u32 v29, s39, v1
    s_waitcnt vmcnt(11)
    v_mfma_f32_32x32x16_bf16 v[64:79], a[0:3], v[128:131], v[64:79]
    buffer_load_dwordx4 v[172:175], v0, s[4:7], s46 offen offset:2048 sc1
    v_mfma_f32_32x32x16_bf16 v[80:95], a[112:115], v[128:131], 0
    s_waitcnt vmcnt(11)
    v_mfma_f32_32x32x16_bf16 v[64:79], a[28:31], v[132:135], v[64:79]
    buffer_load_dwordx4 v[176:179], v0, s[4:7], s48 offen sc1
    v_mfma_f32_32x32x16_bf16 v[80:95], a[140:143], v[132:135], v[80:95]
    s_lshr_b32 s39, s2, 3
    s_lshl_b32 s39, s39, 2
    s_add_u32 s39, s39, s32
    s_lshl_b32 s39, s39, 8
    s_add_u32 s39, s39, L_p1_1-interleave_layers__linear_kernel_hedgehog__geglu_ffn__prompt_kernel
    v_and_b32 v18, 0x80, v0
    v_add_u32 v18, s39, v18
    v_min_u32 v18, L_codeend-interleave_layers__linear_kernel_hedgehog__geglu_ffn__prompt_kernel-4, v18
    global_load_dword v21, v18, s[12:13]
    s_waitcnt vmcnt(12)
    v_mfma_f32_32x32x16_bf16 v[64:79], a[56:59], v[136:139], v[64:79]
    buffer_load_dwordx2 v[60:61], v15, s[4:7], s92 offen offset:128 sc1
    buffer_load_dwordx4 v[180:183], v0, s[4:7], s50 offen sc1
    v_mfma_f32_32x32x16_bf16 v[80:95], a[168:171], v[136:139], v[80:95]
    s_add_u32 m0, s11, 67584
    s_add_u32 s37, s34, 0
    buffer_load_dwordx4 v0, s[4:7], s37 offen lds
    s_waitcnt vmcnt(14)
    v_mfma_f32_32x32x16_bf16 v[64:79], a[84:87], v[140:143], v[64:79]
    buffer_load_dwordx4 v[184:187], v0, s[4:7], s52 offen sc1
    v_mfma_f32_32x32x16_bf16 v[80:95], a[196:199], v[140:143], v[80:95]
    buffer_load_dwordx4 v0, s[4:7], s37 offen offset:1024 lds
    s_waitcnt vmcnt(15)
    v_mfma_f32_32x32x16_bf16 v[64:79], a[4:7], v[144:147], v[64:79]
    buffer_load_dwordx4 v[188:191], v0, s[4:7], s54 offen sc1
    v_mfma_f32_32x32x16_bf16 v[80:95], a[116:119], v[144:147], v[80:95]
    buffer_load_dwordx4 v0, s[4:7], s37 offen offset:2048 lds
    s_waitcnt vmcnt(16)
    v_mfma_f32_32x32x16_bf16 v[64:79], a[32:35], v[148:151], v[64:79]
    buffer_load_dwordx4 v[192:195], v0, s[4:7], s48 offen offset:1024 sc1
    v_mfma_f32_32x32x16_bf16 v[80:95], a[144:147], v[148:151], v[80:95]
    buffer_load_dwordx4 v0, s[4:7], s37 offen offset:3072 lds
    s_waitcnt vmcnt(17)
    v_mfma_f32_32x32x16_bf16 v[64:79], a[60:63], v[152:155], v[64:79]
    buffer_load_dwordx4 v[196:199], v0, s[4:7], s50 offen offset:1024 sc1
    v_mfma_f32_32x32x16_bf16 v[80:95], a[172:175], v[152:155], v[80:95]
    s_add_u32 m0, s11, 83968
    s_add_u32 s37, s34, 16384
    buffer_load_dwordx4 v0, s[4:7], s37 offen lds
    s_waitcnt vmcnt(18)
    v_mfma_f32_32x32x16_bf16 v[64:79], a[88:91], v[156:159], v[64:79]
    buffer_load_dwordx4 v[200:203], v0, s[4:7], s52 offen offset:1024 sc1
    v_mfma_f32_32x32x16_bf16 v[80:95], a[200:203], v[156:159], v[80:95]
    buffer_load_dwordx4 v0, s[4:7], s37 offen offset:1024 lds
    s_waitcnt vmcnt(19)
    v_mfma_f32_32x32x16_bf16 v[64:79], a[8:11], v[160:163], v[64:79]
    buffer_load_dwordx4 v[204:207], v0, s[4:7], s54 offen offset:1024 sc1
    v_mfma_f32_32x32x16_bf16 v[80:95], a[120:123], v[160:163], v[80:95]
    buffer_load_dwordx4 v0, s[4:7], s37 offen offset:2048 lds
    s_waitcnt vmcnt(20)
    v_mfma_f32_32x32x16_bf16 v[64:79], a[36:39], v[164:167], v[64:79]
    buffer_load_dwordx4 v[208:211], v0, s[4:7], s48 offen offset:2048 sc1
    v_mfma_f32_32x32x16_bf16 v[80:95], a[148:151], v[164:167], v[80:95]
    buffer_load_dwordx4 v0, s[4:7], s37 offen offset:3072 lds
    s_waitcnt vmcnt(20)
    v_mfma_f32_32x32x16_bf16 v[64:79], a[64:67], v[168:171], v[64:79]
    buffer_load_dwordx4 v[212:215], v0, s[4:7], s50 offen offset:2048 sc1
    v_mfma_f32_32x32x16_bf16 v[80:95], a[176:179], v[168:171], v[80:95]
    s_add_u32 m0, s35, 67584
    s_add_u32 s37, s36, 0
    buffer_load_dword v63, s[4:7], s37 offen lds
    s_waitcnt vmcnt(21)
    v_mfma_f32_32x32x16_bf16 v[64:79], a[92:95], v[172:175], v[64:79]
    s_mov_b64 exec, 1
    s_cmp_lg_u32 s8, 0
    s_cbranch_scc1 ss_42
    buffer_store_dwordx2 v[16:17], off, s[4:7], s87 offset:256
sb_43:
    s_mov_b64 exec, -1
    buffer_load_dwordx4 v[216:219], v0, s[4:7], s52 offen offset:2048 sc1
    v_mfma_f32_32x32x16_bf16 v[80:95], a[204:207], v[172:175], v[80:95]
    s_add_u32 m0, s11, 101376
    s_add_u32 s37, s34, 33792
    buffer_load_dwordx4 v0, s[4:7], s37 offen lds
    s_waitcnt vmcnt(23)
    v_mfma_f32_32x32x16_bf16 v[96:111], a[0:3], v[176:179], v[96:111]
    buffer_load_dwordx4 v[220:223], v0, s[4:7], s54 offen offset:2048 sc1
    v_mfma_f32_32x32x16_bf16 v[112:127], a[112:115], v[176:179], 0
    buffer_load_dwordx4 v0, s[4:7], s37 offen offset:1024 lds
    s_waitcnt vmcnt(22)
    v_mfma_f32_32x32x16_bf16 v[96:111], a[28:31], v[180:183], v[96:111]
    v_cmp_ne_u64 vcc, s[28:29], v[60:61]
    s_cbranch_vccnz fstub_44
fback_45:
    buffer_load_dwordx4 v[224:227], v0, s[4:7], s40 offen offset:3072 sc1
    v_mfma_f32_32x32x16_bf16 v[112:127], a[140:143], v[180:183], v[112:127]
    buffer_load_dwordx4 v0, s[4:7], s37 offen offset:2048 lds
    s_waitcnt vmcnt(22)
    v_mfma_f32_32x32x16_bf16 v[96:111], a[56:59], v[184:187], v[96:111]
    buffer_load_dwordx4 v[228:231], v0, s[4:7], s42 offen offset:3072 sc1
    v_mfma_f32_32x32x16_bf16 v[112:127], a[168:171], v[184:187], v[112:127]
    buffer_load_dwordx4 v0, s[4:7], s37 offen offset:3072 lds
    s_waitcnt vmcnt(22)
    v_mfma_f32_32x32x16_bf16 v[96:111], a[84:87], v[188:191], v[96:111]
    buffer_load_dwordx4 v[232:235], v0, s[4:7], s44 offen offset:3072 sc1
    v_mfma_f32_32x32x16_bf16 v[112:127], a[196:199], v[188:191], v[112:127]
    s_add_u32 m0, s11, 117760
    s_add_u32 s37, s34, 50176
    buffer_load_dwordx4 v0, s[4:7], s37 offen lds
    s_waitcnt vmcnt(22)
    v_mfma_f32_32x32x16_bf16 v[96:111], a[4:7], v[192:195], v[96:111]
    buffer_load_dwordx4 v[236:239], v0, s[4:7], s46 offen offset:3072 sc1
    v_mfma_f32_32x32x16_bf16 v[112:127], a[116:119], v[192:195], v[112:127]
    buffer_load_dwordx4 v0, s[4:7], s37 offen offset:1024 lds
    s_waitcnt vmcnt(22)
    v_mfma_f32_32x32x16_bf16 v[96:111], a[32:35], v[196:199], v[96:111]
    buffer_load_dwordx4 v[240:243], v0, s[4:7], s41 offen sc1
    v_mfma_f32_32x32x16_bf16 v[112:127], a[144:147], v[196:199], v[112:127]
    buffer_load_dwordx4 v0, s[4:7], s37 offen offset:2048 lds
    s_waitcnt vmcnt(22)
    v_mfma_f32_32x32x16_bf16 v[96:111], a[60:63], v[200:203], v[96:111]
    buffer_load_dwordx2 v[60:61], v15, s[4:7], s92 offen offset:256 sc1
    buffer_load_dwordx4 v[244:247], v0, s[4:7], s43 offen sc1
    v_mfma_f32_32x32x16_bf16 v[112:127], a[172:175], v[200:203], v[112:127]
    buffer_load_dwordx4 v0, s[4:7], s37 offen offset:3072 lds
    s_waitcnt vmcnt(23)
    v_mfma_f32_32x32x16_bf16 v[96:111], a[88:91], v[204:207], v[96:111]
    buffer_load_dwordx4 v[248:251], v0, s[4:7], s45 offen sc1
    v_mfma_f32_32x32x16_bf16 v[112:127], a[200:203], v[204:207], v[112:127]
    s_add_u32 m0, s35, 101376
    s_add_u32 s37, s36, 33792
    buffer_load_dword v63, s[4:7], s37 offen lds
    s_waitcnt vmcnt(23)
    v_mfma_f32_32x32x16_bf16 v[96:111], a[8:11], v[208:211], v[96:111]
    buffer_load_dwordx4 v[252:255], v0, s[4:7], s47 offen sc1
    v_mfma_f32_32x32x16_bf16 v[112:127], a[120:123], v[208:211], v[112:127]
    s_waitcnt vmcnt(22)
    v_mfma_f32_32x32x16_bf16 v[96:111], a[36:39], v[212:215], v[96:111]
    buffer_load_dwordx4 v[128:131], v0, s[4:7], s48 offen offset:3072 sc1
    v_mfma_f32_32x32x16_bf16 v[112:127], a[148:151], v[212:215], v[112:127]
    s_waitcnt vmcnt(20)
    v_mfma_f32_32x32x16_bf16 v[96:111], a[64:67], v[216:219], v[96:111]
    buffer_load_dwordx4 v[132:135], v0, s[4:7], s50 offen offset:3072 sc1
    v_mfma_f32_32x32x16_bf16 v[112:127], a[176:179], v[216:219], v[112:127]
    s_waitcnt vmcnt(19)
    v_mfma_f32_32x32x16_bf16 v[96:111], a[92:95], v[220:223], v[96:111]
    buffer_load_dwordx4 v[136:139], v0, s[4:7], s52 offen offset:3072 sc1
    v_mfma_f32_32x32x16_bf16 v[112:127], a[204:207], v[220:223], v[112:127]
    s_waitcnt vmcnt(18)
    v_mfma_f32_32x32x16_bf16 v[64:79], a[12:15], v[224:227], v[64:79]
    buffer_load_dwordx4 v[140:143], v0, s[4:7], s54 offen offset:3072 sc1
    v_mfma_f32_32x32x16_bf16 v[80:95], a[124:127], v[224:227], v[80:95]
    s_waitcnt vmcnt(17)
    v_mfma_f32_32x32x16_bf16 v[64:79], a[40:43], v[228:231], v[64:79]
    buffer_load_dwordx4 v[144:147], v0, s[4:7], s49 offen sc1
    v_mfma_f32_32x32x16_bf16 v[80:95], a[152:155], v[228:231], v[80:95]
    s_waitcnt vmcnt(16)
    v_mfma_f32_32x32x16_bf16 v[64:79], a[68:71], v[232:235], v[64:79]
    buffer_load_dwordx4 v[148:151], v0, s[4:7], s51 offen sc1
    v_mfma_f32_32x32x16_bf16 v[80:95], a[180:183], v[232:235], v[80:95]
    s_waitcnt vmcnt(15)
    v_mfma_f32_32x32x16_bf16 v[64:79], a[96:99], v[236:239], v[64:79]
    buffer_load_dwordx4 v[152:155], v0, s[4:7], s53 offen sc1
    v_mfma_f32_32x32x16_bf16 v[80:95], a[208:211], v[236:239], v[80:95]
    s_waitcnt vmcnt(14)
    v_mfma_f32_32x32x16_bf16 v[64:79], a[16:19], v[240:243], v[64:79]
    buffer_load_dwordx4 v[156:159], v0, s[4:7], s55 offen sc1
    v_mfma_f32_32x32x16_bf16 v[80:95], a[128:131], v[240:243], v[80:95]
    s_waitcnt vmcnt(12)
    v_mfma_f32_32x32x16_bf16 v[64:79], a[44:47], v[244:247], v[64:79]
    v_cmp_ne_u64 vcc, s[28:29], v[60:61]
    s_cbranch_vccnz fstub_46
fback_47:
    buffer_load_dwordx4 v[160:163], v0, s[4:7], s41 offen offset:1024 sc1
    v_mfma_f32_32x32x16_bf16 v[80:95], a[156:159], v[244:247], v[80:95]
    s_waitcnt vmcnt(11)
    v_mfma_f32_32x32x16_bf16 v[64:79], a[72:75], v[248:251], v[64:79]
    buffer_load_dwordx4 v[164:167], v0, s[4:7], s43 offen offset:1024 sc1
    v_mfma_f32_32x32x16_bf16 v[80:95], a[184:187], v[248:251], v[80:95]
    s_waitcnt vmcnt(10)
    v_mfma_f32_32x32x16_bf16 v[64:79], a[100:103], v[252:255], v[64:79]
    buffer_load_dwordx4 v[168:171], v0, s[4:7], s45 offen offset:1024 sc1
    v_mfma_f32_32x32x16_bf16 v[80:95], a[212:215], v[252:255], v[80:95]
    s_waitcnt vmcnt(10)
    v_mfma_f32_32x32x16_bf16 v[96:111], a[12:15], v[128:131], v[96:111]
    buffer_load_dwordx4 v[172:175], v0, s[4:7], s47 offen offset:1024 sc1
    v_mfma_f32_32x32x16_bf16 v[112:127], a[124:127], v[128:131], v[112:127]
    s_waitcnt vmcnt(10)
    v_mfma_f32_32x32x16_bf16 v[96:111], a[40:43], v[132:135], v[96:111]
    buffer_load_dwordx4 v[176:179], v0, s[4:7], s41 offen offset:2048 sc1
    v_mfma_f32_32x32x16_bf16 v[112:127], a[152:155], v[132:135], v[112:127]
    s_waitcnt vmcnt(10)
    v_mfma_f32_32x32x16_bf16 v[96:111], a[68:71], v[136:139], v[96:111]
    buffer_load_dwordx4 v[180:183], v0, s[4:7], s43 offen offset:2048 sc1
    v_mfma_f32_32x32x16_bf16 v[112:127], a[180:183], v[136:139], v[112:127]
    s_waitcnt vmcnt(10)
    v_mfma_f32_32x32x16_bf16 v[96:111], a[96:99], v[140:143], v[96:111]
    buffer_load_dwordx4 v[184:187], v0, s[4:7], s45 offen offset:2048 sc1
    v_mfma_f32_32x32x16_bf16 v[112:127], a[208:211], v[140:143], v[112:127]
    s_waitcnt vmcnt(10)
    v_mfma_f32_32x32x16_bf16 v[96:111], a[16:19], v[144:147], v[96:111]
    buffer_load_dwordx4 v[188:191], v0, s[4:7], s47 offen offset:2048 sc1
    v_mfma_f32_32x32x16_bf16 v[112:127], a[128:131], v[144:147], v[112:127]
    s_waitcnt vmcnt(10)
    v_mfma_f32_32x32x16_bf16 v[96:111], a[44:47], v[148:151], v[96:111]
    buffer_load_dwordx4 v[192:195], v0, s[4:7], s49 offen offset:1024 sc1
    v_mfma_f32_32x32x16_bf16 v[112:127], a[156:159], v[148:151], v[112:127]
    s_waitcnt vmcnt(10)
    v_mfma_f32_32x32x16_bf16 v[96:111], a[72:75], v[152:155], v[96:111]
    buffer_load_dwordx4 v[196:199], v0, s[4:7], s51 offen offset:1024 sc1
    v_mfma_f32_32x32x16_bf16 v[112:127], a[184:187], v[152:155], v[112:127]
    s_waitcnt vmcnt(10)
    v_mfma_f32_32x32x16_bf16 v[96:111], a[100:103], v[156:159], v[96:111]
    buffer_load_dwordx4 v[200:203], v0, s[4:7], s53 offen offset:1024 sc1
    v_mfma_f32_32x32x16_bf16 v[112:127], a[212:215], v[156:159], v[112:127]
    s_waitcnt vmcnt(10)
    v_mfma_f32_32x32x16_bf16 v[64:79], a[20:23], v[160:163], v[64:79]
    buffer_load_dwordx4 v[204:207], v0, s[4:7], s55 offen offset:1024 sc1
    v_mfma_f32_32x32x16_bf16 v[80:95], a[132:135], v[160:163], v[80:95]
    s_waitcnt vmcnt(10)
    v_mfma_f32_32x32x16_bf16 v[64:79], a[48:51], v[164:167], v[64:79]
    buffer_load_dwordx4 v[208:211], v0, s[4:7], s49 offen offset:2048 sc1
    v_mfma_f32_32x32x16_bf16 v[80:95], a[160:163], v[164:167], v[80:95]
    s_waitcnt vmcnt(10)
    v_mfma_f32_32x32x16_bf16 v[64:79], a[76:79], v[168:171], v[64:79]
    buffer_load_dwordx4 v[212:215], v0, s[4:7], s51 offen offset:2048 sc1
    v_mfma_f32_32x32x16_bf16 v[80:95], a[188:191], v[168:171], v[80:95]
    s_waitcnt vmcnt(10)
    v_mfma_f32_32x32x16_bf16 v[64:79], a[104:107], v[172:175], v[64:79]
    buffer_load_dwordx4 v[216:219], v0, s[4:7], s53 offen offset:2048 sc1
    v_mfma_f32_32x32x16_bf16 v[80:95], a[216:219], v[172:175], v[80:95]
    s_waitcnt vmcnt(10)
    v_mfma_f32_32x32x16_bf16 v[64:79], a[24:27], v[176:179], v[64:79]
    buffer_load_dwordx4 v[220:223], v0, s[4:7], s55 offen offset:2048 sc1
    v_mfma_f32_32x32x16_bf16 v[80:95], a[136:139], v[176:179], v[80:95]
    s_waitcnt vmcnt(10)
    v_mfma_f32_32x32x16_bf16 v[64:79], a[52:55], v[180:183], v[64:79]
    v_mfma_f32_32x32x16_bf16 v[80:95], a[164:167], v[180:183], v[80:95]
    s_waitcnt vmcnt(9)
    v_mfma_f32_32x32x16_bf16 v[64:79], a[80:83], v[184:187], v[64:79]
    v_mfma_f32_32x32x16_bf16 v[80:95], a[192:195], v[184:187], v[80:95]
    s_waitcnt vmcnt(8)
    v_mfma_f32_32x32x16_bf16 v[64:79], a[108:111], v[188:191], v[64:79]
    v_mfma_f32_32x32x16_bf16 v[80:95], a[220:223], v[188:191], v[80:95]
    s_waitcnt vmcnt(7)
    v_mfma_f32_32x32x16_bf16 v[96:111], a[20:23], v[192:195], v[96:111]
    v_mfma_f32_32x32x16_bf16 v[112:127], a[132:135], v[192:195], v[112:127]
    s_nop 7
    ds_write_b128 v24, v[72:75]
    s_waitcnt vmcnt(6)
    v_mfma_f32_32x32x16_bf16 v[96:111], a[48:51], v[196:199], v[96:111]
    ds_write_b128 v24, v[76:79] offset:1024
    v_mfma_f32_32x32x16_bf16 v[112:127], a[160:163], v[196:199], v[112:127]
    ds_write_b128 v25, v[80:83]
    s_waitcnt vmcnt(5)
    v_mfma_f32_32x32x16_bf16 v[96:111], a[76:79], v[200:203], v[96:111]
    ds_write_b128 v25, v[84:87] offset:1024
    v_mfma_f32_32x32x16_bf16 v[112:127], a[188:191], v[200:203], v[112:127]
    ds_write_b128 v26, v[88:91]
    s_waitcnt vmcnt(4)
    v_mfma_f32_32x32x16_bf16 v[96:111], a[104:107], v[204:207], v[96:111]
    s_add_u32 m0, s11, 0
    s_add_u32 s37, s34, 67584
    buffer_load_dwordx4 v0, s[4:7], s37 offen lds
    ds_write_b128 v26, v[92:95] offset:1024
    v_mfma_f32_32x32x16_bf16 v[112:127], a[216:219], v[204:207], v[112:127]
    buffer_load_dwordx4 v0, s[4:7], s37 offen offset:1024 lds
    s_waitcnt lgkmcnt(0)
    s_barrier
    ds_read_b128 v[72:75], v27 offset:0
    ds_read_b128 v[76:79], v27 offset:1024
    s_waitcnt vmcnt(5)
    v_mfma_f32_32x32x16_bf16 v[96:111], a[24:27], v[208:211], v[96:111]
    buffer_load_dwordx4 v0, s[4:7], s37 offen offset:2048 lds
    ds_read_b128 v[80:83], v27 offset:2048
    ds_read_b128 v[84:87], v27 offset:3072
    ds_read_b128 v[88:91], v27 offset:4096
    ds_read_b128 v[92:95], v27 offset:5120
    s_waitcnt lgkmcnt(5)
    v_add_f32_e64 v64, v64, v72
    v_mfma_f32_32x32x16_bf16 v[112:127], a[136:139], v[208:211], v[112:127]
    buffer_load_dwordx4 v0, s[4:7], s37 offen offset:3072 lds
    v_add_f32 v65, v65, v73
    v_add_f32 v66, v66, v74
    v_add_f32 v67, v67, v75
    s_waitcnt lgkmcnt(4)
    v_add_f32 v68, v68, v76
    s_waitcnt vmcnt(6)
    v_mfma_f32_32x32x16_bf16 v[96:111], a[52:55], v[212:215], v[96:111]
    s_add_u32 m0, s11, 16384
    s_add_u32 s37, s34, 83968
    buffer_load_dwordx4 v0, s[4:7], s37 offen lds
    v_add_f32 v69, v69, v77
    v_add_f32 v70, v70, v78
    v_add_f32_e64 v71, v71, v79
    v_mfma_f32_32x32x16_bf16 v[112:127], a[164:167], v[212:215], v[112:127]
    buffer_load_dwordx4 v0, s[4:7], s37 offen offset:1024 lds
    s_waitcnt lgkmcnt(3)
    v_add_f32 v64, v64, v80
    v_add_f32 v65, v65, v81
    v_add_f32_e64 v66, v66, v82
    s_waitcnt vmcnt(7)
    v_mfma_f32_32x32x16_bf16 v[96:111], a[80:83], v[216:219], v[96:111]
    buffer_load_dwordx4 v0, s[4:7], s37 offen offset:2048 lds
    v_add_f32 v67, v67, v83
    s_waitcnt lgkmcnt(2)
    v_add_f32 v68, v68, v84
    v_add_f32 v69, v69, v85
    v_add_f32_e64 v70, v70, v86
    v_mfma_f32_32x32x16_bf16 v[112:127], a[192:195], v[216:219], v[112:127]
    buffer_load_dwordx4 v0, s[4:7], s37 offen offset:3072 lds
    v_add_f32 v71, v71, v87
    s_waitcnt lgkmcnt(1)
    v_add_f32 v64, v64, v88
    v_add_f32_e64 v65, v65, v89
    s_waitcnt vmcnt(8)
    v_mfma_f32_32x32x16_bf16 v[96:111], a[108:111], v[220:223], v[96:111]
    s_add_u32 m0, s35, 0
    s_add_u32 s37, s36, 67584
    buffer_load_dword v63, s[4:7], s37 offen lds
    v_add_f32 v66, v66, v90
    v_add_f32 v67, v67, v91
    s_waitcnt lgkmcnt(0)
    v_add_f32_e64 v68, v68, v92
    v_mfma_f32_32x32x16_bf16 v[112:127], a[220:223], v[220:223], v[112:127]
    v_add_f32 v69, v69, v93
    v_add_f32 v70, v70, v94
    v_add_f32 v71, v71, v95
    s_barrier
    v_cvt_pk_bf16_f32 v72, v64, v65
    v_cvt_pk_bf16_f32 v73, v66, v67
    v_cvt_pk_bf16_f32 v74, v68, v69
    v_cvt_pk_bf16_f32 v75, v70, v71
    s_cmp_lg_u32 s8, 0
    s_cbranch_scc1 ss_48
    buffer_store_dwordx4 v[72:75], v0, s[4:7], s69 offen
sb_49:
    v_mov_b64 v[64:65], 0
    v_dot2c_f32_bf16 v64, s80, v72
    ds_write_b128 v24, v[104:107]
    v_dot2c_f32_bf16 v65, v72, v72
    v_dot2c_f32_bf16 v64, s80, v73
    ds_write_b128 v24, v[108:111] offset:1024
    v_dot2c_f32_bf16 v65, v73, v73
    v_dot2c_f32_bf16 v64, s80, v74
    ds_write_b128 v25, v[112:115]
    v_dot2c_f32_bf16 v65, v74, v74
    v_dot2c_f32_bf16 v64, s80, v75
    ds_write_b128 v25, v[116:119] offset:1024
    v_dot2c_f32_bf16 v65, v75, v75
    s_nop 2
    v_permlane32_swap_b32_e64 v64, v65
    ds_write_b128 v26, v[120:123]
    v_add_f32_e64 v64, v64, v65
    ds_write_b128 v26, v[124:127] offset:1024
    s_waitcnt lgkmcnt(0)
    s_barrier
    ds_read_b128 v[104:107], v27 offset:0
    ds_read_b128 v[108:111], v27 offset:1024
    ds_read_b128 v[112:115], v27 offset:2048
    ds_read_b128 v[116:119], v27 offset:3072
    ds_read_b128 v[120:123], v27 offset:4096
    ds_read_b128 v[124:127], v27 offset:5120
    s_waitcnt lgkmcnt(5)
    v_pk_add_f32 v[96:97], v[96:97], v[104:105]
    v_pk_add_f32 v[98:99], v[98:99], v[106:107]
    s_waitcnt lgkmcnt(4)
    v_pk_add_f32 v[100:101], v[100:101], v[108:109]
    v_pk_add_f32 v[102:103], v[102:103], v[110:111]
    s_waitcnt lgkmcnt(3)
    v_pk_add_f32 v[96:97], v[96:97], v[112:113]
    v_pk_add_f32 v[98:99], v[98:99], v[114:115]
    s_waitcnt lgkmcnt(2)
    v_pk_add_f32 v[100:101], v[100:101], v[116:117]
    v_pk_add_f32 v[102:103], v[102:103], v[118:119]
    s_waitcnt lgkmcnt(1)
    v_pk_add_f32 v[96:97], v[96:97], v[120:121]
    v_pk_add_f32 v[98:99], v[98:99], v[122:123]
    s_waitcnt lgkmcnt(0)
    v_pk_add_f32 v[100:101], v[100:101], v[124:125]
    v_pk_add_f32 v[102:103], v[102:103], v[126:127]
    v_cvt_pk_bf16_f32 v104, v96, v97
    v_cvt_pk_bf16_f32 v105, v98, v99
    v_cvt_pk_bf16_f32 v106, v100, v101
    v_cvt_pk_bf16_f32 v107, v102, v103
    s_cmp_lg_u32 s8, 0
    s_cbranch_scc1 ss_50
    buffer_store_dwordx4 v[104:107], v0, s[4:7], s70 offen
sb_51:
    v_mov_b64 v[96:97], 0
    v_dot2c_f32_bf16 v96, s80, v104
    v_dot2c_f32_bf16 v97, v104, v104
    v_dot2c_f32_bf16 v96, s80, v105
    v_dot2c_f32_bf16 v97, v105, v105
    v_dot2c_f32_bf16 v96, s80, v106
    v_dot2c_f32_bf16 v97, v106, v106
    v_dot2c_f32_bf16 v96, s80, v107
    v_dot2c_f32_bf16 v97, v107, v107
    s_nop 2
    v_permlane32_swap_b32 v96, v97
    v_add_f32 v96, v96, v97
    ds_write_b32 v28, v64
    ds_write_b32 v28, v96 offset:256
    s_waitcnt vmcnt(0) lgkmcnt(0)
    s_barrier
    s_cmp_lg_u32 s32, 0
    s_cbranch_scc1 hop_52
    s_mov_b64 exec, 1
    s_cmp_lg_u32 s8, 0
    s_cbranch_scc1 ss_54
    buffer_store_dwordx2 v[16:17], off, s[4:7], s77 offset:256
sb_55:
    s_mov_b64 exec, -1
    s_mov_b32 s74, 0
poll_56:
    buffer_load_dwordx2 v[60:61], v19, s[4:7], 0 offen offset:256 sc1
    s_waitcnt vmcnt(0)
    v_cmp_ne_u64_e64 vcc, s[28:29], v[60:61]
    s_cbranch_vccz polled_57
    s_add_u32 s74, s74, 1
    s_cmp_lt_u32 s74, 0x20000
    s_cbranch_scc1 poll_56
    s_mov_b32 s74, 18
    s_branch L_timeout
polled_57:
hop_52:
    s_cmp_lt_u32 s32, 2
    s_cbranch_scc1 sto_59
    ds_read_b32 v48, v29 offset:0
    ds_read_b32 v49, v29 offset:6144
    ds_read_b32 v50, v29 offset:12288
    ds_read_b32 v51, v29 offset:18432
    s_waitcnt lgkmcnt(2)
    v_add_f32 v48, v48, v49
    s_waitcnt lgkmcnt(0)
    v_add_f32 v50, v50, v51
    v_add_f32 v48, v48, v50
    s_cmp_lg_u32 s8, 0
    s_cbranch_scc1 ss_61
    buffer_store_dword v48, v1, s[4:7], s71 offen
sb_62:
    s_waitcnt vmcnt(0)
    s_mov_b64 exec, 1
    s_cmp_lg_u32 s8, 0
    s_cbranch_scc1 ss_63
    buffer_store_dwordx2 v[16:17], off, s[4:7], s9 offset:448
sb_64:
    s_mov_b64 exec, -1
sto_59:
    s_barrier
L_p1_1:
    buffer_load_dwordx4 v[128:131], v0, s[4:7], s65 offen sc1
    buffer_load_dwordx4 v[132:135], v0, s[4:7], s65 offen offset:1024 sc1
    buffer_load_dwordx4 v[136:139], v0, s[4:7], s65 offen offset:2048 sc1
    buffer_load_dwordx4 v[140:143], v0, s[4:7], s65 offen offset:3072 sc1
    s_add_u32 s93, s65, 4096
    buffer_load_dwordx4 v[144:147], v0, s[4:7], s93 offen sc1
    buffer_load_dwordx4 v[148:151], v0, s[4:7], s93 offen offset:1024 sc1
    buffer_load_dwordx4 v[152:155], v0, s[4:7], s93 offen offset:2048 sc1
    ds_read_b128 a[236:239], v4 offset:0
    ds_read_b128 a[240:243], v5 offset:0
    ds_read_b128 a[244:247], v4 offset:1024
    ds_read_b128 a[248:251], v5 offset:1024
    ds_read_b128 a[252:255], v4 offset:2048
    ds_read_b128 a[224:227], v5 offset:2048
    s_waitcnt vmcnt(6) lgkmcnt(3)
    v_mfma_f32_32x32x16_bf16 v[64:79], a[236:239], v[128:131], 0
    ds_read_b128 a[228:231], v4 offset:3072
    buffer_load_dwordx4 v[156:159], v0, s[4:7], s93 offen offset:3072 sc1
    v_mfma_f32_32x32x16_bf16 v[80:95], a[240:243], v[128:131], 0
    ds_read_b128 a[232:235], v5 offset:3072
    s_add_u32 s93, s65, 8192
    buffer_load_dwordx4 v[160:163], v0, s[4:7], s93 offen sc1
    s_waitcnt vmcnt(7)
    v_mfma_f32_32x32x16_bf16 v[64:79], a[244:247], v[132:135], v[64:79]
    ds_read_b128 a[236:239], v4 offset:4096
    buffer_load_dwordx4 v[164:167], v0, s[4:7], s93 offen offset:1024 sc1
    s_waitcnt lgkmcnt(3)
    v_mfma_f32_32x32x16_bf16 v[80:95], a[248:251], v[132:135], v[80:95]
    ds_read_b128 a[240:243], v5 offset:4096
    buffer_load_dwordx4 v[168:171], v0, s[4:7], s93 offen offset:2048 sc1
    s_waitcnt vmcnt(8)
    v_mfma_f32_32x32x16_bf16 v[64:79], a[252:255], v[136:139], v[64:79]
    ds_read_b128 a[244:247], v4 offset:5120
    buffer_load_dwordx4 v[172:175], v0, s[4:7], s93 offen offset:3072 sc1
    v_mfma_f32_32x32x16_bf16 v[80:95], a[224:227], v[136:139], v[80:95]
    ds_read_b128 a[248:251], v5 offset:5120
    s_add_u32 s93, s65, 12288
    buffer_load_dwordx4 v[176:179], v0, s[4:7], s93 offen sc1
    buffer_load_dwordx2 v[60:61], v62, s[4:7], s10 offen offset:448 sc1
    s_waitcnt vmcnt(10) lgkmcnt(3)
    v_mfma_f32_32x32x16_bf16 v[64:79], a[228:231], v[140:143], v[64:79]
    ds_read_b128 a[252:255], v4 offset:6144
    buffer_load_dwordx4 v[180:183], v0, s[4:7], s93 offen offset:1024 sc1
    v_mfma_f32_32x32x16_bf16 v[80:95], a[232:235], v[140:143], v[80:95]
    ds_read_b128 a[224:227], v5 offset:6144
    buffer_load_dwordx4 v[184:187], v0, s[4:7], s93 offen offset:2048 sc1
    s_waitcnt vmcnt(11)
    v_mfma_f32_32x32x16_bf16 v[64:79], a[236:239], v[144:147], v[64:79]
    ds_read_b128 a[228:231], v4 offset:7168
    buffer_load_dwordx4 v[188:191], v0, s[4:7], s93 offen offset:3072 sc1
    s_waitcnt lgkmcnt(3)
    v_mfma_f32_32x32x16_bf16 v[80:95], a[240:243], v[144:147], v[80:95]
    ds_read_b128 a[232:235], v5 offset:7168
    s_waitcnt vmcnt(11)
    v_mfma_f32_32x32x16_bf16 v[64:79], a[244:247], v[148:151], v[64:79]
    ds_read_b128 a[236:239], v4 offset:8192
    s_add_u32 s93, s65, 16384
    buffer_load_dwordx4 v[192:195], v0, s[4:7], s93 offen sc1
    v_mfma_f32_32x32x16_bf16 v[80:95], a[248:251], v[148:151], v[80:95]
    ds_read_b128 a[240:243], v5 offset:8192
    s_waitcnt vmcnt(11) lgkmcnt(3)
    v_mfma_f32_32x32x16_bf16 v[64:79], a[252:255], v[152:155], v[64:79]
    ds_read_b128 a[244:247], v4 offset:9216
    buffer_load_dwordx4 v[196:199], v0, s[4:7], s93 offen offset:1024 sc1
    v_mfma_f32_32x32x16_bf16 v[80:95], a[224:227], v[152:155], v[80:95]
    ds_read_b128 a[248:251], v5 offset:9216
    s_waitcnt vmcnt(11)
    v_mfma_f32_32x32x16_bf16 v[64:79], a[228:231], v[156:159], v[64:79]
    ds_read_b128 a[252:255], v4 offset:10240
    buffer_load_dwordx4 v[200:203], v0, s[4:7], s93 offen offset:2048 sc1
    s_waitcnt lgkmcnt(3)
    v_mfma_f32_32x32x16_bf16 v[80:95], a[232:235], v[156:159], v[80:95]
    ds_read_b128 a[224:227], v5 offset:10240
    s_waitcnt vmcnt(11)
    v_mfma_f32_32x32x16_bf16 v[64:79], a[236:239], v[160:163], v[64:79]
    ds_read_b128 a[228:231], v4 offset:11264
    buffer_load_dwordx4 v[204:207], v0, s[4:7], s93 offen offset:3072 sc1
    v_mfma_f32_32x32x16_bf16 v[80:95], a[240:243], v[160:163], v[80:95]
    ds_read_b128 a[232:235], v5 offset:11264
    s_waitcnt vmcnt(11) lgkmcnt(3)
    v_mfma_f32_32x32x16_bf16 v[64:79], a[244:247], v[164:167], v[64:79]
    ds_read_b128 a[236:239], v4 offset:12288
    s_add_u32 s93, s65, 20480
    buffer_load_dwordx4 v[208:211], v0, s[4:7], s93 offen sc1
    v_mfma_f32_32x32x16_bf16 v[80:95], a[248:251], v[164:167], v[80:95]
    ds_read_b128 a[240:243], v5 offset:12288
    s_waitcnt vmcnt(11)
    v_mfma_f32_32x32x16_bf16 v[64:79], a[252:255], v[168:171], v[64:79]
    ds_read_b128 a[244:247], v4 offset:13312
    buffer_load_dwordx4 v[212:215], v0, s[4:7], s93 offen offset:1024 sc1
    s_waitcnt lgkmcnt(3)
    v_mfma_f32_32x32x16_bf16 v[80:95], a[224:227], v[168:171], v[80:95]
    ds_read_b128 a[248:251], v5 offset:13312
    s_waitcnt vmcnt(11)
    v_mfma_f32_32x32x16_bf16 v[64:79], a[228:231], v[172:175], v[64:79]
    ds_read_b128 a[252:255], v4 offset:14336
    buffer_load_dwordx4 v[216:219], v0, s[4:7], s93 offen offset:2048 sc1
    v_mfma_f32_32x32x16_bf16 v[80:95], a[232:235], v[172:175], v[80:95]
    ds_read_b128 a[224:227], v5 offset:14336
    s_waitcnt vmcnt(11) lgkmcnt(3)
    v_mfma_f32_32x32x16_bf16 v[64:79], a[236:239], v[176:179], v[64:79]
    ds_read_b128 a[228:231], v4 offset:15360
    buffer_load_dwordx4 v[220:223], v0, s[4:7], s93 offen offset:3072 sc1
    v_mfma_f32_32x32x16_bf16 v[80:95], a[240:243], v[176:179], v[80:95]
    ds_read_b128 a[232:235], v5 offset:15360
    s_waitcnt vmcnt(10)
    v_mfma_f32_32x32x16_bf16 v[64:79], a[244:247], v[180:183], v[64:79]
    ds_read_b128 a[236:239], v4 offset:16384
    v_cmp_ne_u64 vcc, s[28:29], v[60:61]
    s_cbranch_vccnz fstub_65
fback_66:
    buffer_load_dword v24, v1, s[4:7], s66 offen sc1
    buffer_load_dword v25, v1, s[4:7], s66 offen offset:256 sc1
    buffer_load_dword v26, v1, s[4:7], s66 offen offset:512 sc1
    buffer_load_dword v27, v1, s[4:7], s66 offen offset:768 sc1
    s_waitcnt lgkmcnt(3)
    v_mfma_f32_32x32x16_bf16 v[80:95], a[248:251], v[180:183], v[80:95]
    ds_read_b128 a[240:243], v5 offset:16384
    s_waitcnt vmcnt(13)
    v_mfma_f32_32x32x16_bf16 v[64:79], a[252:255], v[184:187], v[64:79]
    ds_read_b128 a[244:247], v4 offset:17408
    buffer_load_dword v28, v1, s[4:7], s66 offen offset:1024 sc1
    buffer_load_dword v29, v1, s[4:7], s66 offen offset:1280 sc1
    buffer_load_dword v30, v1, s[4:7], s66 offen offset:1536 sc1
    buffer_load_dword v31, v1, s[4:7], s66 offen offset:1792 sc1
    v_mfma_f32_32x32x16_bf16 v[80:95], a[224:227], v[184:187], v[80:95]
    ds_read_b128 a[248:251], v5 offset:17408
    s_waitcnt vmcnt(16) lgkmcnt(3)
    v_mfma_f32_32x32x16_bf16 v[64:79], a[228:231], v[188:191], v[64:79]
    s_add_u32 s93, s65, 24576
    buffer_load_dwordx4 v[224:227], v0, s[4:7], s93 offen sc1
    v_mfma_f32_32x32x16_bf16 v[80:95], a[232:235], v[188:191], v[80:95]
    s_waitcnt lgkmcnt(0)
    s_barrier
    ds_read_b128 a[252:255], v4 offset:18432
    ds_read_b128 a[224:227], v5 offset:18432
    s_waitcnt vmcnt(16)
    v_mfma_f32_32x32x16_bf16 v[64:79], a[236:239], v[192:195], v[64:79]
    ds_read_b128 a[228:231], v4 offset:19456
    buffer_load_dwordx4 v[228:231], v0, s[4:7], s93 offen offset:1024 sc1
    v_mfma_f32_32x32x16_bf16 v[80:95], a[240:243], v[192:195], v[80:95]
    ds_read_b128 a[232:235], v5 offset:19456
    s_waitcnt vmcnt(16)
    v_mfma_f32_32x32x16_bf16 v[64:79], a[244:247], v[196:199], v[64:79]
    ds_read_b128 a[236:239], v4 offset:20480
    buffer_load_dwordx4 v[232:235], v0, s[4:7], s93 offen offset:2048 sc1
    v_mfma_f32_32x32x16_bf16 v[80:95], a[248:251], v[196:199], v[80:95]
    ds_read_b128 a[240:243], v5 offset:20480
    s_waitcnt vmcnt(16) lgkmcnt(3)
    v_mfma_f32_32x32x16_bf16 v[64:79], a[252:255], v[200:203], v[64:79]
    ds_read_b128 a[244:247], v4 offset:21504
    buffer_load_dwordx4 v[236:239], v0, s[4:7], s93 offen offset:3072 sc1
    v_mfma_f32_32x32x16_bf16 v[80:95], a[224:227], v[200:203], v[80:95]
    ds_read_b128 a[248:251], v5 offset:21504
    s_waitcnt vmcnt(16)
    v_mfma_f32_32x32x16_bf16 v[64:79], a[228:231], v[204:207], v[64:79]
    ds_read_b128 a[252:255], v4 offset:22528
    s_add_u32 s93, s65, 28672
    buffer_load_dwordx4 v[240:243], v0, s[4:7], s93 offen sc1
    s_waitcnt lgkmcnt(3)
    v_mfma_f32_32x32x16_bf16 v[80:95], a[232:235], v[204:207], v[80:95]
    ds_read_b128 a[224:227], v5 offset:22528
    s_waitcnt vmcnt(16)
    v_mfma_f32_32x32x16_bf16 v[64:79], a[236:239], v[208:211], v[64:79]
    ds_read_b128 a[228:231], v4 offset:23552
    buffer_load_dwordx4 v[244:247], v0, s[4:7], s93 offen offset:1024 sc1
    v_mfma_f32_32x32x16_bf16 v[80:95], a[240:243], v[208:211], v[80:95]
    ds_read_b128 a[232:235], v5 offset:23552
    s_waitcnt vmcnt(16) lgkmcnt(3)
    v_mfma_f32_32x32x16_bf16 v[64:79], a[244:247], v[212:215], v[64:79]
    ds_read_b128 a[236:239], v4 offset:24576
    buffer_load_dwordx4 v[248:251], v0, s[4:7], s93 offen offset:2048 sc1
    v_mfma_f32_32x32x16_bf16 v[80:95], a[248:251], v[212:215], v[80:95]
    ds_read_b128 a[240:243], v5 offset:24576
    s_waitcnt vmcnt(16)
    v_mfma_f32_32x32x16_bf16 v[64:79], a[252:255], v[216:219], v[64:79]
    ds_read_b128 a[244:247], v4 offset:25600
    buffer_load_dwordx4 v[252:255], v0, s[4:7], s93 offen offset:3072 sc1
    s_waitcnt lgkmcnt(3)
    v_mfma_f32_32x32x16_bf16 v[80:95], a[224:227], v[216:219], v[80:95]
    ds_read_b128 a[248:251], v5 offset:25600
    s_waitcnt vmcnt(16)
    v_mfma_f32_32x32x16_bf16 v[64:79], a[228:231], v[220:223], v[64:79]
    ds_read_b128 a[252:255], v4 offset:26624
    v_mfma_f32_32x32x16_bf16 v[80:95], a[232:235], v[220:223], v[80:95]
    ds_read_b128 a[224:227], v5 offset:26624
    s_waitcnt vmcnt(7) lgkmcnt(3)
    v_mfma_f32_32x32x16_bf16 v[64:79], a[236:239], v[224:227], v[64:79]
    ds_read_b128 a[228:231], v4 offset:27648
    v_mfma_f32_32x32x16_bf16 v[80:95], a[240:243], v[224:227], v[80:95]
    ds_read_b128 a[232:235], v5 offset:27648
    v_add_f32 v24, v24, v25
    v_add_f32 v26, v26, v27
    v_add_f32 v28, v28, v29
    v_add_f32_e64 v30, v30, v31
    s_waitcnt vmcnt(6)
    v_mfma_f32_32x32x16_bf16 v[64:79], a[244:247], v[228:231], v[64:79]
    ds_read_b128 a[236:239], v4 offset:28672
    v_add_f32 v24, v24, v26
    v_add_f32 v28, v28, v30
    v_add_f32_e64 v24, v24, v28
    v_mul_f32 v24, 0x3b000000, v24
    s_waitcnt lgkmcnt(3)
    v_mfma_f32_32x32x16_bf16 v[80:95], a[248:251], v[228:231], v[80:95]
    ds_read_b128 a[240:243], v5 offset:28672
    v_mov_b32 v25, v24
    s_nop 1
    v_permlane32_swap_b32_e64 v24, v25
    s_waitcnt vmcnt(5)
    v_mfma_f32_32x32x16_bf16 v[64:79], a[252:255], v[232:235], v[64:79]
    ds_read_b128 a[244:247], v4 offset:29696
    v_fma_f32 v25, -v24, v24, v25
    v_max_f32_e64 v25, 0, v25
    v_add_f32 v46, 0x3727c5ac, v25
    v_rsq_f32_e64 v47, v46
    v_mfma_f32_32x32x16_bf16 v[80:95], a[224:227], v[232:235], v[80:95]
    ds_read_b128 a[248:251], v5 offset:29696
    v_cvt_pk_bf16_f32 v40, -v24, -v24
    v_mov_b32 v41, v40
    v_mov_b32 v42, v40
    v_mov_b32 v43, v40
    s_waitcnt vmcnt(4) lgkmcnt(3)
    v_mfma_f32_32x32x16_bf16 v[64:79], a[228:231], v[236:239], v[64:79]
    ds_read_b128 a[252:255], v4 offset:30720
    s_add_u32 m0, s11, 67584
    s_add_u32 s37, s34, 270336
    buffer_load_dwordx4 v0, s[4:7], s37 offen lds
    v_mul_f32 v44, 0x3fb8aa3b, v47
    v_mfma_f32_32x32x16_bf16 v[80:95], a[232:235], v[236:239], v[80:95]
    ds_read_b128 a[224:227], v5 offset:30720
    buffer_load_dwordx4 v0, s[4:7], s37 offen offset:1024 lds
    s_waitcnt vmcnt(5)
    v_mfma_f32_32x32x16_bf16 v[64:79], a[236:239], v[240:243], v[64:79]
    ds_read_b128 a[228:231], v4 offset:32768
    buffer_load_dwordx4 v0, s[4:7], s37 offen offset:2048 lds
    s_waitcnt lgkmcnt(3)
    v_mfma_f32_32x32x16_bf16 v[80:95], a[240:243], v[240:243], v[80:95]
    ds_read_b128 a[232:235], v5 offset:32768
    buffer_load_dwordx4 v0, s[4:7], s37 offen offset:3072 lds
    s_waitcnt vmcnt(6)
    v_mfma_f32_32x32x16_bf16 v[64:79], a[244:247], v[244:247], v[64:79]
    ds_read_b128 a[236:239], v4 offset:31744
    s_add_u32 m0, s11, 101376
    s_add_u32 s37, s34, 236544
    buffer_load_dwordx4 v0, s[4:7], s37 offen lds
    v_mfma_f32_32x32x16_bf16 v[80:95], a[248:251], v[244:247], v[80:95]
    ds_read_b128 a[240:243], v5 offset:31744
    buffer_load_dwordx4 v0, s[4:7], s37 offen offset:1024 lds
    s_waitcnt vmcnt(7) lgkmcnt(3)
    v_mfma_f32_32x32x16_bf16 v[64:79], a[252:255], v[248:251], v[64:79]
    buffer_load_dwordx4 v0, s[4:7], s37 offen offset:2048 lds
    v_mfma_f32_32x32x16_bf16 v[80:95], a[224:227], v[248:251], v[80:95]
    buffer_load_dwordx4 v0, s[4:7], s37 offen offset:3072 lds
    v_mfma_f32_32x32x16_bf16 v[64:79], a[228:231], v[40:43], v[64:79]
    s_and_b32 s39, s30, 1
    s_lshl_b32 s39, s39, 1
    s_lshr_b32 s62, s31, 3
    s_add_u32 s39, s39, s62
    s_lshl_b32 s39, s39, 14
    s_lshl_b32 s62, s95, 16
    s_add_u32 s39, s39, s62
    s_add_u32 s39, s39, s11
    s_add_u32 s39, s39, 0x680000
    buffer_load_dword v21, v14, s[4:7], s39 offen
    s_waitcnt lgkmcnt(2)
    v_mfma_f32_32x32x16_bf16 v[80:95], a[232:235], v[40:43], v[80:95]
    ds_read_b128 a[244:247], v20 offset:25600
    ds_read_b128 a[248:251], v20 offset:26624
    s_waitcnt vmcnt(9) lgkmcnt(3)
    v_mfma_f32_32x32x16_bf16 v[64:79], a[236:239], v[252:255], v[64:79]
    s_waitcnt lgkmcnt(2)
    v_mfma_f32_32x32x16_bf16 v[80:95], a[240:243], v[252:255], v[80:95]
    s_nop 9
    v_cvt_pk_bf16_f32 v48, v64, v65
    v_cvt_pk_bf16_f32 v49, v66, v67
    v_cvt_pk_bf16_f32 v50, v68, v69
    v_cvt_pk_bf16_f32 v51, v70, v71
    v_cvt_pk_bf16_f32 v52, v72, v73
    v_cvt_pk_bf16_f32 v53, v74, v75
    v_cvt_pk_bf16_f32 v54, v76, v77
    v_cvt_pk_bf16_f32 v55, v78, v79
    s_waitcnt lgkmcnt(1)
    v_mfma_f32_32x32x16_bf16 v[96:111], a[244:247], v[48:51], 0
    s_waitcnt lgkmcnt(0)
    v_mfma_f32_32x32x16_bf16 v[112:127], a[248:251], v[52:55], 0
    v_mul_f32 v80, v80, v47
    v_mul_f32 v81, v81, v47
    v_mul_f32 v82, v82, v47
    v_mul_f32 v83, v83, v47
    v_mul_f32 v84, v84, v47
    v_mul_f32 v85, v85, v47
    v_mul_f32 v86, v86, v47
    v_mul_f32 v87, v87, v47
    v_mul_f32 v88, v88, v47
    v_mul_f32 v89, v89, v47
    v_mul_f32 v90, v90, v47
    v_mul_f32 v91, v91, v47
    v_mul_f32 v92, v92, v47
    v_mul_f32 v93, v93, v47
    v_mul_f32 v94, v94, v47
    v_mul_f32 v95, v95, v47
    v_cvt_pk_bf16_f32 v80, v80, v81
    v_cvt_pk_bf16_f32 v81, v82, v83
    ds_write_b64 v6, v[80:81] offset:128
    v_cvt_pk_bf16_f32 v84, v84, v85
    v_cvt_pk_bf16_f32 v85, v86, v87
    ds_write_b64 v6, v[84:85] offset:144
    v_cvt_pk_bf16_f32 v88, v88, v89
    v_cvt_pk_bf16_f32 v89, v90, v91
    ds_write_b64 v6, v[88:89] offset:160
    v_cvt_pk_bf16_f32 v92, v92, v93
    v_cvt_pk_bf16_f32 v93, v94, v95
    ds_write_b64 v6, v[92:93] offset:176
    v_max3_f32 v56, v96, v97, v98
    v_max3_f32 v48, v99, v100, v101
    v_max3_f32 v56, v102, v103, v56
    v_max_f32_e64 v56, v56, v48
    v_max3_f32 v57, v104, v105, v106
    v_max3_f32 v49, v107, v108, v109
    v_max3_f32 v57, v110, v111, v57
    v_max_f32_e64 v57, v57, v49
    v_max3_f32 v58, v112, v113, v114
    v_max3_f32 v50, v115, v116, v117
    v_max3_f32 v58, v118, v119, v58
    v_max_f32_e64 v58, v58, v50
    v_max3_f32 v59, v120, v121, v122
    v_max3_f32 v51, v123, v124, v125
    v_max3_f32 v59, v126, v127, v59
    v_max_f32 v59, v59, v51
    v_permlane32_swap_b32 v56, v57
    s_nop 0
    v_permlane32_swap_b32 v58, v59
    v_max_f32 v56, v56, v57
    v_max_f32 v58, v58, v59
    v_mul_f32 v57, v56, v44
    v_mul_f32 v56, v56, v44
    v_mul_f32 v59, v58, v44
    v_mul_f32 v58, v58, v44
    v_permlane32_swap_b32 v56, v57
    s_nop 0
    v_permlane32_swap_b32_e64 v58, v59
    v_pk_fma_f32 v[96:97], v[96:97], v[44:45], v[56:57] op_sel:[0,0,0] op_sel_hi:[1,0,0] neg_lo:[0,0,1] neg_hi:[0,0,1]
    v_pk_fma_f32 v[98:99], v[98:99], v[44:45], v[56:57] op_sel:[0,0,0] op_sel_hi:[1,0,0] neg_lo:[0,0,1] neg_hi:[0,0,1]
    v_pk_fma_f32 v[100:101], v[100:101], v[44:45], v[56:57] op_sel:[0,0,0] op_sel_hi:[1,0,0] neg_lo:[0,0,1] neg_hi:[0,0,1]
    v_pk_fma_f32 v[102:103], v[102:103], v[44:45], v[56:57] op_sel:[0,0,0] op_sel_hi:[1,0,0] neg_lo:[0,0,1] neg_hi:[0,0,1]
    v_pk_fma_f32 v[104:105], v[104:105], v[44:45], v[56:57] op_sel:[0,0,1] op_sel_hi:[1,0,1] neg_lo:[0,0,1] neg_hi:[0,0,1]
    v_pk_fma_f32 v[106:107], v[106:107], v[44:45], v[56:57] op_sel:[0,0,1] op_sel_hi:[1,0,1] neg_lo:[0,0,1] neg_hi:[0,0,1]
    v_pk_fma_f32 v[108:109], v[108:109], v[44:45], v[56:57] op_sel:[0,0,1] op_sel_hi:[1,0,1] neg_lo:[0,0,1] neg_hi:[0,0,1]
    v_pk_fma_f32 v[110:111], v[110:111], v[44:45], v[56:57] op_sel:[0,0,1] op_sel_hi:[1,0,1] neg_lo:[0,0,1] neg_hi:[0,0,1]
    v_pk_fma_f32 v[112:113], v[112:113], v[44:45], v[58:59] op_sel:[0,0,0] op_sel_hi:[1,0,0] neg_lo:[0,0,1] neg_hi:[0,0,1]
    v_pk_fma_f32 v[114:115], v[114:115], v[44:45], v[58:59] op_sel:[0,0,0] op_sel_hi:[1,0,0] neg_lo:[0,0,1] neg_hi:[0,0,1]
    v_pk_fma_f32 v[116:117], v[116:117], v[44:45], v[58:59] op_sel:[0,0,0] op_sel_hi:[1,0,0] neg_lo:[0,0,1] neg_hi:[0,0,1]
    v_pk_fma_f32 v[118:119], v[118:119], v[44:45], v[58:59] op_sel:[0,0,0] op_sel_hi:[1,0,0] neg_lo:[0,0,1] neg_hi:[0,0,1]
    v_pk_fma_f32 v[120:121], v[120:121], v[44:45], v[58:59] op_sel:[0,0,1] op_sel_hi:[1,0,1] neg_lo:[0,0,1] neg_hi:[0,0,1]
    v_pk_fma_f32 v[122:123], v[122:123], v[44:45], v[58:59] op_sel:[0,0,1] op_sel_hi:[1,0,1] neg_lo:[0,0,1] neg_hi:[0,0,1]
    v_pk_fma_f32 v[124:125], v[124:125], v[44:45], v[58:59] op_sel:[0,0,1] op_sel_hi:[1,0,1] neg_lo:[0,0,1] neg_hi:[0,0,1]
    v_pk_fma_f32 v[126:127], v[126:127], v[44:45], v[58:59] op_sel:[0,0,1] op_sel_hi:[1,0,1] neg_lo:[0,0,1] neg_hi:[0,0,1]
    v_exp_f32 v96, v96
    v_exp_f32 v97, v97
    v_exp_f32 v98, v98
    v_exp_f32 v99, v99
    v_exp_f32 v100, v100
    v_exp_f32 v101, v101
    v_exp_f32 v102, v102
    v_exp_f32 v103, v103
    v_exp_f32 v104, v104
    v_exp_f32 v105, v105
    v_exp_f32 v106, v106
    v_exp_f32 v107, v107
    v_exp_f32 v108, v108
    v_exp_f32 v109, v109
    v_exp_f32 v110, v110
    v_exp_f32 v111, v111
    v_exp_f32 v112, v112
    v_exp_f32 v113, v113
    v_exp_f32 v114, v114
    v_exp_f32 v115, v115
    s_mov_b64 exec, 0xffff0000
    buffer_load_dword v21, v22, s[4:7], 0 offen
    s_mov_b64 exec, -1
    v_exp_f32 v116, v116
    v_exp_f32 v117, v117
    v_exp_f32 v118, v118
    v_exp_f32 v119, v119
    v_exp_f32 v120, v120
    v_exp_f32 v121, v121
    v_exp_f32 v122, v122
    v_exp_f32 v123, v123
    v_exp_f32 v124, v124
    v_exp_f32 v125, v125
    v_exp_f32 v126, v126
    v_exp_f32_e64 v127, v127
    v_pk_add_f32 v[48:49], v[96:97], v[98:99]
    v_pk_add_f32 v[48:49], v[48:49], v[100:101]
    v_pk_add_f32 v[48:49], v[48:49], v[102:103]
    v_add_f32_e64 v56, v48, v49
    v_pk_add_f32 v[50:51], v[104:105], v[106:107]
    v_pk_add_f32 v[50:51], v[50:51], v[108:109]
    v_pk_add_f32 v[50:51], v[50:51], v[110:111]
    v_add_f32_e64 v57, v50, v51
    v_pk_add_f32 v[52:53], v[112:113], v[114:115]
    v_pk_add_f32 v[52:53], v[52:53], v[116:117]
    v_pk_add_f32 v[52:53], v[52:53], v[118:119]
    v_add_f32_e64 v58, v52, v53
    v_pk_add_f32 v[54:55], v[120:121], v[122:123]
    v_pk_add_f32 v[54:55], v[54:55], v[124:125]
    v_pk_add_f32 v[54:55], v[54:55], v[126:127]
    v_add_f32 v59, v54, v55
    v_permlane32_swap_b32 v56, v57
    s_nop 0
    v_permlane32_swap_b32 v58, v59
    v_add_f32 v56, v56, v57
    v_add_f32 v58, v58, v59
    v_rcp_f32 v56, v56
    v_rcp_f32 v58, v58
    v_mov_b32 v57, v56
    v_mov_b32 v59, v58
    s_nop 0
    v_permlane32_swap_b32 v56, v57
    v_permlane32_swap_b32_e64 v58, v59
    v_pk_mul_f32 v[96:97], v[96:97], v[56:57] op_sel:[0,0] op_sel_hi:[1,0]
    v_pk_mul_f32 v[98:99], v[98:99], v[56:57] op_sel:[0,0] op_sel_hi:[1,0]
    v_pk_mul_f32 v[100:101], v[100:101], v[56:57] op_sel:[0,0] op_sel_hi:[1,0]
    v_pk_mul_f32 v[102:103], v[102:103], v[56:57] op_sel:[0,0] op_sel_hi:[1,0]
    v_pk_mul_f32 v[104:105], v[104:105], v[56:57] op_sel:[0,1] op_sel_hi:[1,1]
    v_pk_mul_f32 v[106:107], v[106:107], v[56:57] op_sel:[0,1] op_sel_hi:[1,1]
    v_pk_mul_f32 v[108:109], v[108:109], v[56:57] op_sel:[0,1] op_sel_hi:[1,1]
    v_pk_mul_f32 v[110:111], v[110:111], v[56:57] op_sel:[0,1] op_sel_hi:[1,1]
    v_cvt_pk_bf16_f32 v96, v96, v97
    v_cvt_pk_bf16_f32 v97, v98, v99
    ds_write_b64 v6, v[96:97] offset:0
    v_cvt_pk_bf16_f32 v100, v100, v101
    v_cvt_pk_bf16_f32 v101, v102, v103
    ds_write_b64 v6, v[100:101] offset:16
    v_cvt_pk_bf16_f32 v104, v104, v105
    v_cvt_pk_bf16_f32 v105, v106, v107
    ds_write_b64 v6, v[104:105] offset:32
    v_cvt_pk_bf16_f32 v108, v108, v109
    v_cvt_pk_bf16_f32 v109, v110, v111
    ds_write_b64 v6, v[108:109] offset:48
    v_pk_mul_f32 v[112:113], v[112:113], v[58:59] op_sel:[0,0] op_sel_hi:[1,0]
    v_pk_mul_f32 v[114:115], v[114:115], v[58:59] op_sel:[0,0] op_sel_hi:[1,0]
    v_pk_mul_f32 v[116:117], v[116:117], v[58:59] op_sel:[0,0] op_sel_hi:[1,0]
    v_pk_mul_f32 v[118:119], v[118:119], v[58:59] op_sel:[0,0] op_sel_hi:[1,0]
    v_pk_mul_f32 v[120:121], v[120:121], v[58:59] op_sel:[0,1] op_sel_hi:[1,1]
    v_pk_mul_f32 v[122:123], v[122:123], v[58:59] op_sel:[0,1] op_sel_hi:[1,1]
    v_pk_mul_f32 v[124:125], v[124:125], v[58:59] op_sel:[0,1] op_sel_hi:[1,1]
    v_pk_mul_f32 v[126:127], v[126:127], v[58:59] op_sel:[0,1] op_sel_hi:[1,1]
    v_cvt_pk_bf16_f32 v112, v112, v113
    v_cvt_pk_bf16_f32 v113, v114, v115
    ds_write_b64 v6, v[112:113] offset:64
    v_cvt_pk_bf16_f32 v116, v116, v117
    v_cvt_pk_bf16_f32 v117, v118, v119
    ds_write_b64 v6, v[116:117] offset:80
    v_cvt_pk_bf16_f32 v120, v120, v121
    v_cvt_pk_bf16_f32 v121, v122, v123
    ds_write_b64 v6, v[120:121] offset:96
    v_cvt_pk_bf16_f32 v124, v124, v125
    v_cvt_pk_bf16_f32 v125, v126, v127
    ds_write_b64 v6, v[124:125] offset:112
    v_mov_b32 v48, s80
    v_mov_b32 v49, s80
    v_mov_b32 v50, s80
    v_mov_b32 v51, s80
    s_waitcnt lgkmcnt(0)
    s_barrier
    ds_read_b64_tr_b16 v[80:81], v7 offset:0
    ds_read_b64_tr_b16 v[82:83], v7 offset:800
    ds_read_b64_tr_b16 v[96:97], v8 offset:0
    ds_read_b64_tr_b16 v[98:99], v8 offset:800
    ds_read_b64_tr_b16 v[84:85], v7 offset:6400
    ds_read_b64_tr_b16 v[86:87], v7 offset:7200
    ds_read_b64_tr_b16 v[100:101], v8 offset:6400
    ds_read_b64_tr_b16 v[102:103], v8 offset:7200
    ds_read_b64_tr_b16 v[88:89], v7 offset:12800
    ds_read_b64_tr_b16 v[90:91], v7 offset:13600
    ds_read_b64_tr_b16 v[104:105], v8 offset:12800
    ds_read_b64_tr_b16 v[106:107], v8 offset:13600
    ds_read_b64_tr_b16 v[92:93], v7 offset:19200
    ds_read_b64_tr_b16 v[94:95], v7 offset:20000
    ds_read_b64_tr_b16 v[108:109], v8 offset:19200
    ds_read_b64_tr_b16 v[110:111], v8 offset:20000
    s_add_u32 s76, s76, 655360
    s_waitcnt lgkmcnt(12)
    v_mfma_f32_16x16x32_bf16 v[64:67], v[80:83], v[96:99], 0
    v_mfma_f32_16x16x32_bf16 v[68:71], v[80:83], v[48:51], 0
    s_waitcnt lgkmcnt(8)
    v_mfma_f32_16x16x32_bf16 v[64:67], v[84:87], v[100:103], v[64:67]
    v_mfma_f32_16x16x32_bf16 v[68:71], v[84:87], v[48:51], v[68:71]
    s_waitcnt lgkmcnt(4)
    v_mfma_f32_16x16x32_bf16 v[64:67], v[88:91], v[104:107], v[64:67]
    v_mfma_f32_16x16x32_bf16 v[68:71], v[88:91], v[48:51], v[68:71]
    s_waitcnt lgkmcnt(0)
    v_mfma_f32_16x16x32_bf16 v[64:67], v[92:95], v[108:111], v[64:67]
    v_mfma_f32_16x16x32_bf16 v[68:71], v[92:95], v[48:51], v[68:71]
    s_nop 6
    v_cvt_pk_bf16_f32 v72, v64, v65
    v_cvt_pk_bf16_f32 v73, v66, v67
    v_min_u32 v72, -2, v72
    buffer_store_dwordx2 v[72:73], v9, s[4:7], s76 offen sc1
    v_cvt_pk_bf16_f32 v74, v68, v69
    v_cvt_pk_bf16_f32 v75, v70, v71
    v_min_u32_e64 v74, -2, v74
    buffer_store_dwordx2 v[74:75], v10, s[4:7], s76 offen sc1
    s_barrier
    ds_read_b128 a[252:255], v2 offset:0
    ds_read_b128 a[224:227], v2 offset:1024
    ds_read_b128 a[228:231], v2 offset:2048
    ds_read_b128 a[232:235], v2 offset:3072
    ds_read_b128 a[236:239], v2 offset:4096
    ds_read_b128 a[240:243], v2 offset:5120
    s_waitcnt lgkmcnt(3)
    v_mfma_f32_32x32x16_bf16 v[80:95], a[252:255], v[128:131], 0
    ds_read_b128 a[244:247], v2 offset:6144
    v_mfma_f32_32x32x16_bf16 v[80:95], a[224:227], v[132:135], v[80:95]
    ds_read_b128 a[248:251], v2 offset:7168
    buffer_load_dwordx4 v[128:131], v13, s[4:7], s81 offen
    v_mfma_f32_32x32x16_bf16 v[80:95], a[228:231], v[136:139], v[80:95]
    ds_read_b128 a[252:255], v2 offset:8192
    s_waitcnt lgkmcnt(3)
    v_mfma_f32_32x32x16_bf16 v[80:95], a[232:235], v[140:143], v[80:95]
    ds_read_b128 a[224:227], v2 offset:9216
    buffer_load_dwordx4 v[132:135], v13, s[4:7], s81 offen offset:1024
    v_mfma_f32_32x32x16_bf16 v[80:95], a[236:239], v[144:147], v[80:95]
    ds_read_b128 a[228:231], v2 offset:10240
    v_mfma_f32_32x32x16_bf16 v[80:95], a[240:243], v[148:151], v[80:95]
    ds_read_b128 a[232:235], v2 offset:11264
    buffer_load_dwordx4 v[136:139], v13, s[4:7], s81 offen offset:2048
    s_waitcnt lgkmcnt(3)
    v_mfma_f32_32x32x16_bf16 v[80:95], a[244:247], v[152:155], v[80:95]
    ds_read_b128 a[236:239], v2 offset:12288
    v_mfma_f32_32x32x16_bf16 v[80:95], a[248:251], v[156:159], v[80:95]
    ds_read_b128 a[240:243], v2 offset:13312
    buffer_load_dwordx4 v[140:143], v13, s[4:7], s81 offen offset:3072
    v_mfma_f32_32x32x16_bf16 v[80:95], a[252:255], v[160:163], v[80:95]
    ds_read_b128 a[244:247], v2 offset:14336
    s_waitcnt lgkmcnt(3)
    v_mfma_f32_32x32x16_bf16 v[80:95], a[224:227], v[164:167], v[80:95]
    ds_read_b128 a[248:251], v2 offset:15360
    s_add_u32 s93, s81, 4096
    buffer_load_dwordx4 v[144:147], v13, s[4:7], s93 offen
    v_mfma_f32_32x32x16_bf16 v[80:95], a[228:231], v[168:171], v[80:95]
    ds_read_b128 a[252:255], v2 offset:16384
    v_mfma_f32_32x32x16_bf16 v[80:95], a[232:235], v[172:175], v[80:95]
    ds_read_b128 a[224:227], v2 offset:17408
    buffer_load_dwordx4 v[148:151], v13, s[4:7], s93 offen offset:1024
    s_waitcnt lgkmcnt(3)
    v_mfma_f32_32x32x16_bf16 v[80:95], a[236:239], v[176:179], v[80:95]
    ds_read_b128 a[228:231], v2 offset:18432
    v_mfma_f32_32x32x16_bf16 v[80:95], a[240:243], v[180:183], v[80:95]
    ds_read_b128 a[232:235], v2 offset:19456
    buffer_load_dwordx4 v[152:155], v13, s[4:7], s93 offen offset:2048
    v_mfma_f32_32x32x16_bf16 v[80:95], a[244:247], v[184:187], v[80:95]
    ds_read_b128 a[236:239], v2 offset:20480
    s_waitcnt lgkmcnt(3)
    v_mfma_f32_32x32x16_bf16 v[80:95], a[248:251], v[188:191], v[80:95]
    ds_read_b128 a[240:243], v2 offset:21504
    buffer_load_dwordx4 v[156:159], v13, s[4:7], s93 offen offset:3072
    v_mfma_f32_32x32x16_bf16 v[80:95], a[252:255], v[192:195], v[80:95]
    ds_read_b128 a[244:247], v2 offset:22528
    v_mfma_f32_32x32x16_bf16 v[80:95], a[224:227], v[196:199], v[80:95]
    ds_read_b128 a[248:251], v2 offset:23552
    buffer_load_dwordx4 v[160:163], v13, s[4:7], s82 offen
    s_waitcnt lgkmcnt(3)
    v_mfma_f32_32x32x16_bf16 v[80:95], a[228:231], v[200:203], v[80:95]
    ds_read_b128 a[252:255], v2 offset:24576
    v_mfma_f32_32x32x16_bf16 v[80:95], a[232:235], v[204:207], v[80:95]
    ds_read_b128 a[224:227], v2 offset:25600
    buffer_load_dwordx4 v[164:167], v13, s[4:7], s82 offen offset:1024
    v_mfma_f32_32x32x16_bf16 v[80:95], a[236:239], v[208:211], v[80:95]
    ds_read_b128 a[228:231], v2 offset:26624
    s_waitcnt lgkmcnt(3)
    v_mfma_f32_32x32x16_bf16 v[80:95], a[240:243], v[212:215], v[80:95]
    ds_read_b128 a[232:235], v2 offset:27648
    buffer_load_dwordx4 v[168:171], v13, s[4:7], s82 offen offset:2048
    v_mfma_f32_32x32x16_bf16 v[80:95], a[244:247], v[216:219], v[80:95]
    ds_read_b128 a[236:239], v2 offset:28672
    v_mfma_f32_32x32x16_bf16 v[80:95], a[248:251], v[220:223], v[80:95]
    ds_read_b128 a[240:243], v2 offset:29696
    buffer_load_dwordx4 v[172:175], v13, s[4:7], s82 offen offset:3072
    s_waitcnt lgkmcnt(3)
    v_mfma_f32_32x32x16_bf16 v[80:95], a[252:255], v[224:227], v[80:95]
    ds_read_b128 a[244:247], v2 offset:30720
    v_mfma_f32_32x32x16_bf16 v[80:95], a[224:227], v[228:231], v[80:95]
    ds_read_b128 a[248:251], v2 offset:31744
    s_add_u32 s93, s82, 4096
    buffer_load_dwordx4 v[176:179], v13, s[4:7], s93 offen
    v_mfma_f32_32x32x16_bf16 v[80:95], a[228:231], v[232:235], v[80:95]
    ds_read_b128 a[252:255], v2 offset:32768
    s_waitcnt lgkmcnt(3)
    v_mfma_f32_32x32x16_bf16 v[80:95], a[232:235], v[236:239], v[80:95]
    buffer_load_dwordx4 v[180:183], v13, s[4:7], s93 offen offset:1024
    v_mfma_f32_32x32x16_bf16 v[80:95], a[236:239], v[240:243], v[80:95]
    v_mfma_f32_32x32x16_bf16 v[80:95], a[240:243], v[244:247], v[80:95]
    buffer_load_dwordx4 v[184:187], v13, s[4:7], s93 offen offset:2048
    s_waitcnt lgkmcnt(2)
    v_mfma_f32_32x32x16_bf16 v[80:95], a[244:247], v[248:251], v[80:95]
    ds_read_b128 a[224:227], v20 offset:25600
    ds_read_b128 a[228:231], v20 offset:26624
    s_waitcnt lgkmcnt(3)
    v_mfma_f32_32x32x16_bf16 v[80:95], a[248:251], v[252:255], v[80:95]
    buffer_load_dwordx4 v[188:191], v13, s[4:7], s93 offen offset:3072
    s_waitcnt lgkmcnt(2)
    v_mfma_f32_32x32x16_bf16 v[80:95], a[252:255], v[40:43], v[80:95]
    s_nop 11
    v_cvt_pk_bf16_f32 v48, v80, v81
    s_lshr_b32 s39, s2, 3
    s_lshl_b32 s39, s39, 2
    s_add_u32 s39, s39, s32
    s_lshl_b32 s39, s39, 8
    s_add_u32 s39, s39, L_p3_1-interleave_layers__linear_kernel_hedgehog__geglu_ffn__prompt_kernel
    v_and_b32 v18, 0x80, v0
    v_add_u32 v18, s39, v18
    v_min_u32 v18, L_codeend-interleave_layers__linear_kernel_hedgehog__geglu_ffn__prompt_kernel-4, v18
    global_load_dword v21, v18, s[12:13]
    v_cvt_pk_bf16_f32 v49, v82, v83
    v_cvt_pk_bf16_f32 v50, v84, v85
    v_cvt_pk_bf16_f32 v51, v86, v87
    v_cvt_pk_bf16_f32 v52, v88, v89
    v_cvt_pk_bf16_f32 v53, v90, v91
    v_cvt_pk_bf16_f32 v54, v92, v93
    v_cvt_pk_bf16_f32 v55, v94, v95
    s_waitcnt lgkmcnt(1)
    v_mfma_f32_32x32x16_bf16 v[96:111], a[224:227], v[48:51], 0
    s_waitcnt lgkmcnt(0)
    v_mfma_f32_32x32x16_bf16 v[112:127], a[228:231], v[52:55], 0
    s_nop 9
    v_max3_f32 v56, v96, v97, v98
    buffer_load_dwordx4 v[192:195], v0, s[4:7], s76 offen sc1
    v_max3_f32 v48, v99, v100, v101
    v_max3_f32 v56, v102, v103, v56
    v_max_f32 v56, v56, v48
    v_max3_f32 v57, v104, v105, v106
    v_max3_f32 v49, v107, v108, v109
    v_max3_f32 v57, v110, v111, v57
    v_max_f32_e64 v57, v57, v49
    v_max3_f32 v58, v112, v113, v114
    v_max3_f32 v50, v115, v116, v117
    v_max3_f32 v58, v118, v119, v58
    v_max_f32_e64 v58, v58, v50
    v_max3_f32 v59, v120, v121, v122
    v_max3_f32 v51, v123, v124, v125
    v_max3_f32 v59, v126, v127, v59
    v_max_f32 v59, v59, v51
    v_permlane32_swap_b32 v56, v57
    buffer_load_dwordx4 v[196:199], v0, s[4:7], s76 offen offset:1024 sc1
    v_permlane32_swap_b32 v58, v59
    v_max_f32 v56, v56, v57
    v_max_f32 v58, v58, v59
    v_mul_f32 v57, v56, v44
    v_mul_f32 v56, v56, v44
    v_mul_f32 v59, v58, v44
    v_mul_f32 v58, v58, v44
    v_permlane32_swap_b32 v56, v57
    s_nop 0
    v_permlane32_swap_b32 v58, v59
    v_pk_fma_f32 v[96:97], v[96:97], v[44:45], v[56:57] op_sel:[0,0,0] op_sel_hi:[1,0,0] neg_lo:[0,0,1] neg_hi:[0,0,1]
    v_pk_fma_f32 v[98:99], v[98:99], v[44:45], v[56:57] op_sel:[0,0,0] op_sel_hi:[1,0,0] neg_lo:[0,0,1] neg_hi:[0,0,1]
    v_pk_fma_f32 v[100:101], v[100:101], v[44:45], v[56:57] op_sel:[0,0,0] op_sel_hi:[1,0,0] neg_lo:[0,0,1] neg_hi:[0,0,1]
    buffer_load_dwordx4 v[200:203], v0, s[4:7], s76 offen offset:2048 sc1
    v_pk_fma_f32 v[102:103], v[102:103], v[44:45], v[56:57] op_sel:[0,0,0] op_sel_hi:[1,0,0] neg_lo:[0,0,1] neg_hi:[0,0,1]
    v_pk_fma_f32 v[104:105], v[104:105], v[44:45], v[56:57] op_sel:[0,0,1] op_sel_hi:[1,0,1] neg_lo:[0,0,1] neg_hi:[0,0,1]
    v_pk_fma_f32 v[106:107], v[106:107], v[44:45], v[56:57] op_sel:[0,0,1] op_sel_hi:[1,0,1] neg_lo:[0,0,1] neg_hi:[0,0,1]
    v_pk_fma_f32 v[108:109], v[108:109], v[44:45], v[56:57] op_sel:[0,0,1] op_sel_hi:[1,0,1] neg_lo:[0,0,1] neg_hi:[0,0,1]
    v_pk_fma_f32 v[110:111], v[110:111], v[44:45], v[56:57] op_sel:[0,0,1] op_sel_hi:[1,0,1] neg_lo:[0,0,1] neg_hi:[0,0,1]
    v_pk_fma_f32 v[112:113], v[112:113], v[44:45], v[58:59] op_sel:[0,0,0] op_sel_hi:[1,0,0] neg_lo:[0,0,1] neg_hi:[0,0,1]
    v_pk_fma_f32 v[114:115], v[114:115], v[44:45], v[58:59] op_sel:[0,0,0] op_sel_hi:[1,0,0] neg_lo:[0,0,1] neg_hi:[0,0,1]
    v_pk_fma_f32 v[116:117], v[116:117], v[44:45], v[58:59] op_sel:[0,0,0] op_sel_hi:[1,0,0] neg_lo:[0,0,1] neg_hi:[0,0,1]
    v_pk_fma_f32 v[118:119], v[118:119], v[44:45], v[58:59] op_sel:[0,0,0] op_sel_hi:[1,0,0] neg_lo:[0,0,1] neg_hi:[0,0,1]
    v_pk_fma_f32 v[120:121], v[120:121], v[44:45], v[58:59] op_sel:[0,0,1] op_sel_hi:[1,0,1] neg_lo:[0,0,1] neg_hi:[0,0,1]
    v_pk_fma_f32 v[122:123], v[122:123], v[44:45], v[58:59] op_sel:[0,0,1] op_sel_hi:[1,0,1] neg_lo:[0,0,1] neg_hi:[0,0,1]
    v_pk_fma_f32 v[124:125], v[124:125], v[44:45], v[58:59] op_sel:[0,0,1] op_sel_hi:[1,0,1] neg_lo:[0,0,1] neg_hi:[0,0,1]
    v_pk_fma_f32 v[126:127], v[126:127], v[44:45], v[58:59] op_sel:[0,0,1] op_sel_hi:[1,0,1] neg_lo:[0,0,1] neg_hi:[0,0,1]
    v_exp_f32 v96, v96
    v_exp_f32 v97, v97
    buffer_load_dwordx4 v[204:207], v0, s[4:7], s76 offen offset:3072 sc1
    v_exp_f32 v98, v98
    v_exp_f32 v99, v99
    v_exp_f32 v100, v100
    v_exp_f32 v101, v101
    v_exp_f32 v102, v102
    v_exp_f32 v103, v103
    v_exp_f32 v104, v104
    v_exp_f32 v105, v105
    s_add_u32 s94, s76, 4096
    buffer_load_dwordx4 v[208:211], v0, s[4:7], s94 offen sc1
    v_exp_f32 v106, v106
    v_exp_f32 v107, v107
    v_exp_f32 v108, v108
    v_exp_f32 v109, v109
    v_exp_f32 v110, v110
    v_exp_f32 v111, v111
    v_exp_f32 v112, v112
    v_exp_f32 v113, v113
    buffer_load_dwordx4 v[212:215], v0, s[4:7], s94 offen offset:1024 sc1
    v_exp_f32 v114, v114
    v_exp_f32 v115, v115
    v_exp_f32 v116, v116
    v_exp_f32 v117, v117
    v_exp_f32 v118, v118
    v_exp_f32 v119, v119
    v_exp_f32 v120, v120
    v_exp_f32 v121, v121
    buffer_load_dwordx4 v[216:219], v0, s[4:7], s94 offen offset:2048 sc1
    v_exp_f32 v122, v122
    v_exp_f32 v123, v123
    v_exp_f32 v124, v124
    v_exp_f32 v125, v125
    v_exp_f32 v126, v126
    v_exp_f32 v127, v127
    v_pk_add_f32 v[48:49], v[96:97], v[98:99]
    v_pk_add_f32 v[48:49], v[48:49], v[100:101]
    v_pk_add_f32 v[48:49], v[48:49], v[102:103]
    v_add_f32_e64 v56, v48, v49
    buffer_load_dwordx4 v[220:223], v0, s[4:7], s94 offen offset:3072 sc1
    v_pk_add_f32 v[50:51], v[104:105], v[106:107]
    v_pk_add_f32 v[50:51], v[50:51], v[108:109]
    v_pk_add_f32 v[50:51], v[50:51], v[110:111]
    v_add_f32_e64 v57, v50, v51
    v_pk_add_f32 v[52:53], v[112:113], v[114:115]
    v_pk_add_f32 v[52:53], v[52:53], v[116:117]
    v_pk_add_f32 v[52:53], v[52:53], v[118:119]
    v_add_f32_e64 v58, v52, v53
    v_pk_add_f32 v[54:55], v[120:121], v[122:123]
    v_pk_add_f32 v[54:55], v[54:55], v[124:125]
    v_pk_add_f32 v[54:55], v[54:55], v[126:127]
    v_add_f32 v59, v54, v55
    v_permlane32_swap_b32 v56, v57
    s_nop 0
    v_permlane32_swap_b32 v58, v59
    buffer_load_dwordx4 v[224:227], v11, s[4:7], s76 offen sc1
    v_add_f32 v56, v56, v57
    v_add_f32 v58, v58, v59
    v_rcp_f32 v56, v56
    v_rcp_f32 v58, v58
    v_mov_b32 v57, v56
    v_mov_b32 v59, v58
    s_nop 0
    v_permlane32_swap_b32 v56, v57
    v_permlane32_swap_b32_e64 v58, v59
    v_pk_mul_f32 v[96:97], v[96:97], v[56:57] op_sel:[0,0] op_sel_hi:[1,0]
    v_pk_mul_f32 v[98:99], v[98:99], v[56:57] op_sel:[0,0] op_sel_hi:[1,0]
    v_pk_mul_f32 v[100:101], v[100:101], v[56:57] op_sel:[0,0] op_sel_hi:[1,0]
    v_pk_mul_f32 v[102:103], v[102:103], v[56:57] op_sel:[0,0] op_sel_hi:[1,0]
    v_pk_mul_f32 v[104:105], v[104:105], v[56:57] op_sel:[0,1] op_sel_hi:[1,1]
    v_pk_mul_f32 v[106:107], v[106:107], v[56:57] op_sel:[0,1] op_sel_hi:[1,1]
    v_pk_mul_f32 v[108:109], v[108:109], v[56:57] op_sel:[0,1] op_sel_hi:[1,1]
    v_pk_mul_f32 v[110:111], v[110:111], v[56:57] op_sel:[0,1] op_sel_hi:[1,1]
    v_cvt_pk_bf16_f32 v24, v96, v97
    v_cvt_pk_bf16_f32 v25, v98, v99
    v_cvt_pk_bf16_f32 v26, v100, v101
    v_cvt_pk_bf16_f32 v27, v102, v103
    v_cvt_pk_bf16_f32 v28, v104, v105
    v_cvt_pk_bf16_f32 v29, v106, v107
    v_cvt_pk_bf16_f32 v30, v108, v109
    v_cvt_pk_bf16_f32 v31, v110, v111
    v_pk_mul_f32 v[112:113], v[112:113], v[58:59] op_sel:[0,0] op_sel_hi:[1,0]
    v_pk_mul_f32 v[114:115], v[114:115], v[58:59] op_sel:[0,0] op_sel_hi:[1,0]
    v_pk_mul_f32 v[116:117], v[116:117], v[58:59] op_sel:[0,0] op_sel_hi:[1,0]
    v_pk_mul_f32 v[118:119], v[118:119], v[58:59] op_sel:[0,0] op_sel_hi:[1,0]
    v_pk_mul_f32 v[120:121], v[120:121], v[58:59] op_sel:[0,1] op_sel_hi:[1,1]
    v_pk_mul_f32 v[122:123], v[122:123], v[58:59] op_sel:[0,1] op_sel_hi:[1,1]
    v_pk_mul_f32 v[124:125], v[124:125], v[58:59] op_sel:[0,1] op_sel_hi:[1,1]
    v_pk_mul_f32 v[126:127], v[126:127], v[58:59] op_sel:[0,1] op_sel_hi:[1,1]
    v_cvt_pk_bf16_f32 v32, v112, v113
    v_cvt_pk_bf16_f32 v33, v114, v115
    v_cvt_pk_bf16_f32 v34, v116, v117
    v_cvt_pk_bf16_f32 v35, v118, v119
    v_cvt_pk_bf16_f32 v36, v120, v121
    v_cvt_pk_bf16_f32 v37, v122, v123
    v_cvt_pk_bf16_f32 v38, v124, v125
    v_cvt_pk_bf16_f32 v39, v126, v127
L_p2a_1:
    ds_read_b128 a[232:235], v20 offset:27648
    s_waitcnt vmcnt(6)
    v_max3_u32 v48, v192, v196, v200
    s_waitcnt vmcnt(4)
    v_max3_u32 v48, v204, v208, v48
    s_waitcnt vmcnt(2)
    v_max3_u32 v48, v212, v216, v48
    s_waitcnt vmcnt(0)
    v_max3_u32 v48, v220, v224, v48
    v_cmp_eq_u32_e64 vcc, -1, v48
    s_cbranch_vccnz gstub_67
gback_68:
    s_waitcnt lgkmcnt(0)
    v_mfma_f32_16x16x32_bf16 v[64:67], a[232:235], v[224:227], 0
    v_mfma_f32_16x16x32_bf16 v[68:71], a[232:235], v[192:195], 0
    v_mfma_f32_16x16x32_bf16 v[68:71], a[232:235], v[196:199], v[68:71]
    v_mfma_f32_16x16x32_bf16 v[68:71], a[232:235], v[200:203], v[68:71]
    v_mfma_f32_16x16x32_bf16 v[68:71], a[232:235], v[204:207], v[68:71]
    v_mfma_f32_16x16x32_bf16 v[68:71], a[232:235], v[208:211], v[68:71]
    v_mfma_f32_16x16x32_bf16 v[68:71], a[232:235], v[212:215], v[68:71]
    v_mfma_f32_16x16x32_bf16 v[68:71], a[232:235], v[216:219], v[68:71]
    v_mfma_f32_16x16x32_bf16 v[68:71], a[232:235], v[220:223], v[68:71]
    v_add_f32_dpp v64, v64, v64 row_ror:1 row_mask:0xf bank_mask:0xf
    v_add_f32_dpp v65, v65, v65 row_ror:1 row_mask:0xf bank_mask:0xf
    v_add_f32_dpp v66, v66, v66 row_ror:1 row_mask:0xf bank_mask:0xf
    v_add_f32_dpp v67, v67, v67 row_ror:1 row_mask:0xf bank_mask:0xf
    v_add_f32_dpp v64, v64, v64 row_ror:2 row_mask:0xf bank_mask:0xf
    v_add_f32_dpp v65, v65, v65 row_ror:2 row_mask:0xf bank_mask:0xf
    v_add_f32_dpp v66, v66, v66 row_ror:2 row_mask:0xf bank_mask:0xf
    v_add_f32_dpp v67, v67, v67 row_ror:2 row_mask:0xf bank_mask:0xf
    v_add_f32_dpp v64, v64, v64 row_ror:4 row_mask:0xf bank_mask:0xf
    v_add_f32_dpp v65, v65, v65 row_ror:4 row_mask:0xf bank_mask:0xf
    v_add_f32_dpp v66, v66, v66 row_ror:4 row_mask:0xf bank_mask:0xf
    v_add_f32_dpp v67, v67, v67 row_ror:4 row_mask:0xf bank_mask:0xf
    v_cvt_pk_bf16_f32 v72, v64, v65
    v_cvt_pk_bf16_f32 v73, v66, v67
    ds_write_b64 v12, v[72:73] offset:256
    v_cvt_pk_bf16_f32 v74, v68, v69
    v_cvt_pk_bf16_f32 v75, v70, v71
    ds_write_b64 v12, v[74:75] offset:0
    s_waitcnt lgkmcnt(0)
    s_barrier
    ds_read_b128 a[236:239], v20 offset:0
    ds_read_b128 a[244:247], v20 offset:2048
    ds_read_b128 a[240:243], v20 offset:1024
    ds_read_b128 a[248:251], v20 offset:3072
    s_waitcnt lgkmcnt(3)
    v_mfma_f32_32x32x16_bf16 v[64:79], a[236:239], v[24:27], 0
    s_waitcnt lgkmcnt(2)
    v_mfma_f32_32x32x16_bf16 v[80:95], a[244:247], v[32:35], 0
    s_waitcnt lgkmcnt(1)
    v_mfma_f32_32x32x16_bf16 v[64:79], a[240:243], v[28:31], v[64:79]
    s_waitcnt lgkmcnt(0)
    v_mfma_f32_32x32x16_bf16 v[80:95], a[248:251], v[36:39], v[80:95]
    buffer_load_dwordx4 v[32:35], v0, s[4:7], s69 offen sc1
    buffer_load_dwordx4 v[36:39], v0, s[4:7], s70 offen sc1
    v_add_u32 v24, s99, v20
    v_add_u32 v25, s100, v20
    v_add_u32 v26, s101, v20
    v_add_u32 v27, s3, v20
    s_add_u32 s39, s3, 135168
    v_add_u32_e64 v28, s39, v1
    s_and_b32 s39, s32, 1
    s_lshl_b32 s39, s39, 8
    s_add_u32 s39, s39, 135168
    v_add_u32_e64 v29, s39, v1
    v_add_f32 v72, 0x358637bd, v72
    v_rcp_f32 v72, v72
    s_nop 0
    v_pk_mul_f32 v[64:65], v[64:65], v[72:73] op_sel_hi:[1,0]
    v_pk_mul_f32 v[66:67], v[66:67], v[72:73] op_sel_hi:[1,0]
    v_pk_mul_f32 v[68:69], v[68:69], v[72:73] op_sel_hi:[1,0]
    v_pk_mul_f32 v[70:71], v[70:71], v[72:73] op_sel_hi:[1,0]
    v_cvt_pk_bf16_f32 v48, v64, v65
    v_cvt_pk_bf16_f32 v49, v66, v67
    v_cvt_pk_bf16_f32 v50, v68, v69
    v_cvt_pk_bf16_f32 v51, v70, v71
    buffer_store_dwordx4 v[48:51], v0, s[4:7], s67 offen sc1
    v_add_f32 v88, 0x358637bd, v88
    v_rcp_f32 v88, v88
    s_nop 0
    v_pk_mul_f32 v[80:81], v[80:81], v[88:89] op_sel_hi:[1,0]
    v_pk_mul_f32 v[82:83], v[82:83], v[88:89] op_sel_hi:[1,0]
    v_pk_mul_f32 v[84:85], v[84:85], v[88:89] op_sel_hi:[1,0]
    v_pk_mul_f32 v[86:87], v[86:87], v[88:89] op_sel_hi:[1,0]
    v_cvt_pk_bf16_f32 v52, v80, v81
    v_cvt_pk_bf16_f32 v53, v82, v83
    v_cvt_pk_bf16_f32 v54, v84, v85
    v_cvt_pk_bf16_f32 v55, v86, v87
    buffer_store_dwordx4 v[52:55], v0, s[4:7], s67 offen offset:1024 sc1
    s_waitcnt vmcnt(0)
    s_barrier
    s_cmp_lg_u32 s32, 0
    s_cbranch_scc1 hop_69
    s_mov_b64 exec, 1
    s_cmp_lg_u32 s8, 0
    s_cbranch_scc1 ss_71
    buffer_store_dwordx2 v[16:17], off, s[4:7], s77 offset:384
sb_72:
    s_mov_b64 exec, -1
    s_mov_b32 s74, 0
poll_73:
    buffer_load_dwordx2 v[60:61], v19, s[4:7], 0 offen offset:384 sc1
    s_waitcnt vmcnt(0)
    v_cmp_ne_u64_e64 vcc, s[28:29], v[60:61]
    s_cbranch_vccz polled_74
    s_add_u32 s74, s74, 1
    s_cmp_lt_u32 s74, 0x20000
    s_cbranch_scc1 poll_73
    s_mov_b32 s74, 19
    s_branch L_timeout
polled_74:
hop_69:
    s_barrier
L_p2_1:
    v_lshlrev_b32_e64 v64, 16, v32
    buffer_load_dwordx4 v[192:195], v0, s[4:7], s68 offen sc1
    v_and_b32 v65, 0xffff0000, v32
    v_lshlrev_b32_e64 v66, 16, v33
    v_and_b32 v67, 0xffff0000, v33
    buffer_load_dwordx4 v[196:199], v0, s[4:7], s68 offen offset:1024 sc1
    v_lshlrev_b32_e64 v68, 16, v34
    v_and_b32 v69, 0xffff0000, v34
    v_lshlrev_b32_e64 v70, 16, v35
    buffer_load_dwordx4 v[200:203], v0, s[4:7], s68 offen offset:2048 sc1
    v_and_b32 v71, 0xffff0000, v35
    v_mov_b64 v[72:73], 0
    v_mov_b64 v[74:75], 0
    buffer_load_dwordx4 v[204:207], v0, s[4:7], s68 offen offset:3072 sc1
    v_mov_b64 v[76:77], 0
    v_mov_b64 v[78:79], 0
    v_lshlrev_b32_e64 v96, 16, v36
    s_add_u32 s93, s68, 4096
    buffer_load_dwordx4 v[208:211], v0, s[4:7], s93 offen sc1
    v_and_b32 v97, 0xffff0000, v36
    v_lshlrev_b32_e64 v98, 16, v37
    v_and_b32 v99, 0xffff0000, v37
    buffer_load_dwordx4 v[212:215], v0, s[4:7], s93 offen offset:1024 sc1
    v_lshlrev_b32_e64 v100, 16, v38
    v_and_b32 v101, 0xffff0000, v38
    v_lshlrev_b32_e64 v102, 16, v39
    buffer_load_dwordx4 v[216:219], v0, s[4:7], s93 offen offset:2048 sc1
    v_and_b32 v103, 0xffff0000, v39
    v_mov_b64 v[104:105], 0
    v_mov_b64 v[106:107], 0
    buffer_load_dwordx4 v[220:223], v0, s[4:7], s93 offen offset:3072 sc1
    v_mov_b64 v[108:109], 0
    v_mov_b64_e64 v[110:111], 0
    s_waitcnt vmcnt(7)
    v_mfma_f32_32x32x16_bf16 v[64:79], v[128:131], v[192:195], v[64:79]
    buffer_load_dwordx4 v[224:227], v0, s[4:7], s96 offen sc1
    v_mfma_f32_32x32x16_bf16 v[80:95], v[160:163], v[192:195], 0
    s_waitcnt vmcnt(7)
    v_mfma_f32_32x32x16_bf16 v[64:79], v[132:135], v[196:199], v[64:79]
    buffer_load_dwordx4 v[228:231], v0, s[4:7], s96 offen offset:1024 sc1
    v_mfma_f32_32x32x16_bf16 v[80:95], v[164:167], v[196:199], v[80:95]
    s_waitcnt vmcnt(7)
    v_mfma_f32_32x32x16_bf16 v[64:79], v[136:139], v[200:203], v[64:79]
    buffer_load_dwordx4 v[232:235], v0, s[4:7], s96 offen offset:2048 sc1
    v_mfma_f32_32x32x16_bf16 v[80:95], v[168:171], v[200:203], v[80:95]
    s_waitcnt vmcnt(7)
    v_mfma_f32_32x32x16_bf16 v[64:79], v[140:143], v[204:207], v[64:79]
    buffer_load_dwordx4 v[236:239], v0, s[4:7], s96 offen offset:3072 sc1
    v_mfma_f32_32x32x16_bf16 v[80:95], v[172:175], v[204:207], v[80:95]
    s_waitcnt vmcnt(7)
    v_mfma_f32_32x32x16_bf16 v[64:79], v[144:147], v[208:211], v[64:79]
    s_add_u32 s93, s96, 4096
    buffer_load_dwordx4 v[240:243], v0, s[4:7], s93 offen sc1
    v_mfma_f32_32x32x16_bf16 v[80:95], v[176:179], v[208:211], v[80:95]
    s_waitcnt vmcnt(7)
    v_mfma_f32_32x32x16_bf16 v[64:79], v[148:151], v[212:215], v[64:79]
    buffer_load_dwordx4 v[244:247], v0, s[4:7], s93 offen offset:1024 sc1
    v_mfma_f32_32x32x16_bf16 v[80:95], v[180:183], v[212:215], v[80:95]
    s_waitcnt vmcnt(7)
    v_mfma_f32_32x32x16_bf16 v[64:79], v[152:155], v[216:219], v[64:79]
    buffer_load_dwordx4 v[248:251], v0, s[4:7], s93 offen offset:2048 sc1
    v_mfma_f32_32x32x16_bf16 v[80:95], v[184:187], v[216:219], v[80:95]
    s_waitcnt vmcnt(7)
    v_mfma_f32_32x32x16_bf16 v[64:79], v[156:159], v[220:223], v[64:79]
    buffer_load_dwordx4 v[252:255], v0, s[4:7], s93 offen offset:3072 sc1
    v_mfma_f32_32x32x16_bf16 v[80:95], v[188:191], v[220:223], v[80:95]
    s_waitcnt vmcnt(7)
    v_mfma_f32_32x32x16_bf16 v[96:111], v[128:131], v[224:227], v[96:111]
    v_mfma_f32_32x32x16_bf16 v[112:127], v[160:163], v[224:227], 0
    s_nop 6
    ds_write_b128 v24, v[72:75]
    s_waitcnt vmcnt(6)
    v_mfma_f32_32x32x16_bf16 v[96:111], v[132:135], v[228:231], v[96:111]
    ds_write_b128 v24, v[76:79] offset:1024
    v_mfma_f32_32x32x16_bf16 v[112:127], v[164:167], v[228:231], v[112:127]
    ds_write_b128 v25, v[80:83]
    s_waitcnt vmcnt(5)
    v_mfma_f32_32x32x16_bf16 v[96:111], v[136:139], v[232:235], v[96:111]
    ds_write_b128 v25, v[84:87] offset:1024
    v_mfma_f32_32x32x16_bf16 v[112:127], v[168:171], v[232:235], v[112:127]
    ds_write_b128 v26, v[88:91]
    s_waitcnt vmcnt(4)
    v_mfma_f32_32x32x16_bf16 v[96:111], v[140:143], v[236:239], v[96:111]
    s_add_u32 m0, s11, 83968
    s_add_u32 s37, s34, 286720
    buffer_load_dwordx4 v0, s[4:7], s37 offen lds
    ds_write_b128 v26, v[92:95] offset:1024
    v_mfma_f32_32x32x16_bf16 v[112:127], v[172:175], v[236:239], v[112:127]
    buffer_load_dwordx4 v0, s[4:7], s37 offen offset:1024 lds
    s_waitcnt lgkmcnt(0)
    s_barrier
    ds_read_b128 v[72:75], v27 offset:0
    ds_read_b128 v[76:79], v27 offset:1024
    s_waitcnt vmcnt(5)
    v_mfma_f32_32x32x16_bf16 v[96:111], v[144:147], v[240:243], v[96:111]
    buffer_load_dwordx4 v0, s[4:7], s37 offen offset:2048 lds
    ds_read_b128 v[80:83], v27 offset:2048
    ds_read_b128 v[84:87], v27 offset:3072
    ds_read_b128 v[88:91], v27 offset:4096
    ds_read_b128 v[92:95], v27 offset:5120
    s_waitcnt lgkmcnt(5)
    v_add_f32_e64 v64, v64, v72
    v_mfma_f32_32x32x16_bf16 v[112:127], v[176:179], v[240:243], v[112:127]
    buffer_load_dwordx4 v0, s[4:7], s37 offen offset:3072 lds
    v_add_f32 v65, v65, v73
    v_add_f32 v66, v66, v74
    v_add_f32 v67, v67, v75
    s_waitcnt lgkmcnt(4)
    v_add_f32 v68, v68, v76
    s_waitcnt vmcnt(6)
    v_mfma_f32_32x32x16_bf16 v[96:111], v[148:151], v[244:247], v[96:111]
    s_add_u32 m0, s35, 67584
    s_add_u32 s37, s36, 270336
    buffer_load_dword v63, s[4:7], s37 offen lds
    v_add_f32 v69, v69, v77
    v_add_f32 v70, v70, v78
    v_add_f32_e64 v71, v71, v79
    v_mfma_f32_32x32x16_bf16 v[112:127], v[180:183], v[244:247], v[112:127]
    s_add_u32 m0, s11, 117760
    s_add_u32 s37, s34, 252928
    buffer_load_dwordx4 v0, s[4:7], s37 offen lds
    s_waitcnt lgkmcnt(3)
    v_add_f32_e64 v64, v64, v80
    s_waitcnt vmcnt(7)
    v_mfma_f32_32x32x16_bf16 v[96:111], v[152:155], v[248:251], v[96:111]
    buffer_load_dwordx4 v0, s[4:7], s37 offen offset:1024 lds
    v_add_f32 v65, v65, v81
    v_add_f32 v66, v66, v82
    v_add_f32 v67, v67, v83
    s_waitcnt lgkmcnt(2)
    v_add_f32_e64 v68, v68, v84
    v_mfma_f32_32x32x16_bf16 v[112:127], v[184:187], v[248:251], v[112:127]
    buffer_load_dwordx4 v0, s[4:7], s37 offen offset:2048 lds
    v_add_f32 v69, v69, v85
    v_add_f32 v70, v70, v86
    v_add_f32 v71, v71, v87
    s_waitcnt lgkmcnt(1)
    v_add_f32 v64, v64, v88
    s_waitcnt vmcnt(8)
    v_mfma_f32_32x32x16_bf16 v[96:111], v[156:159], v[252:255], v[96:111]
    buffer_load_dwordx4 v0, s[4:7], s37 offen offset:3072 lds
    v_add_f32 v65, v65, v89
    v_add_f32 v66, v66, v90
    v_add_f32 v67, v67, v91
    s_waitcnt lgkmcnt(0)
    v_add_f32_e64 v68, v68, v92
    v_mfma_f32_32x32x16_bf16 v[112:127], v[188:191], v[252:255], v[112:127]
    s_add_u32 m0, s35, 101376
    s_add_u32 s37, s36, 236544
    buffer_load_dword v63, s[4:7], s37 offen lds
    v_add_f32 v69, v69, v93
    v_add_f32 v70, v70, v94
    v_add_f32 v71, v71, v95
    s_barrier
    v_cvt_pk_bf16_f32 v72, v64, v65
    v_cvt_pk_bf16_f32 v73, v66, v67
    v_cvt_pk_bf16_f32 v74, v68, v69
    v_cvt_pk_bf16_f32 v75, v70, v71
    s_cmp_lg_u32 s8, 0
    s_cbranch_scc1 ss_76
    buffer_store_dwordx4 v[72:75], v0, s[4:7], s69 offen
sb_77:
    ds_write_b128 v24, v[104:107]
    v_mov_b64 v[64:65], 0
    v_dot2c_f32_bf16 v64, s80, v72
    ds_write_b128 v24, v[108:111] offset:1024
    v_dot2c_f32_bf16 v65, v72, v72
    v_dot2c_f32_bf16 v64, s80, v73
    ds_write_b128 v25, v[112:115]
    v_dot2c_f32_bf16 v65, v73, v73
    v_dot2c_f32_bf16 v64, s80, v74
    ds_write_b128 v25, v[116:119] offset:1024
    v_dot2c_f32_bf16 v65, v74, v74
    v_dot2c_f32_bf16 v64, s80, v75
    ds_write_b128 v26, v[120:123]
    v_dot2c_f32_bf16 v65, v75, v75
    s_nop 2
    v_permlane32_swap_b32_e64 v64, v65
    ds_write_b128 v26, v[124:127] offset:1024
    v_add_f32_e64 v64, v64, v65
    s_waitcnt lgkmcnt(0)
    s_barrier
    ds_read_b128 v[104:107], v27 offset:0
    ds_read_b128 v[108:111], v27 offset:1024
    ds_read_b128 v[112:115], v27 offset:2048
    ds_read_b128 v[116:119], v27 offset:3072
    ds_read_b128 v[120:123], v27 offset:4096
    ds_read_b128 v[124:127], v27 offset:5120
    s_waitcnt lgkmcnt(5)
    v_pk_add_f32 v[96:97], v[96:97], v[104:105]
    v_pk_add_f32 v[98:99], v[98:99], v[106:107]
    s_waitcnt lgkmcnt(4)
    v_pk_add_f32 v[100:101], v[100:101], v[108:109]
    v_pk_add_f32 v[102:103], v[102:103], v[110:111]
    s_waitcnt lgkmcnt(3)
    v_pk_add_f32 v[96:97], v[96:97], v[112:113]
    v_pk_add_f32 v[98:99], v[98:99], v[114:115]
    s_waitcnt lgkmcnt(2)
    v_pk_add_f32 v[100:101], v[100:101], v[116:117]
    v_pk_add_f32 v[102:103], v[102:103], v[118:119]
    s_waitcnt lgkmcnt(1)
    v_pk_add_f32 v[96:97], v[96:97], v[120:121]
    v_pk_add_f32 v[98:99], v[98:99], v[122:123]
    s_waitcnt lgkmcnt(0)
    v_pk_add_f32 v[100:101], v[100:101], v[124:125]
    v_pk_add_f32 v[102:103], v[102:103], v[126:127]
    v_cvt_pk_bf16_f32 v104, v96, v97
    v_cvt_pk_bf16_f32 v105, v98, v99
    v_cvt_pk_bf16_f32 v106, v100, v101
    v_cvt_pk_bf16_f32 v107, v102, v103
    s_cmp_lg_u32 s8, 0
    s_cbranch_scc1 ss_78
    buffer_store_dwordx4 v[104:107], v0, s[4:7], s70 offen
sb_79:
    v_mov_b64 v[96:97], 0
    v_dot2c_f32_bf16 v96, s80, v104
    v_dot2c_f32_bf16 v97, v104, v104
    v_dot2c_f32_bf16 v96, s80, v105
    v_dot2c_f32_bf16 v97, v105, v105
    v_dot2c_f32_bf16 v96, s80, v106
    v_dot2c_f32_bf16 v97, v106, v106
    v_dot2c_f32_bf16 v96, s80, v107
    v_dot2c_f32_bf16 v97, v107, v107
    s_nop 2
    v_permlane32_swap_b32 v96, v97
    v_add_f32 v96, v96, v97
    ds_write_b32 v28, v64
    ds_write_b32 v28, v96 offset:256
    s_waitcnt vmcnt(0) lgkmcnt(0)
    s_barrier
    s_cmp_lg_u32 s32, 0
    s_cbranch_scc1 hop_80
    s_mov_b64 exec, 1
    s_cmp_lg_u32 s8, 0
    s_cbranch_scc1 ss_82
    buffer_store_dwordx2 v[16:17], off, s[4:7], s77 offset:512
sb_83:
    s_mov_b64 exec, -1
    s_mov_b32 s74, 0
poll_84:
    buffer_load_dwordx2 v[60:61], v19, s[4:7], 0 offen offset:512 sc1
    s_waitcnt vmcnt(0)
    v_cmp_ne_u64_e64 vcc, s[28:29], v[60:61]
    s_cbranch_vccz polled_85
    s_add_u32 s74, s74, 1
    s_cmp_lt_u32 s74, 0x20000
    s_cbranch_scc1 poll_84
    s_mov_b32 s74, 20
    s_branch L_timeout
polled_85:
hop_80:
    s_cmp_lt_u32 s32, 2
    s_cbranch_scc1 sto_87
    ds_read_b32 v48, v29 offset:0
    ds_read_b32 v49, v29 offset:6144
    ds_read_b32 v50, v29 offset:12288
    ds_read_b32 v51, v29 offset:18432
    s_waitcnt lgkmcnt(2)
    v_add_f32 v48, v48, v49
    s_waitcnt lgkmcnt(0)
    v_add_f32 v50, v50, v51
    v_add_f32 v48, v48, v50
    s_cmp_lg_u32 s8, 0
    s_cbranch_scc1 ss_89
    buffer_store_dword v48, v1, s[4:7], s71 offen
sb_90:
    s_waitcnt vmcnt(0)
    s_mov_b64 exec, 1
    s_cmp_lg_u32 s8, 0
    s_cbranch_scc1 ss_91
    buffer_store_dwordx2 v[16:17], off, s[4:7], s9 offset:896
sb_92:
    s_mov_b64 exec, -1
sto_87:
    s_barrier
L_p3_1:
    buffer_load_dwordx4 v[128:131], v0, s[4:7], s65 offen sc1
    buffer_load_dwordx4 v[132:135], v0, s[4:7], s65 offen offset:1024 sc1
    buffer_load_dwordx4 v[136:139], v0, s[4:7], s65 offen offset:2048 sc1
    buffer_load_dwordx4 v[140:143], v0, s[4:7], s65 offen offset:3072 sc1
    s_add_u32 s93, s65, 4096
    buffer_load_dwordx4 v[144:147], v0, s[4:7], s93 offen sc1
    buffer_load_dwordx4 v[148:151], v0, s[4:7], s93 offen offset:1024 sc1
    buffer_load_dwordx4 v[152:155], v0, s[4:7], s93 offen offset:2048 sc1
    ds_read_b128 a[252:255], v3 offset:0
    ds_read_b128 a[224:227], v4 offset:0
    ds_read_b128 a[228:231], v3 offset:1024
    ds_read_b128 a[232:235], v4 offset:1024
    ds_read_b128 a[236:239], v5 offset:0
    ds_read_b128 a[240:243], v3 offset:2048
    s_waitcnt vmcnt(6) lgkmcnt(3)
    v_mfma_f32_32x32x16_bf16 v[64:79], a[252:255], v[128:131], 0
    ds_read_b128 a[244:247], v4 offset:2048
    buffer_load_dwordx4 v[156:159], v0, s[4:7], s93 offen offset:3072 sc1
    v_mfma_f32_32x32x16_bf16 v[80:95], a[224:227], v[128:131], 0
    ds_read_b128 a[248:251], v5 offset:1024
    s_add_u32 s93, s65, 8192
    buffer_load_dwordx4 v[160:163], v0, s[4:7], s93 offen sc1
    s_waitcnt vmcnt(7)
    v_mfma_f32_32x32x16_bf16 v[64:79], a[228:231], v[132:135], v[64:79]
    ds_read_b128 a[252:255], v3 offset:3072
    buffer_load_dwordx4 v[164:167], v0, s[4:7], s93 offen offset:1024 sc1
    s_waitcnt lgkmcnt(3)
    v_mfma_f32_32x32x16_bf16 v[80:95], a[232:235], v[132:135], v[80:95]
    ds_read_b128 a[224:227], v4 offset:3072
    buffer_load_dwordx4 v[168:171], v0, s[4:7], s93 offen offset:2048 sc1
    v_mfma_f32_32x32x16_bf16 v[96:111], a[236:239], v[128:131], 0
    ds_read_b128 a[228:231], v3 offset:4096
    s_waitcnt vmcnt(8)
    v_mfma_f32_32x32x16_bf16 v[64:79], a[240:243], v[136:139], v[64:79]
    ds_read_b128 a[232:235], v4 offset:4096
    buffer_load_dwordx4 v[172:175], v0, s[4:7], s93 offen offset:3072 sc1
    s_waitcnt lgkmcnt(3)
    v_mfma_f32_32x32x16_bf16 v[80:95], a[244:247], v[136:139], v[80:95]
    ds_read_b128 a[236:239], v5 offset:2048
    s_add_u32 s93, s65, 12288
    buffer_load_dwordx4 v[176:179], v0, s[4:7], s93 offen sc1
    buffer_load_dwordx2 v[60:61], v62, s[4:7], s10 offen offset:896 sc1
    v_mfma_f32_32x32x16_bf16 v[96:111], a[248:251], v[132:135], v[96:111]
    ds_read_b128 a[240:243], v3 offset:5120
    s_waitcnt vmcnt(10)
    v_mfma_f32_32x32x16_bf16 v[64:79], a[252:255], v[140:143], v[64:79]
    ds_read_b128 a[244:247], v4 offset:5120
    buffer_load_dwordx4 v[180:183], v0, s[4:7], s93 offen offset:1024 sc1
    s_waitcnt lgkmcnt(3)
    v_mfma_f32_32x32x16_bf16 v[80:95], a[224:227], v[140:143], v[80:95]
    ds_read_b128 a[248:251], v5 offset:3072
    buffer_load_dwordx4 v[184:187], v0, s[4:7], s93 offen offset:2048 sc1
    s_waitcnt vmcnt(11)
    v_mfma_f32_32x32x16_bf16 v[64:79], a[228:231], v[144:147], v[64:79]
    ds_read_b128 a[252:255], v3 offset:6144
    buffer_load_dwordx4 v[188:191], v0, s[4:7], s93 offen offset:3072 sc1
    v_mfma_f32_32x32x16_bf16 v[80:95], a[232:235], v[144:147], v[80:95]
    ds_read_b128 a[224:227], v4 offset:6144
    s_waitcnt lgkmcnt(3)
    v_mfma_f32_32x32x16_bf16 v[96:111], a[236:239], v[136:139], v[96:111]
    ds_read_b128 a[228:231], v3 offset:7168
    s_waitcnt vmcnt(11)
    v_mfma_f32_32x32x16_bf16 v[64:79], a[240:243], v[148:151], v[64:79]
    ds_read_b128 a[232:235], v4 offset:7168
    s_add_u32 s93, s65, 16384
    buffer_load_dwordx4 v[192:195], v0, s[4:7], s93 offen sc1
    v_mfma_f32_32x32x16_bf16 v[80:95], a[244:247], v[148:151], v[80:95]
    ds_read_b128 a[236:239], v5 offset:4096
    s_waitcnt lgkmcnt(3)
    v_mfma_f32_32x32x16_bf16 v[96:111], a[248:251], v[140:143], v[96:111]
    ds_read_b128 a[240:243], v3 offset:8192
    s_waitcnt vmcnt(11)
    v_mfma_f32_32x32x16_bf16 v[64:79], a[252:255], v[152:155], v[64:79]
    ds_read_b128 a[244:247], v4 offset:8192
    buffer_load_dwordx4 v[196:199], v0, s[4:7], s93 offen offset:1024 sc1
    v_mfma_f32_32x32x16_bf16 v[80:95], a[224:227], v[152:155], v[80:95]
    ds_read_b128 a[248:251], v5 offset:5120
    s_waitcnt vmcnt(11) lgkmcnt(3)
    v_mfma_f32_32x32x16_bf16 v[64:79], a[228:231], v[156:159], v[64:79]
    ds_read_b128 a[252:255], v3 offset:9216
    buffer_load_dwordx4 v[200:203], v0, s[4:7], s93 offen offset:2048 sc1
    v_mfma_f32_32x32x16_bf16 v[80:95], a[232:235], v[156:159], v[80:95]
    ds_read_b128 a[224:227], v4 offset:9216
    v_mfma_f32_32x32x16_bf16 v[96:111], a[236:239], v[144:147], v[96:111]
    ds_read_b128 a[228:231], v3 offset:10240
    s_waitcnt vmcnt(11) lgkmcnt(3)
    v_mfma_f32_32x32x16_bf16 v[64:79], a[240:243], v[160:163], v[64:79]
    ds_read_b128 a[232:235], v4 offset:10240
    buffer_load_dwordx4 v[204:207], v0, s[4:7], s93 offen offset:3072 sc1
    v_mfma_f32_32x32x16_bf16 v[80:95], a[244:247], v[160:163], v[80:95]
    ds_read_b128 a[236:239], v5 offset:6144
    v_mfma_f32_32x32x16_bf16 v[96:111], a[248:251], v[148:151], v[96:111]
    ds_read_b128 a[240:243], v3 offset:11264
    s_waitcnt vmcnt(11) lgkmcnt(3)
    v_mfma_f32_32x32x16_bf16 v[64:79], a[252:255], v[164:167], v[64:79]
    ds_read_b128 a[244:247], v4 offset:11264
    s_add_u32 s93, s65, 20480
    buffer_load_dwordx4 v[208:211], v0, s[4:7], s93 offen sc1
    v_mfma_f32_32x32x16_bf16 v[80:95], a[224:227], v[164:167], v[80:95]
    ds_read_b128 a[248:251], v5 offset:7168
    s_waitcnt vmcnt(11)
    v_mfma_f32_32x32x16_bf16 v[64:79], a[228:231], v[168:171], v[64:79]
    ds_read_b128 a[252:255], v3 offset:12288
    buffer_load_dwordx4 v[212:215], v0, s[4:7], s93 offen offset:1024 sc1
    s_waitcnt lgkmcnt(3)
    v_mfma_f32_32x32x16_bf16 v[80:95], a[232:235], v[168:171], v[80:95]
    ds_read_b128 a[224:227], v4 offset:12288
    v_mfma_f32_32x32x16_bf16 v[96:111], a[236:239], v[152:155], v[96:111]
    ds_read_b128 a[228:231], v3 offset:13312
    s_waitcnt vmcnt(11)
    v_mfma_f32_32x32x16_bf16 v[64:79], a[240:243], v[172:175], v[64:79]
    ds_read_b128 a[232:235], v4 offset:13312
    buffer_load_dwordx4 v[216:219], v0, s[4:7], s93 offen offset:2048 sc1
    s_waitcnt lgkmcnt(3)
    v_mfma_f32_32x32x16_bf16 v[80:95], a[244:247], v[172:175], v[80:95]
    ds_read_b128 a[236:239], v5 offset:8192
    v_mfma_f32_32x32x16_bf16 v[96:111], a[248:251], v[156:159], v[96:111]
    ds_read_b128 a[240:243], v3 offset:14336
    s_waitcnt vmcnt(11)
    v_mfma_f32_32x32x16_bf16 v[64:79], a[252:255], v[176:179], v[64:79]
    ds_read_b128 a[244:247], v4 offset:14336
    buffer_load_dwordx4 v[220:223], v0, s[4:7], s93 offen offset:3072 sc1
    s_waitcnt lgkmcnt(3)
    v_mfma_f32_32x32x16_bf16 v[80:95], a[224:227], v[176:179], v[80:95]
    ds_read_b128 a[248:251], v5 offset:9216
    s_waitcnt vmcnt(10)
    v_mfma_f32_32x32x16_bf16 v[64:79], a[228:231], v[180:183], v[64:79]
    ds_read_b128 a[252:255], v3 offset:15360
    v_cmp_ne_u64 vcc, s[28:29], v[60:61]
    s_cbranch_vccnz fstub_93
fback_94:
    buffer_load_dword v24, v1, s[4:7], s66 offen sc1
    buffer_load_dword v25, v1, s[4:7], s66 offen offset:256 sc1
    buffer_load_dword v26, v1, s[4:7], s66 offen offset:512 sc1
    buffer_load_dword v27, v1, s[4:7], s66 offen offset:768 sc1
    v_mfma_f32_32x32x16_bf16 v[80:95], a[232:235], v[180:183], v[80:95]
    ds_read_b128 a[224:227], v4 offset:15360
    s_waitcnt lgkmcnt(3)
    v_mfma_f32_32x32x16_bf16 v[96:111], a[236:239], v[160:163], v[96:111]
    ds_read_b128 a[228:231], v3 offset:16384
    s_waitcnt vmcnt(13)
    v_mfma_f32_32x32x16_bf16 v[64:79], a[240:243], v[184:187], v[64:79]
    ds_read_b128 a[232:235], v4 offset:16384
    buffer_load_dword v28, v1, s[4:7], s66 offen offset:1024 sc1
    buffer_load_dword v29, v1, s[4:7], s66 offen offset:1280 sc1
    buffer_load_dword v30, v1, s[4:7], s66 offen offset:1536 sc1
    buffer_load_dword v31, v1, s[4:7], s66 offen offset:1792 sc1
    v_mfma_f32_32x32x16_bf16 v[80:95], a[244:247], v[184:187], v[80:95]
    ds_read_b128 a[236:239], v5 offset:10240
    s_waitcnt lgkmcnt(3)
    v_mfma_f32_32x32x16_bf16 v[96:111], a[248:251], v[164:167], v[96:111]
    ds_read_b128 a[240:243], v3 offset:17408
    s_waitcnt vmcnt(16)
    v_mfma_f32_32x32x16_bf16 v[64:79], a[252:255], v[188:191], v[64:79]
    ds_read_b128 a[244:247], v4 offset:17408
    s_add_u32 s93, s65, 24576
    buffer_load_dwordx4 v[224:227], v0, s[4:7], s93 offen sc1
    v_mfma_f32_32x32x16_bf16 v[80:95], a[224:227], v[188:191], v[80:95]
    ds_read_b128 a[248:251], v5 offset:11264
    s_waitcnt vmcnt(16) lgkmcnt(3)
    v_mfma_f32_32x32x16_bf16 v[64:79], a[228:231], v[192:195], v[64:79]
    ds_read_b128 a[252:255], v3 offset:18432
    buffer_load_dwordx4 v[228:231], v0, s[4:7], s93 offen offset:1024 sc1
    v_mfma_f32_32x32x16_bf16 v[80:95], a[232:235], v[192:195], v[80:95]
    ds_read_b128 a[224:227], v4 offset:18432
    v_mfma_f32_32x32x16_bf16 v[96:111], a[236:239], v[168:171], v[96:111]
    ds_read_b128 a[228:231], v3 offset:19456
    s_waitcnt vmcnt(16) lgkmcnt(3)
    v_mfma_f32_32x32x16_bf16 v[64:79], a[240:243], v[196:199], v[64:79]
    ds_read_b128 a[232:235], v4 offset:19456
    buffer_load_dwordx4 v[232:235], v0, s[4:7], s93 offen offset:2048 sc1
    v_mfma_f32_32x32x16_bf16 v[80:95], a[244:247], v[196:199], v[80:95]
    ds_read_b128 a[236:239], v5 offset:12288
    v_mfma_f32_32x32x16_bf16 v[96:111], a[248:251], v[172:175], v[96:111]
    ds_read_b128 a[240:243], v3 offset:20480
    s_waitcnt vmcnt(16) lgkmcnt(3)
    v_mfma_f32_32x32x16_bf16 v[64:79], a[252:255], v[200:203], v[64:79]
    ds_read_b128 a[244:247], v4 offset:20480
    buffer_load_dwordx4 v[236:239], v0, s[4:7], s93 offen offset:3072 sc1
    v_mfma_f32_32x32x16_bf16 v[80:95], a[224:227], v[200:203], v[80:95]
    ds_read_b128 a[248:251], v5 offset:13312
    s_waitcnt vmcnt(16)
    v_mfma_f32_32x32x16_bf16 v[64:79], a[228:231], v[204:207], v[64:79]
    ds_read_b128 a[252:255], v3 offset:21504
    s_add_u32 s93, s65, 28672
    buffer_load_dwordx4 v[240:243], v0, s[4:7], s93 offen sc1
    s_waitcnt lgkmcnt(3)
    v_mfma_f32_32x32x16_bf16 v[80:95], a[232:235], v[204:207], v[80:95]
    ds_read_b128 a[224:227], v4 offset:21504
    v_mfma_f32_32x32x16_bf16 v[96:111], a[236:239], v[176:179], v[96:111]
    ds_read_b128 a[228:231], v3 offset:22528
    s_waitcnt vmcnt(16)
    v_mfma_f32_32x32x16_bf16 v[64:79], a[240:243], v[208:211], v[64:79]
    ds_read_b128 a[232:235], v4 offset:22528
    buffer_load_dwordx4 v[244:247], v0, s[4:7], s93 offen offset:1024 sc1
    s_waitcnt lgkmcnt(3)
    v_mfma_f32_32x32x16_bf16 v[80:95], a[244:247], v[208:211], v[80:95]
    ds_read_b128 a[236:239], v5 offset:14336
    v_mfma_f32_32x32x16_bf16 v[96:111], a[248:251], v[180:183], v[96:111]
    ds_read_b128 a[240:243], v3 offset:23552
    s_waitcnt vmcnt(16)
    v_mfma_f32_32x32x16_bf16 v[64:79], a[252:255], v[212:215], v[64:79]
    ds_read_b128 a[244:247], v4 offset:23552
    buffer_load_dwordx4 v[248:251], v0, s[4:7], s93 offen offset:2048 sc1
    s_waitcnt lgkmcnt(3)
    v_mfma_f32_32x32x16_bf16 v[80:95], a[224:227], v[212:215], v[80:95]
    ds_read_b128 a[248:251], v5 offset:15360
    s_waitcnt vmcnt(16)
    v_mfma_f32_32x32x16_bf16 v[64:79], a[228:231], v[216:219], v[64:79]
    ds_read_b128 a[252:255], v3 offset:24576
    buffer_load_dwordx4 v[252:255], v0, s[4:7], s93 offen offset:3072 sc1
    v_mfma_f32_32x32x16_bf16 v[80:95], a[232:235], v[216:219], v[80:95]
    ds_read_b128 a[224:227], v4 offset:24576
    s_waitcnt lgkmcnt(3)
    v_mfma_f32_32x32x16_bf16 v[96:111], a[236:239], v[184:187], v[96:111]
    ds_read_b128 a[228:231], v3 offset:25600
    s_waitcnt vmcnt(16)
    v_mfma_f32_32x32x16_bf16 v[64:79], a[240:243], v[220:223], v[64:79]
    ds_read_b128 a[232:235], v4 offset:25600
    s_add_u32 m0, s11, 0
    s_add_u32 s37, s34, 202752
    buffer_load_dwordx4 v0, s[4:7], s37 offen lds
    v_mfma_f32_32x32x16_bf16 v[80:95], a[244:247], v[220:223], v[80:95]
    ds_read_b128 a[236:239], v5 offset:16384
    s_waitcnt lgkmcnt(3)
    v_mfma_f32_32x32x16_bf16 v[96:111], a[248:251], v[188:191], v[96:111]
    ds_read_b128 a[240:243], v3 offset:26624
    s_waitcnt vmcnt(8)
    v_mfma_f32_32x32x16_bf16 v[64:79], a[252:255], v[224:227], v[64:79]
    ds_read_b128 a[244:247], v4 offset:26624
    buffer_load_dwordx4 v0, s[4:7], s37 offen offset:1024 lds
    v_mfma_f32_32x32x16_bf16 v[80:95], a[224:227], v[224:227], v[80:95]
    ds_read_b128 a[248:251], v5 offset:17408
    buffer_load_dwordx4 v0, s[4:7], s37 offen offset:2048 lds
    v_add_f32 v24, v24, v25
    v_add_f32 v26, v26, v27
    v_add_f32_e64 v28, v28, v29
    s_waitcnt vmcnt(9) lgkmcnt(3)
    v_mfma_f32_32x32x16_bf16 v[64:79], a[228:231], v[228:231], v[64:79]
    ds_read_b128 a[252:255], v3 offset:27648
    buffer_load_dwordx4 v0, s[4:7], s37 offen offset:3072 lds
    v_add_f32 v30, v30, v31
    v_add_f32 v24, v24, v26
    v_add_f32 v28, v28, v30
    v_add_f32 v24, v24, v28
    v_mfma_f32_32x32x16_bf16 v[80:95], a[232:235], v[228:231], v[80:95]
    ds_read_b128 a[224:227], v4 offset:27648
    s_add_u32 m0, s11, 16384
    s_add_u32 s37, s34, 219136
    buffer_load_dwordx4 v0, s[4:7], s37 offen lds
    v_mul_f32 v24, 0x3b000000, v24
    v_mov_b32_e64 v25, v24
    v_mfma_f32_32x32x16_bf16 v[96:111], a[236:239], v[192:195], v[96:111]
    ds_read_b128 a[228:231], v3 offset:28672
    v_permlane32_swap_b32_e64 v24, v25
    v_fma_f32 v25, -v24, v24, v25
    v_max_f32 v25, 0, v25
    s_waitcnt vmcnt(10) lgkmcnt(3)
    v_mfma_f32_32x32x16_bf16 v[64:79], a[240:243], v[232:235], v[64:79]
    ds_read_b128 a[232:235], v4 offset:28672
    buffer_load_dwordx4 v0, s[4:7], s37 offen offset:1024 lds
    v_add_f32 v46, 0x3727c5ac, v25
    v_rsq_f32_e64 v47, v46
    v_cvt_pk_bf16_f32 v40, -v24, -v24
    v_mfma_f32_32x32x16_bf16 v[80:95], a[244:247], v[232:235], v[80:95]
    ds_read_b128 a[236:239], v5 offset:18432
    v_mov_b32 v41, v40
    v_mov_b32 v42, v40
    v_mov_b32_e64 v43, v40
    v_mul_f32 v44, 0xc0135761, v47
    v_mul_f32_e64 v45, v47, v47
    v_mfma_f32_32x32x16_bf16 v[96:111], a[248:251], v[196:199], v[96:111]
    ds_read_b128 a[240:243], v3 offset:29696
    v_mul_f32 v45, 0x3d372713, v45
    v_mul_f32 v45, v45, v44
    s_waitcnt vmcnt(10) lgkmcnt(3)
    v_mfma_f32_32x32x16_bf16 v[64:79], a[252:255], v[236:239], v[64:79]
    ds_read_b128 a[244:247], v4 offset:29696
    buffer_load_dwordx4 v0, s[4:7], s37 offen offset:2048 lds
    v_mfma_f32_32x32x16_bf16 v[80:95], a[224:227], v[236:239], v[80:95]
    ds_read_b128 a[248:251], v5 offset:19456
    s_waitcnt vmcnt(10)
    v_mfma_f32_32x32x16_bf16 v[64:79], a[228:231], v[240:243], v[64:79]
    ds_read_b128 a[252:255], v3 offset:30720
    buffer_load_dwordx4 v0, s[4:7], s37 offen offset:3072 lds
    s_waitcnt lgkmcnt(3)
    v_mfma_f32_32x32x16_bf16 v[80:95], a[232:235], v[240:243], v[80:95]
    ds_read_b128 a[224:227], v4 offset:30720
    v_mfma_f32_32x32x16_bf16 v[96:111], a[236:239], v[200:203], v[96:111]
    ds_read_b128 a[228:231], v3 offset:31744
    s_waitcnt vmcnt(10)
    v_mfma_f32_32x32x16_bf16 v[64:79], a[240:243], v[244:247], v[64:79]
    ds_read_b128 a[232:235], v4 offset:31744
    s_add_u32 m0, s35, 0
    s_add_u32 s37, s36, 202752
    buffer_load_dword v63, s[4:7], s37 offen lds
    s_waitcnt lgkmcnt(3)
    v_mfma_f32_32x32x16_bf16 v[80:95], a[244:247], v[244:247], v[80:95]
    ds_read_b128 a[236:239], v5 offset:20480
    v_mfma_f32_32x32x16_bf16 v[96:111], a[248:251], v[204:207], v[96:111]
    ds_read_b128 a[240:243], v3 offset:32768
    s_waitcnt vmcnt(10)
    v_mfma_f32_32x32x16_bf16 v[64:79], a[252:255], v[248:251], v[64:79]
    ds_read_b128 a[244:247], v4 offset:32768
    s_waitcnt lgkmcnt(3)
    v_mfma_f32_32x32x16_bf16 v[80:95], a[224:227], v[248:251], v[80:95]
    s_waitcnt vmcnt(9)
    v_mfma_f32_32x32x16_bf16 v[64:79], a[228:231], v[252:255], v[64:79]
    s_waitcnt lgkmcnt(0)
    s_barrier
    ds_read_b128 a[248:251], v5 offset:21504
    ds_read_b128 a[252:255], v5 offset:22528
    v_mfma_f32_32x32x16_bf16 v[80:95], a[232:235], v[252:255], v[80:95]
    ds_read_b128 a[224:227], v5 offset:23552
    v_mfma_f32_32x32x16_bf16 v[96:111], a[236:239], v[208:211], v[96:111]
    ds_read_b128 a[228:231], v5 offset:24576
    v_mfma_f32_32x32x16_bf16 v[64:79], a[240:243], v[40:43], v[64:79]
    ds_read_b128 a[232:235], v5 offset:25600
    s_add_u32 m0, s11, 33792
    s_add_u32 s37, s34, 168960
    buffer_load_dwordx4 v0, s[4:7], s37 offen lds
    v_mfma_f32_32x32x16_bf16 v[80:95], a[244:247], v[40:43], v[80:95]
    ds_read_b128 a[236:239], v5 offset:26624
    s_waitcnt lgkmcnt(3)
    v_mfma_f32_32x32x16_bf16 v[96:111], a[248:251], v[212:215], v[96:111]
    ds_read_b128 a[240:243], v5 offset:27648
    buffer_load_dwordx4 v0, s[4:7], s37 offen offset:1024 lds
    v_mfma_f32_32x32x16_bf16 v[96:111], a[252:255], v[216:219], v[96:111]
    ds_read_b128 a[244:247], v5 offset:28672
    v_mul_f32 v48, v64, v64
    v_mul_f32 v49, v65, v65
    v_mul_f32 v50, v66, v66
    v_mul_f32 v51, v67, v67
    v_mul_f32 v52, v68, v68
    v_mfma_f32_32x32x16_bf16 v[96:111], a[224:227], v[220:223], v[96:111]
    ds_read_b128 a[248:251], v5 offset:29696
    buffer_load_dwordx4 v0, s[4:7], s37 offen offset:2048 lds
    v_mul_f32 v53, v69, v69
    v_mul_f32 v54, v70, v70
    v_mul_f32 v55, v71, v71
    s_waitcnt lgkmcnt(3)
    v_mfma_f32_32x32x16_bf16 v[96:111], a[228:231], v[224:227], v[96:111]
    ds_read_b128 a[252:255], v5 offset:30720
    v_fma_f32 v48, v48, v45, v44
    v_fma_f32 v49, v49, v45, v44
    v_fma_f32 v50, v50, v45, v44
    v_fma_f32 v51, v51, v45, v44
    v_fma_f32 v52, v52, v45, v44
    v_mfma_f32_32x32x16_bf16 v[96:111], a[232:235], v[228:231], v[96:111]
    ds_read_b128 a[224:227], v5 offset:31744
    buffer_load_dwordx4 v0, s[4:7], s37 offen offset:3072 lds
    v_fma_f32 v53, v53, v45, v44
    v_fma_f32 v54, v54, v45, v44
    v_fma_f32 v55, v55, v45, v44
    v_mul_f32_e64 v48, v48, v64
    v_mfma_f32_32x32x16_bf16 v[96:111], a[236:239], v[232:235], v[96:111]
    ds_read_b128 a[228:231], v5 offset:32768
    v_mul_f32 v49, v49, v65
    v_mul_f32 v50, v50, v66
    v_mul_f32 v51, v51, v67
    v_mul_f32_e64 v52, v52, v68
    s_waitcnt lgkmcnt(3)
    v_mfma_f32_32x32x16_bf16 v[96:111], a[240:243], v[236:239], v[96:111]
    s_add_u32 m0, s11, 50176
    s_add_u32 s37, s34, 185344
    buffer_load_dwordx4 v0, s[4:7], s37 offen lds
    v_mul_f32 v53, v53, v69
    v_mul_f32 v54, v54, v70
    v_mul_f32_e64 v55, v55, v71
    v_mfma_f32_32x32x16_bf16 v[96:111], a[244:247], v[240:243], v[96:111]
    s_waitcnt lgkmcnt(0)
    s_waitcnt vmcnt(5)
    s_barrier
    ds_read_b128 a[232:235], v2 offset:0
    ds_read_b128 a[236:239], v2 offset:1024
    v_mfma_f32_32x32x16_bf16 v[96:111], a[248:251], v[244:247], v[96:111]
    ds_read_b128 a[240:243], v2 offset:2048
    buffer_load_dwordx4 v0, s[4:7], s37 offen offset:1024 lds
    v_exp_f32 v48, v48
    v_mul_f32_e64 v72, v64, v72
    v_mfma_f32_32x32x16_bf16 v[96:111], a[252:255], v[248:251], v[96:111]
    ds_read_b128 a[244:247], v2 offset:3072
    v_exp_f32 v49, v49
    v_mul_f32 v73, v65, v73
    v_exp_f32_e64 v50, v50
    v_mfma_f32_32x32x16_bf16 v[96:111], a[224:227], v[252:255], v[96:111]
    ds_read_b128 a[248:251], v2 offset:4096
    buffer_load_dwordx4 v0, s[4:7], s37 offen offset:2048 lds
    v_mul_f32 v74, v66, v74
    v_exp_f32 v51, v51
    v_mul_f32_e64 v75, v67, v75
    v_mfma_f32_32x32x16_bf16 v[96:111], a[228:231], v[40:43], v[96:111]
    ds_read_b128 a[252:255], v2 offset:5120
    v_exp_f32 v52, v52
    v_mul_f32_e64 v76, v68, v76
    s_waitcnt lgkmcnt(3)
    v_mfma_f32_32x32x16_bf16 v[112:127], a[232:235], v[128:131], 0
    ds_read_b128 a[224:227], v2 offset:6144
    buffer_load_dwordx4 v0, s[4:7], s37 offen offset:3072 lds
    v_exp_f32 v53, v53
    v_mul_f32 v77, v69, v77
    v_mfma_f32_32x32x16_bf16 v[112:127], a[236:239], v[132:135], v[112:127]
    ds_read_b128 a[228:231], v2 offset:7168
    v_exp_f32 v54, v54
    v_mul_f32 v78, v70, v78
    v_exp_f32_e64 v55, v55
    v_mfma_f32_32x32x16_bf16 v[112:127], a[240:243], v[136:139], v[112:127]
    ds_read_b128 a[232:235], v2 offset:8192
    s_add_u32 m0, s35, 33792
    s_add_u32 s37, s36, 168960
    buffer_load_dword v63, s[4:7], s37 offen lds
    v_mul_f32 v79, v71, v79
    s_waitcnt lgkmcnt(3)
    v_mfma_f32_32x32x16_bf16 v[112:127], a[244:247], v[140:143], v[112:127]
    ds_read_b128 a[236:239], v2 offset:9216
    v_fma_f32 v48, v48, v46, v46
    v_fma_f32 v49, v49, v46, v46
    v_fma_f32 v50, v50, v46, v46
    v_fma_f32 v51, v51, v46, v46
    v_fma_f32 v52, v52, v46, v46
    v_mfma_f32_32x32x16_bf16 v[112:127], a[248:251], v[144:147], v[112:127]
    ds_read_b128 a[240:243], v2 offset:10240
    s_add_u32 m0, s11, 67584
    s_add_u32 s37, s34, 135168
    buffer_load_dwordx4 v0, s[4:7], s37 offen lds
    v_fma_f32 v53, v53, v46, v46
    v_fma_f32 v54, v54, v46, v46
    v_mfma_f32_32x32x16_bf16 v[112:127], a[252:255], v[148:151], v[112:127]
    ds_read_b128 a[244:247], v2 offset:11264
    v_fma_f32 v55, v55, v46, v46
    v_rcp_f32 v48, v48
    s_waitcnt lgkmcnt(3)
    v_mfma_f32_32x32x16_bf16 v[112:127], a[224:227], v[152:155], v[112:127]
    ds_read_b128 a[248:251], v2 offset:12288
    buffer_load_dwordx4 v0, s[4:7], s37 offen offset:1024 lds
    v_rcp_f32 v49, v49
    v_mul_f32 v72, v72, v48
    v_mfma_f32_32x32x16_bf16 v[112:127], a[228:231], v[156:159], v[112:127]
    ds_read_b128 a[252:255], v2 offset:13312
    v_rcp_f32 v50, v50
    v_mul_f32 v73, v73, v49
    v_rcp_f32_e64 v51, v51
    v_mfma_f32_32x32x16_bf16 v[112:127], a[232:235], v[160:163], v[112:127]
    ds_read_b128 a[224:227], v2 offset:14336
    buffer_load_dwordx4 v0, s[4:7], s37 offen offset:2048 lds
    v_mul_f32 v74, v74, v50
    v_rcp_f32_e64 v52, v52
    s_waitcnt lgkmcnt(3)
    v_mfma_f32_32x32x16_bf16 v[112:127], a[236:239], v[164:167], v[112:127]
    ds_read_b128 a[228:231], v2 offset:15360
    v_mul_f32 v75, v75, v51
    v_rcp_f32 v53, v53
    v_mul_f32_e64 v76, v76, v52
    v_mfma_f32_32x32x16_bf16 v[112:127], a[240:243], v[168:171], v[112:127]
    ds_read_b128 a[232:235], v2 offset:16384
    buffer_load_dwordx4 v0, s[4:7], s37 offen offset:3072 lds
    v_rcp_f32 v54, v54
    v_mul_f32 v77, v77, v53
    v_mfma_f32_32x32x16_bf16 v[112:127], a[244:247], v[172:175], v[112:127]
    ds_read_b128 a[236:239], v2 offset:17408
    v_rcp_f32 v55, v55
    v_mul_f32 v78, v78, v54
    v_cvt_pk_bf16_f32 v56, v72, v73
    s_waitcnt lgkmcnt(3)
    v_mfma_f32_32x32x16_bf16 v[112:127], a[248:251], v[176:179], v[112:127]
    ds_read_b128 a[240:243], v2 offset:18432
    s_add_u32 m0, s11, 83968
    s_add_u32 s37, s34, 151552
    buffer_load_dwordx4 v0, s[4:7], s37 offen lds
    v_mul_f32 v79, v79, v55
    v_cvt_pk_bf16_f32 v57, v74, v75
    v_mfma_f32_32x32x16_bf16 v[112:127], a[252:255], v[180:183], v[112:127]
    ds_read_b128 a[244:247], v2 offset:19456
    v_cvt_pk_bf16_f32 v58, v76, v77
    v_cvt_pk_bf16_f32 v59, v78, v79
    s_add_u32 s94, s73, 4096
    buffer_store_dwordx4 v[56:59], v0, s[4:7], s94 offen offset:2048 sc1
    v_mul_f32_e64 v48, v80, v80
    v_mfma_f32_32x32x16_bf16 v[112:127], a[224:227], v[184:187], v[112:127]
    ds_read_b128 a[248:251], v2 offset:20480
    buffer_load_dwordx4 v0, s[4:7], s37 offen offset:1024 lds
    v_mul_f32 v49, v81, v81
    v_mul_f32 v50, v82, v82
    v_mul_f32 v51, v83, v83
    s_waitcnt lgkmcnt(3)
    v_mfma_f32_32x32x16_bf16 v[112:127], a[228:231], v[188:191], v[112:127]
    ds_read_b128 a[252:255], v2 offset:21504
    v_mul_f32 v52, v84, v84
    v_mul_f32 v53, v85, v85
    v_mul_f32 v54, v86, v86
    v_mul_f32 v55, v87, v87
    v_fma_f32 v48, v48, v45, v44
    v_mfma_f32_32x32x16_bf16 v[112:127], a[232:235], v[192:195], v[112:127]
    ds_read_b128 a[224:227], v2 offset:22528
    buffer_load_dwordx4 v0, s[4:7], s37 offen offset:2048 lds
    v_fma_f32 v49, v49, v45, v44
    v_fma_f32 v50, v50, v45, v44
    v_fma_f32 v51, v51, v45, v44
    v_fma_f32 v52, v52, v45, v44
    v_mfma_f32_32x32x16_bf16 v[112:127], a[236:239], v[196:199], v[112:127]
    ds_read_b128 a[228:231], v2 offset:23552
    v_fma_f32 v53, v53, v45, v44
    v_fma_f32 v54, v54, v45, v44
    v_fma_f32 v55, v55, v45, v44
    v_mul_f32 v48, v48, v80
    s_waitcnt lgkmcnt(3)
    v_mfma_f32_32x32x16_bf16 v[112:127], a[240:243], v[200:203], v[112:127]
    ds_read_b128 a[232:235], v2 offset:24576
    buffer_load_dwordx4 v0, s[4:7], s37 offen offset:3072 lds
    v_mul_f32 v49, v49, v81
    v_mul_f32 v50, v50, v82
    v_mul_f32 v51, v51, v83
    v_mul_f32 v52, v52, v84
    v_mfma_f32_32x32x16_bf16 v[112:127], a[244:247], v[204:207], v[112:127]
    ds_read_b128 a[236:239], v2 offset:25600
    v_mul_f32 v53, v53, v85
    v_mul_f32 v54, v54, v86
    v_mul_f32 v55, v55, v87
    v_exp_f32 v48, v48
    v_mfma_f32_32x32x16_bf16 v[112:127], a[248:251], v[208:211], v[112:127]
    ds_read_b128 a[240:243], v2 offset:26624
    s_add_u32 m0, s35, 67584
    s_add_u32 s37, s36, 135168
    buffer_load_dword v63, s[4:7], s37 offen lds
    v_mul_f32 v88, v80, v88
    s_waitcnt lgkmcnt(3)
    v_mfma_f32_32x32x16_bf16 v[112:127], a[252:255], v[212:215], v[112:127]
    ds_read_b128 a[244:247], v2 offset:27648
    v_exp_f32 v49, v49
    v_mul_f32 v89, v81, v89
    v_exp_f32_e64 v50, v50
    v_mfma_f32_32x32x16_bf16 v[112:127], a[224:227], v[216:219], v[112:127]
    ds_read_b128 a[248:251], v2 offset:28672
    s_add_u32 m0, s11, 101376
    s_add_u32 s37, s34, 101376
    buffer_load_dwordx4 v0, s[4:7], s37 offen lds
    v_mul_f32_e64 v90, v82, v90
    v_mfma_f32_32x32x16_bf16 v[112:127], a[228:231], v[220:223], v[112:127]
    ds_read_b128 a[252:255], v2 offset:29696
    v_exp_f32 v51, v51
    v_mul_f32_e64 v91, v83, v91
    s_waitcnt lgkmcnt(3)
    v_mfma_f32_32x32x16_bf16 v[112:127], a[232:235], v[224:227], v[112:127]
    ds_read_b128 a[224:227], v2 offset:30720
    buffer_load_dwordx4 v0, s[4:7], s37 offen offset:1024 lds
    v_exp_f32 v52, v52
    v_mul_f32 v92, v84, v92
    v_mfma_f32_32x32x16_bf16 v[112:127], a[236:239], v[228:231], v[112:127]
    ds_read_b128 a[228:231], v2 offset:31744
    v_exp_f32 v53, v53
    v_mul_f32 v93, v85, v93
    v_exp_f32_e64 v54, v54
    v_mfma_f32_32x32x16_bf16 v[112:127], a[240:243], v[232:235], v[112:127]
    ds_read_b128 a[232:235], v2 offset:32768
    buffer_load_dwordx4 v0, s[4:7], s37 offen offset:2048 lds
    v_mul_f32 v94, v86, v94
    v_exp_f32_e64 v55, v55
    s_waitcnt lgkmcnt(3)
    v_mfma_f32_32x32x16_bf16 v[112:127], a[244:247], v[236:239], v[112:127]
    v_mul_f32_e64 v95, v87, v95
    v_fma_f32 v48, v48, v46, v46
    v_fma_f32 v49, v49, v46, v46
    v_fma_f32 v50, v50, v46, v46
    v_fma_f32 v51, v51, v46, v46
    v_fma_f32 v52, v52, v46, v46
    v_mfma_f32_32x32x16_bf16 v[112:127], a[248:251], v[240:243], v[112:127]
    s_waitcnt lgkmcnt(0)
    s_waitcnt vmcnt(13)
    s_barrier
    ds_read_b128 a[236:239], v3 offset:0
    ds_read_b128 a[240:243], v3 offset:1024
    buffer_load_dwordx4 v0, s[4:7], s37 offen offset:3072 lds
    v_mfma_f32_32x32x16_bf16 v[112:127], a[252:255], v[244:247], v[112:127]
    ds_read_b128 a[244:247], v3 offset:2048
    v_fma_f32 v53, v53, v46, v46
    v_fma_f32 v54, v54, v46, v46
    v_fma_f32 v55, v55, v46, v46
    v_rcp_f32 v48, v48
    v_mfma_f32_32x32x16_bf16 v[112:127], a[224:227], v[248:251], v[112:127]
    ds_read_b128 a[248:251], v3 offset:3072
    s_add_u32 m0, s11, 117760
    s_add_u32 s37, s34, 117760
    buffer_load_dwordx4 v0, s[4:7], s37 offen lds
    v_rcp_f32_e64 v49, v49
    v_mfma_f32_32x32x16_bf16 v[112:127], a[228:231], v[252:255], v[112:127]
    ds_read_b128 a[252:255], v3 offset:4096
    v_mul_f32 v88, v88, v48
    v_rcp_f32 v50, v50
    v_mul_f32_e64 v89, v89, v49
    v_mfma_f32_32x32x16_bf16 v[112:127], a[232:235], v[40:43], v[112:127]
    ds_read_b128 a[224:227], v3 offset:5120
    buffer_load_dwordx4 v0, s[4:7], s37 offen offset:1024 lds
    v_rcp_f32 v51, v51
    v_mul_f32_e64 v90, v90, v50
    s_waitcnt lgkmcnt(3)
    v_mfma_f32_32x32x16_bf16 v[64:79], a[236:239], v[128:131], 0
    ds_read_b128 a[228:231], v3 offset:6144
    v_rcp_f32 v52, v52
    v_mul_f32 v91, v91, v51
    v_rcp_f32_e64 v53, v53
    v_mfma_f32_32x32x16_bf16 v[64:79], a[240:243], v[132:135], v[64:79]
    ds_read_b128 a[232:235], v3 offset:7168
    buffer_load_dwordx4 v0, s[4:7], s37 offen offset:2048 lds
    v_mul_f32 v92, v92, v52
    v_rcp_f32 v54, v54
    v_mul_f32_e64 v93, v93, v53
    v_mfma_f32_32x32x16_bf16 v[64:79], a[244:247], v[136:139], v[64:79]
    ds_read_b128 a[236:239], v3 offset:8192
    v_rcp_f32 v55, v55
    v_mul_f32 v94, v94, v54
    v_cvt_pk_bf16_f32 v56, v88, v89
    s_waitcnt lgkmcnt(3)
    v_mfma_f32_32x32x16_bf16 v[64:79], a[248:251], v[140:143], v[64:79]
    ds_read_b128 a[240:243], v3 offset:9216
    buffer_load_dwordx4 v0, s[4:7], s37 offen offset:3072 lds
    v_mul_f32 v95, v95, v55
    v_cvt_pk_bf16_f32 v57, v90, v91
    v_cvt_pk_bf16_f32 v58, v92, v93
    v_cvt_pk_bf16_f32 v59, v94, v95
    v_mfma_f32_32x32x16_bf16 v[64:79], a[252:255], v[144:147], v[64:79]
    ds_read_b128 a[244:247], v3 offset:10240
    buffer_store_dwordx4 v[56:59], v0, s[4:7], s94 offen offset:1024 sc1
    v_mul_f32 v48, v96, v96
    v_mul_f32 v49, v97, v97
    v_mul_f32 v50, v98, v98
    v_mul_f32 v51, v99, v99
    v_mfma_f32_32x32x16_bf16 v[64:79], a[224:227], v[148:151], v[64:79]
    ds_read_b128 a[248:251], v3 offset:11264
    s_add_u32 m0, s35, 101376
    s_add_u32 s37, s36, 101376
    buffer_load_dword v63, s[4:7], s37 offen lds
    v_mul_f32 v52, v100, v100
    s_waitcnt lgkmcnt(3)
    v_mfma_f32_32x32x16_bf16 v[64:79], a[228:231], v[152:155], v[64:79]
    ds_read_b128 a[252:255], v3 offset:12288
    v_mul_f32 v53, v101, v101
    v_mul_f32 v54, v102, v102
    v_mul_f32_e64 v55, v103, v103
    v_fma_f32 v48, v48, v45, v44
    v_fma_f32 v49, v49, v45, v44
    v_mfma_f32_32x32x16_bf16 v[64:79], a[232:235], v[156:159], v[64:79]
    ds_read_b128 a[224:227], v3 offset:13312
    v_fma_f32 v50, v50, v45, v44
    v_fma_f32 v51, v51, v45, v44
    v_fma_f32 v52, v52, v45, v44
    v_fma_f32 v53, v53, v45, v44
    v_fma_f32 v54, v54, v45, v44
    v_mfma_f32_32x32x16_bf16 v[64:79], a[236:239], v[160:163], v[64:79]
    ds_read_b128 a[228:231], v3 offset:14336
    v_fma_f32 v55, v55, v45, v44
    v_mul_f32 v48, v48, v96
    v_mul_f32 v49, v49, v97
    v_mul_f32 v50, v50, v98
    s_waitcnt lgkmcnt(3)
    v_mfma_f32_32x32x16_bf16 v[64:79], a[240:243], v[164:167], v[64:79]
    ds_read_b128 a[232:235], v3 offset:15360
    v_mul_f32 v51, v51, v99
    v_mul_f32 v52, v52, v100
    v_mul_f32 v53, v53, v101
    v_mul_f32 v54, v54, v102
    v_mul_f32_e64 v55, v55, v103
    v_mfma_f32_32x32x16_bf16 v[64:79], a[244:247], v[168:171], v[64:79]
    ds_read_b128 a[236:239], v3 offset:16384
    v_exp_f32 v48, v48
    v_mul_f32 v104, v96, v104
    v_exp_f32_e64 v49, v49
    v_mfma_f32_32x32x16_bf16 v[64:79], a[248:251], v[172:175], v[64:79]
    ds_read_b128 a[240:243], v3 offset:17408
    v_mul_f32 v105, v97, v105
    v_exp_f32 v50, v50
    v_mul_f32 v106, v98, v106
    s_waitcnt lgkmcnt(3)
    v_mfma_f32_32x32x16_bf16 v[64:79], a[252:255], v[176:179], v[64:79]
    ds_read_b128 a[244:247], v3 offset:18432
    v_exp_f32 v51, v51
    v_mul_f32 v107, v99, v107
    v_exp_f32_e64 v52, v52
    v_mfma_f32_32x32x16_bf16 v[64:79], a[224:227], v[180:183], v[64:79]
    ds_read_b128 a[248:251], v3 offset:19456
    v_mul_f32 v108, v100, v108
    v_exp_f32 v53, v53
    v_mul_f32_e64 v109, v101, v109
    v_mfma_f32_32x32x16_bf16 v[64:79], a[228:231], v[184:187], v[64:79]
    ds_read_b128 a[252:255], v3 offset:20480
    v_exp_f32 v54, v54
    v_mul_f32_e64 v110, v102, v110
    s_waitcnt lgkmcnt(3)
    v_mfma_f32_32x32x16_bf16 v[64:79], a[232:235], v[188:191], v[64:79]
    ds_read_b128 a[224:227], v3 offset:21504
    v_exp_f32 v55, v55
    v_mul_f32 v111, v103, v111
    v_fma_f32 v48, v48, v46, v46
    v_fma_f32 v49, v49, v46, v46
    v_mfma_f32_32x32x16_bf16 v[64:79], a[236:239], v[192:195], v[64:79]
    ds_read_b128 a[228:231], v3 offset:22528
    v_fma_f32 v50, v50, v46, v46
    v_fma_f32 v51, v51, v46, v46
    v_fma_f32 v52, v52, v46, v46
    v_fma_f32 v53, v53, v46, v46
    v_fma_f32 v54, v54, v46, v46
    v_mfma_f32_32x32x16_bf16 v[64:79], a[240:243], v[196:199], v[64:79]
    ds_read_b128 a[232:235], v3 offset:23552
    v_fma_f32 v55, v55, v46, v46
    v_rcp_f32 v48, v48
    s_waitcnt lgkmcnt(3)
    v_mfma_f32_32x32x16_bf16 v[64:79], a[244:247], v[200:203], v[64:79]
    ds_read_b128 a[236:239], v3 offset:24576
    v_rcp_f32 v49, v49
    v_mul_f32 v104, v104, v48
    v_rcp_f32_e64 v50, v50
    v_mfma_f32_32x32x16_bf16 v[64:79], a[248:251], v[204:207], v[64:79]
    ds_read_b128 a[240:243], v3 offset:25600
    v_mul_f32 v105, v105, v49
    v_rcp_f32 v51, v51
    v_mul_f32_e64 v106, v106, v50
    v_mfma_f32_32x32x16_bf16 v[64:79], a[252:255], v[208:211], v[64:79]
    ds_read_b128 a[244:247], v3 offset:26624
    v_rcp_f32 v52, v52
    v_mul_f32_e64 v107, v107, v51
    s_waitcnt lgkmcnt(3)
    v_mfma_f32_32x32x16_bf16 v[64:79], a[224:227], v[212:215], v[64:79]
    ds_read_b128 a[248:251], v3 offset:27648
    v_rcp_f32 v53, v53
    v_mul_f32 v108, v108, v52
    v_rcp_f32_e64 v54, v54
    v_mfma_f32_32x32x16_bf16 v[64:79], a[228:231], v[216:219], v[64:79]
    ds_read_b128 a[252:255], v3 offset:28672
    v_mul_f32 v109, v109, v53
    v_rcp_f32 v55, v55
    v_mul_f32_e64 v110, v110, v54
    v_cvt_pk_bf16_f32 v56, v104, v105
    v_mfma_f32_32x32x16_bf16 v[64:79], a[232:235], v[220:223], v[64:79]
    ds_read_b128 a[224:227], v3 offset:29696
    v_mul_f32_e64 v111, v111, v55
    v_cvt_pk_bf16_f32 v57, v106, v107
    v_cvt_pk_bf16_f32 v58, v108, v109
    v_cvt_pk_bf16_f32 v59, v110, v111
    s_waitcnt lgkmcnt(3)
    v_mfma_f32_32x32x16_bf16 v[64:79], a[236:239], v[224:227], v[64:79]
    ds_read_b128 a[228:231], v3 offset:30720
    buffer_store_dwordx4 v[56:59], v0, s[4:7], s94 offen sc1
    v_mul_f32 v48, v112, v112
    v_mul_f32 v49, v113, v113
    v_mul_f32 v50, v114, v114
    v_mul_f32_e64 v51, v115, v115
    v_mfma_f32_32x32x16_bf16 v[64:79], a[240:243], v[228:231], v[64:79]
    ds_read_b128 a[232:235], v3 offset:31744
    v_mul_f32 v52, v116, v116
    v_mul_f32 v53, v117, v117
    v_mul_f32 v54, v118, v118
    v_mul_f32 v55, v119, v119
    v_fma_f32 v48, v48, v45, v44
    v_mfma_f32_32x32x16_bf16 v[64:79], a[244:247], v[232:235], v[64:79]
    ds_read_b128 a[236:239], v3 offset:32768
    v_fma_f32 v49, v49, v45, v44
    v_fma_f32 v50, v50, v45, v44
    v_fma_f32 v51, v51, v45, v44
    v_fma_f32 v52, v52, v45, v44
    s_waitcnt lgkmcnt(3)
    v_mfma_f32_32x32x16_bf16 v[64:79], a[248:251], v[236:239], v[64:79]
    v_fma_f32 v53, v53, v45, v44
    v_fma_f32 v54, v54, v45, v44
    v_fma_f32 v55, v55, v45, v44
    v_mul_f32 v48, v48, v112
    v_mul_f32 v49, v49, v113
    v_mul_f32 v50, v50, v114
    v_mfma_f32_32x32x16_bf16 v[64:79], a[252:255], v[240:243], v[64:79]
    s_waitcnt lgkmcnt(0)
    s_waitcnt vmcnt(11)
    s_barrier
    ds_read_b128 a[240:243], v4 offset:0
    ds_read_b128 a[244:247], v4 offset:1024
    v_mul_f32 v51, v51, v115
    v_mfma_f32_32x32x16_bf16 v[64:79], a[224:227], v[244:247], v[64:79]
    ds_read_b128 a[248:251], v4 offset:2048
    v_mul_f32 v52, v52, v116
    v_mul_f32 v53, v53, v117
    v_mul_f32 v54, v54, v118
    v_mul_f32 v55, v55, v119
    v_mfma_f32_32x32x16_bf16 v[64:79], a[228:231], v[248:251], v[64:79]
    ds_read_b128 a[252:255], v4 offset:3072
    v_exp_f32 v48, v48
    v_mul_f32 v120, v112, v120
    v_exp_f32_e64 v49, v49
    v_mfma_f32_32x32x16_bf16 v[64:79], a[232:235], v[252:255], v[64:79]
    ds_read_b128 a[224:227], v4 offset:4096
    v_mul_f32 v121, v113, v121
    v_exp_f32 v50, v50
    v_mul_f32_e64 v122, v114, v122
    v_mfma_f32_32x32x16_bf16 v[64:79], a[236:239], v[40:43], v[64:79]
    ds_read_b128 a[228:231], v4 offset:5120
    v_exp_f32 v51, v51
    v_mul_f32_e64 v123, v115, v123
    s_waitcnt lgkmcnt(3)
    v_mfma_f32_32x32x16_bf16 v[80:95], a[240:243], v[128:131], 0
    ds_read_b128 a[232:235], v4 offset:6144
    v_exp_f32 v52, v52
    v_mul_f32 v124, v116, v124
    v_exp_f32_e64 v53, v53
    v_mfma_f32_32x32x16_bf16 v[80:95], a[244:247], v[132:135], v[80:95]
    ds_read_b128 a[236:239], v4 offset:7168
    v_mul_f32 v125, v117, v125
    v_exp_f32 v54, v54
    v_mul_f32_e64 v126, v118, v126
    v_mfma_f32_32x32x16_bf16 v[80:95], a[248:251], v[136:139], v[80:95]
    ds_read_b128 a[240:243], v4 offset:8192
    v_exp_f32 v55, v55
    v_mul_f32 v127, v119, v127
    v_fma_f32 v48, v48, v46, v46
    s_waitcnt lgkmcnt(3)
    v_mfma_f32_32x32x16_bf16 v[80:95], a[252:255], v[140:143], v[80:95]
    ds_read_b128 a[244:247], v4 offset:9216
    v_fma_f32 v49, v49, v46, v46
    v_fma_f32 v50, v50, v46, v46
    v_fma_f32 v51, v51, v46, v46
    v_fma_f32 v52, v52, v46, v46
    v_fma_f32 v53, v53, v46, v46
    v_mfma_f32_32x32x16_bf16 v[80:95], a[224:227], v[144:147], v[80:95]
    ds_read_b128 a[248:251], v4 offset:10240
    v_fma_f32 v54, v54, v46, v46
    v_fma_f32 v55, v55, v46, v46
    v_rcp_f32 v48, v48
    v_mfma_f32_32x32x16_bf16 v[80:95], a[228:231], v[148:151], v[80:95]
    ds_read_b128 a[252:255], v4 offset:11264
    v_rcp_f32 v49, v49
    v_mul_f32_e64 v120, v120, v48
    s_waitcnt lgkmcnt(3)
    v_mfma_f32_32x32x16_bf16 v[80:95], a[232:235], v[152:155], v[80:95]
    ds_read_b128 a[224:227], v4 offset:12288
    v_rcp_f32 v50, v50
    v_mul_f32 v121, v121, v49
    v_rcp_f32_e64 v51, v51
    v_mfma_f32_32x32x16_bf16 v[80:95], a[236:239], v[156:159], v[80:95]
    ds_read_b128 a[228:231], v4 offset:13312
    v_mul_f32 v122, v122, v50
    v_rcp_f32 v52, v52
    v_mul_f32_e64 v123, v123, v51
    v_mfma_f32_32x32x16_bf16 v[80:95], a[240:243], v[160:163], v[80:95]
    ds_read_b128 a[232:235], v4 offset:14336
    v_rcp_f32 v53, v53
    v_mul_f32_e64 v124, v124, v52
    s_waitcnt lgkmcnt(3)
    v_mfma_f32_32x32x16_bf16 v[80:95], a[244:247], v[164:167], v[80:95]
    ds_read_b128 a[236:239], v4 offset:15360
    v_rcp_f32 v54, v54
    v_mul_f32 v125, v125, v53
    v_rcp_f32_e64 v55, v55
    v_mfma_f32_32x32x16_bf16 v[80:95], a[248:251], v[168:171], v[80:95]
    ds_read_b128 a[240:243], v4 offset:16384
    v_mul_f32_e64 v126, v126, v54
    v_cvt_pk_bf16_f32 v56, v120, v121
    v_mul_f32_e64 v127, v127, v55
    v_cvt_pk_bf16_f32 v57, v122, v123
    v_cvt_pk_bf16_f32 v58, v124, v125
    v_mfma_f32_32x32x16_bf16 v[80:95], a[252:255], v[172:175], v[80:95]
    ds_read_b128 a[244:247], v4 offset:17408
    v_cvt_pk_bf16_f32 v59, v126, v127
    buffer_store_dwordx4 v[56:59], v0, s[4:7], s73 offen offset:3072 sc1
    v_mul_f32 v48, v64, v64
    v_mul_f32_e64 v49, v65, v65
    s_waitcnt lgkmcnt(3)
    v_mfma_f32_32x32x16_bf16 v[80:95], a[224:227], v[176:179], v[80:95]
    ds_read_b128 a[248:251], v4 offset:18432
    v_mul_f32 v50, v66, v66
    v_mul_f32 v51, v67, v67
    v_mul_f32 v52, v68, v68
    v_mul_f32 v53, v69, v69
    v_mul_f32_e64 v54, v70, v70
    v_mfma_f32_32x32x16_bf16 v[80:95], a[228:231], v[180:183], v[80:95]
    ds_read_b128 a[252:255], v4 offset:19456
    v_mul_f32_e64 v55, v71, v71
    v_fma_f32 v48, v48, v45, v44
    v_fma_f32 v49, v49, v45, v44
    v_fma_f32 v50, v50, v45, v44
    v_fma_f32 v51, v51, v45, v44
    v_mfma_f32_32x32x16_bf16 v[80:95], a[232:235], v[184:187], v[80:95]
    ds_read_b128 a[224:227], v4 offset:20480
    v_fma_f32 v52, v52, v45, v44
    v_fma_f32 v53, v53, v45, v44
    v_fma_f32 v54, v54, v45, v44
    v_fma_f32 v55, v55, v45, v44
    s_waitcnt lgkmcnt(3)
    v_mfma_f32_32x32x16_bf16 v[80:95], a[236:239], v[188:191], v[80:95]
    ds_read_b128 a[228:231], v4 offset:21504
    v_mul_f32 v48, v48, v64
    v_mul_f32 v49, v49, v65
    v_mul_f32 v50, v50, v66
    v_mul_f32 v51, v51, v67
    v_mul_f32 v52, v52, v68
    v_mfma_f32_32x32x16_bf16 v[80:95], a[240:243], v[192:195], v[80:95]
    ds_read_b128 a[232:235], v4 offset:22528
    s_waitcnt vmcnt(1)
    s_mov_b64 exec, 1
    s_cmp_lg_u32 s8, 0
    s_cbranch_scc1 ss_95
    buffer_store_dwordx2 v[16:17], off, s[4:7], s87 offset:512
sb_96:
    s_mov_b64 exec, -1
    v_mfma_f32_32x32x16_bf16 v[80:95], a[244:247], v[196:199], v[80:95]
    ds_read_b128 a[236:239], v4 offset:23552
    v_mul_f32 v53, v53, v69
    v_mul_f32 v54, v54, v70
    v_mul_f32_e64 v55, v55, v71
    s_waitcnt lgkmcnt(3)
    v_mfma_f32_32x32x16_bf16 v[80:95], a[248:251], v[200:203], v[80:95]
    ds_read_b128 a[240:243], v4 offset:24576
    v_exp_f32 v48, v48
    v_mul_f32 v72, v64, v72
    v_exp_f32_e64 v49, v49
    v_mfma_f32_32x32x16_bf16 v[80:95], a[252:255], v[204:207], v[80:95]
    ds_read_b128 a[244:247], v4 offset:25600
    v_mul_f32 v73, v65, v73
    v_exp_f32 v50, v50
    v_mul_f32_e64 v74, v66, v74
    v_mfma_f32_32x32x16_bf16 v[80:95], a[224:227], v[208:211], v[80:95]
    ds_read_b128 a[248:251], v4 offset:26624
    v_exp_f32 v51, v51
    v_mul_f32_e64 v75, v67, v75
    s_waitcnt lgkmcnt(3)
    v_mfma_f32_32x32x16_bf16 v[80:95], a[228:231], v[212:215], v[80:95]
    ds_read_b128 a[252:255], v4 offset:27648
    v_exp_f32 v52, v52
    v_mul_f32 v76, v68, v76
    v_exp_f32_e64 v53, v53
    v_mfma_f32_32x32x16_bf16 v[80:95], a[232:235], v[216:219], v[80:95]
    ds_read_b128 a[224:227], v4 offset:28672
    v_mul_f32 v77, v69, v77
    v_exp_f32 v54, v54
    v_mul_f32_e64 v78, v70, v78
    v_mfma_f32_32x32x16_bf16 v[80:95], a[236:239], v[220:223], v[80:95]
    ds_read_b128 a[228:231], v4 offset:29696
    v_exp_f32 v55, v55
    v_mul_f32 v79, v71, v79
    v_fma_f32 v48, v48, v46, v46
    s_waitcnt lgkmcnt(3)
    v_mfma_f32_32x32x16_bf16 v[80:95], a[240:243], v[224:227], v[80:95]
    ds_read_b128 a[232:235], v4 offset:30720
    v_fma_f32 v49, v49, v46, v46
    v_fma_f32 v50, v50, v46, v46
    v_fma_f32 v51, v51, v46, v46
    v_fma_f32 v52, v52, v46, v46
    v_fma_f32 v53, v53, v46, v46
    v_mfma_f32_32x32x16_bf16 v[80:95], a[244:247], v[228:231], v[80:95]
    ds_read_b128 a[236:239], v4 offset:31744
    v_fma_f32 v54, v54, v46, v46
    v_fma_f32 v55, v55, v46, v46
    v_rcp_f32 v48, v48
    v_mfma_f32_32x32x16_bf16 v[80:95], a[248:251], v[232:235], v[80:95]
    ds_read_b128 a[240:243], v4 offset:32768
    v_rcp_f32 v49, v49
    v_mul_f32_e64 v72, v72, v48
    s_waitcnt lgkmcnt(3)
    v_mfma_f32_32x32x16_bf16 v[80:95], a[252:255], v[236:239], v[80:95]
    v_rcp_f32 v50, v50
    v_mul_f32 v73, v73, v49
    v_rcp_f32 v51, v51
    v_mul_f32 v74, v74, v50
    v_mfma_f32_32x32x16_bf16 v[80:95], a[224:227], v[240:243], v[80:95]
    s_waitcnt lgkmcnt(0)
    s_barrier
    ds_read_b128 a[244:247], v5 offset:0
    ds_read_b128 a[248:251], v5 offset:1024
    v_rcp_f32_e64 v52, v52
    v_mfma_f32_32x32x16_bf16 v[80:95], a[228:231], v[244:247], v[80:95]
    ds_read_b128 a[252:255], v5 offset:2048
    v_mul_f32 v75, v75, v51
    v_rcp_f32 v53, v53
    v_mul_f32_e64 v76, v76, v52
    v_mfma_f32_32x32x16_bf16 v[80:95], a[232:235], v[248:251], v[80:95]
    ds_read_b128 a[224:227], v5 offset:3072
    v_rcp_f32 v54, v54
    v_mul_f32 v77, v77, v53
    v_rcp_f32_e64 v55, v55
    v_mfma_f32_32x32x16_bf16 v[80:95], a[236:239], v[252:255], v[80:95]
    ds_read_b128 a[228:231], v5 offset:4096
    v_mul_f32_e64 v78, v78, v54
    v_cvt_pk_bf16_f32 v56, v72, v73
    v_mul_f32_e64 v79, v79, v55
    v_cvt_pk_bf16_f32 v57, v74, v75
    v_cvt_pk_bf16_f32 v58, v76, v77
    v_mfma_f32_32x32x16_bf16 v[80:95], a[240:243], v[40:43], v[80:95]
    ds_read_b128 a[232:235], v5 offset:5120
    v_cvt_pk_bf16_f32 v59, v78, v79
    buffer_store_dwordx4 v[56:59], v0, s[4:7], s73 offen offset:2048 sc1
    s_waitcnt lgkmcnt(3)
    v_mfma_f32_32x32x16_bf16 v[96:111], a[244:247], v[128:131], 0
    ds_read_b128 a[236:239], v5 offset:6144
    v_mfma_f32_32x32x16_bf16 v[96:111], a[248:251], v[132:135], v[96:111]
    ds_read_b128 a[240:243], v5 offset:7168
    v_mfma_f32_32x32x16_bf16 v[96:111], a[252:255], v[136:139], v[96:111]
    ds_read_b128 a[244:247], v5 offset:8192
    buffer_load_dwordx4 v[32:35], v0, s[4:7], s69 offen sc1
    buffer_load_dwordx4 v[36:39], v0, s[4:7], s70 offen sc1
    v_mul_f32 v48, v80, v80
    v_mul_f32 v49, v81, v81
    s_waitcnt lgkmcnt(3)
    v_mfma_f32_32x32x16_bf16 v[96:111], a[224:227], v[140:143], v[96:111]
    ds_read_b128 a[248:251], v5 offset:9216
    v_mul_f32 v50, v82, v82
    v_mul_f32 v51, v83, v83
    v_mul_f32 v52, v84, v84
    v_mul_f32 v53, v85, v85
    v_mul_f32_e64 v54, v86, v86
    v_mfma_f32_32x32x16_bf16 v[96:111], a[228:231], v[144:147], v[96:111]
    ds_read_b128 a[252:255], v5 offset:10240
    v_mul_f32_e64 v55, v87, v87
    v_fma_f32 v48, v48, v45, v44
    v_fma_f32 v49, v49, v45, v44
    v_fma_f32 v50, v50, v45, v44
    v_fma_f32 v51, v51, v45, v44
    v_mfma_f32_32x32x16_bf16 v[96:111], a[232:235], v[148:151], v[96:111]
    ds_read_b128 a[224:227], v5 offset:11264
    v_fma_f32 v52, v52, v45, v44
    v_fma_f32 v53, v53, v45, v44
    v_fma_f32 v54, v54, v45, v44
    v_fma_f32 v55, v55, v45, v44
    s_waitcnt lgkmcnt(3)
    v_mfma_f32_32x32x16_bf16 v[96:111], a[236:239], v[152:155], v[96:111]
    ds_read_b128 a[228:231], v5 offset:12288
    v_mul_f32 v48, v48, v80
    v_mul_f32 v49, v49, v81
    v_mul_f32 v50, v50, v82
    v_mul_f32 v51, v51, v83
    v_mul_f32 v52, v52, v84
    v_mfma_f32_32x32x16_bf16 v[96:111], a[240:243], v[156:159], v[96:111]
    ds_read_b128 a[232:235], v5 offset:13312
    v_mul_f32 v53, v53, v85
    v_mul_f32 v54, v54, v86
    v_mul_f32 v55, v55, v87
    v_exp_f32 v48, v48
    v_mfma_f32_32x32x16_bf16 v[96:111], a[244:247], v[160:163], v[96:111]
    ds_read_b128 a[236:239], v5 offset:14336
    buffer_load_dwordx2 v[60:61], v15, s[4:7], s92 offen offset:512 sc1
    v_mul_f32 v88, v80, v88
    v_exp_f32_e64 v49, v49
    s_waitcnt lgkmcnt(3)
    v_mfma_f32_32x32x16_bf16 v[96:111], a[248:251], v[164:167], v[96:111]
    ds_read_b128 a[240:243], v5 offset:15360
    v_mul_f32 v89, v81, v89
    v_exp_f32 v50, v50
    v_mul_f32_e64 v90, v82, v90
    v_mfma_f32_32x32x16_bf16 v[96:111], a[252:255], v[168:171], v[96:111]
    ds_read_b128 a[244:247], v5 offset:16384
    v_exp_f32 v51, v51
    v_mul_f32 v91, v83, v91
    v_exp_f32_e64 v52, v52
    v_mfma_f32_32x32x16_bf16 v[96:111], a[224:227], v[172:175], v[96:111]
    ds_read_b128 a[248:251], v5 offset:17408
    v_mul_f32 v92, v84, v92
    v_exp_f32 v53, v53
    v_mul_f32 v93, v85, v93
    s_waitcnt lgkmcnt(3)
    v_mfma_f32_32x32x16_bf16 v[96:111], a[228:231], v[176:179], v[96:111]
    ds_read_b128 a[252:255], v5 offset:18432
    v_exp_f32 v54, v54
    v_mul_f32 v94, v86, v94
    v_exp_f32_e64 v55, v55
    v_mfma_f32_32x32x16_bf16 v[96:111], a[232:235], v[180:183], v[96:111]
    ds_read_b128 a[224:227], v5 offset:19456
    v_mul_f32_e64 v95, v87, v95
    v_fma_f32 v48, v48, v46, v46
    v_fma_f32 v49, v49, v46, v46
    v_fma_f32 v50, v50, v46, v46
    v_fma_f32 v51, v51, v46, v46
    v_mfma_f32_32x32x16_bf16 v[96:111], a[236:239], v[184:187], v[96:111]
    ds_read_b128 a[228:231], v5 offset:20480
    v_fma_f32 v52, v52, v46, v46
    v_fma_f32 v53, v53, v46, v46
    v_fma_f32 v54, v54, v46, v46
    v_fma_f32 v55, v55, v46, v46
    s_waitcnt lgkmcnt(3)
    v_mfma_f32_32x32x16_bf16 v[96:111], a[240:243], v[188:191], v[96:111]
    ds_read_b128 a[232:235], v5 offset:21504
    v_rcp_f32 v48, v48
    v_rcp_f32 v49, v49
    v_mul_f32 v88, v88, v48
    v_mfma_f32_32x32x16_bf16 v[96:111], a[244:247], v[192:195], v[96:111]
    ds_read_b128 a[236:239], v5 offset:22528
    v_rcp_f32 v50, v50
    v_mul_f32 v89, v89, v49
    v_rcp_f32_e64 v51, v51
    v_mfma_f32_32x32x16_bf16 v[96:111], a[248:251], v[196:199], v[96:111]
    ds_read_b128 a[240:243], v5 offset:23552
    v_mul_f32 v90, v90, v50
    v_rcp_f32 v52, v52
    v_mul_f32 v91, v91, v51
    s_waitcnt lgkmcnt(3)
    v_mfma_f32_32x32x16_bf16 v[96:111], a[252:255], v[200:203], v[96:111]
    ds_read_b128 a[244:247], v5 offset:24576
    v_rcp_f32 v53, v53
    v_mul_f32 v92, v92, v52
    v_rcp_f32_e64 v54, v54
    v_mfma_f32_32x32x16_bf16 v[96:111], a[224:227], v[204:207], v[96:111]
    ds_read_b128 a[248:251], v5 offset:25600
    v_mul_f32 v93, v93, v53
    v_rcp_f32 v55, v55
    v_mul_f32_e64 v94, v94, v54
    v_cvt_pk_bf16_f32 v56, v88, v89
    v_mfma_f32_32x32x16_bf16 v[96:111], a[228:231], v[208:211], v[96:111]
    ds_read_b128 a[252:255], v5 offset:26624
    v_mul_f32_e64 v95, v95, v55
    v_cvt_pk_bf16_f32 v57, v90, v91
    v_cvt_pk_bf16_f32 v58, v92, v93
    v_cvt_pk_bf16_f32 v59, v94, v95
    s_waitcnt lgkmcnt(3)
    v_mfma_f32_32x32x16_bf16 v[96:111], a[232:235], v[212:215], v[96:111]
    ds_read_b128 a[224:227], v5 offset:27648
    buffer_store_dwordx4 v[56:59], v0, s[4:7], s73 offen offset:1024 sc1
    v_mfma_f32_32x32x16_bf16 v[96:111], a[236:239], v[216:219], v[96:111]
    ds_read_b128 a[228:231], v5 offset:28672
    v_mfma_f32_32x32x16_bf16 v[96:111], a[240:243], v[220:223], v[96:111]
    ds_read_b128 a[232:235], v5 offset:29696
    s_waitcnt lgkmcnt(3)
    v_mfma_f32_32x32x16_bf16 v[96:111], a[244:247], v[224:227], v[96:111]
    ds_read_b128 a[236:239], v5 offset:30720
    v_mfma_f32_32x32x16_bf16 v[96:111], a[248:251], v[228:231], v[96:111]
    ds_read_b128 a[240:243], v5 offset:31744
    v_mfma_f32_32x32x16_bf16 v[96:111], a[252:255], v[232:235], v[96:111]
    ds_read_b128 a[244:247], v5 offset:32768
    s_waitcnt lgkmcnt(3)
    v_mfma_f32_32x32x16_bf16 v[96:111], a[224:227], v[236:239], v[96:111]
    v_mfma_f32_32x32x16_bf16 v[96:111], a[228:231], v[240:243], v[96:111]
    s_waitcnt vmcnt(4)
    s_mov_b64 exec, 1
    s_cmp_lg_u32 s8, 0
    s_cbranch_scc1 ss_97
    buffer_store_dwordx2 v[16:17], off, s[4:7], s87 offset:640
sb_98:
    s_mov_b64 exec, -1
    v_mfma_f32_32x32x16_bf16 v[96:111], a[232:235], v[244:247], v[96:111]
    s_waitcnt lgkmcnt(2)
    v_mfma_f32_32x32x16_bf16 v[96:111], a[236:239], v[248:251], v[96:111]
    s_waitcnt lgkmcnt(1)
    v_mfma_f32_32x32x16_bf16 v[96:111], a[240:243], v[252:255], v[96:111]
    s_waitcnt lgkmcnt(0)
    v_mfma_f32_32x32x16_bf16 v[96:111], a[244:247], v[40:43], v[96:111]
    s_waitcnt vmcnt(2)
    v_cmp_ne_u64_e64 vcc, s[28:29], v[60:61]
    s_cbranch_vccnz fstub_99
fback_100:
    s_nop 8
    v_pk_mul_f32 v[48:49], v[96:97], v[96:97]
    buffer_load_dwordx4 v[128:131], v0, s[4:7], s41 offen offset:2048 sc1
    v_pk_mul_f32 v[50:51], v[98:99], v[98:99]
    v_pk_mul_f32 v[52:53], v[100:101], v[100:101]
    v_pk_mul_f32 v[54:55], v[102:103], v[102:103]
    v_pk_fma_f32 v[48:49], v[48:49], v[44:45], v[44:45] op_sel:[0,1,0] op_sel_hi:[1,1,0]
    v_pk_fma_f32 v[50:51], v[50:51], v[44:45], v[44:45] op_sel:[0,1,0] op_sel_hi:[1,1,0]
    v_pk_fma_f32 v[52:53], v[52:53], v[44:45], v[44:45] op_sel:[0,1,0] op_sel_hi:[1,1,0]
    buffer_load_dwordx4 v[132:135], v0, s[4:7], s43 offen offset:2048 sc1
    v_pk_fma_f32 v[54:55], v[54:55], v[44:45], v[44:45] op_sel:[0,1,0] op_sel_hi:[1,1,0]
    v_pk_mul_f32 v[48:49], v[48:49], v[96:97]
    v_pk_mul_f32 v[50:51], v[50:51], v[98:99]
    v_pk_mul_f32 v[52:53], v[52:53], v[100:101]
    v_pk_mul_f32 v[54:55], v[54:55], v[102:103]
    v_exp_f32_e64 v48, v48
    buffer_load_dwordx4 v[136:139], v0, s[4:7], s45 offen offset:2048 sc1
    v_exp_f32 v49, v49
    v_exp_f32 v50, v50
    v_exp_f32_e64 v51, v51
    buffer_load_dwordx4 v[140:143], v0, s[4:7], s47 offen offset:2048 sc1
    v_exp_f32 v52, v52
    v_exp_f32 v53, v53
    v_exp_f32_e64 v54, v54
    buffer_load_dwordx4 v[144:147], v0, s[4:7], s41 offen offset:1024 sc1
    v_exp_f32_e64 v55, v55
    v_pk_mul_f32 v[104:105], v[96:97], v[104:105]
    v_pk_mul_f32 v[106:107], v[98:99], v[106:107]
    v_pk_mul_f32 v[108:109], v[100:101], v[108:109]
    v_pk_mul_f32 v[110:111], v[102:103], v[110:111]
    buffer_load_dwordx4 v[148:151], v0, s[4:7], s43 offen offset:1024 sc1
    v_pk_fma_f32 v[48:49], v[48:49], v[46:47], v[46:47] op_sel:[0,0,0] op_sel_hi:[1,0,0]
    v_pk_fma_f32 v[50:51], v[50:51], v[46:47], v[46:47] op_sel:[0,0,0] op_sel_hi:[1,0,0]
    v_pk_fma_f32 v[52:53], v[52:53], v[46:47], v[46:47] op_sel:[0,0,0] op_sel_hi:[1,0,0]
    v_pk_fma_f32 v[54:55], v[54:55], v[46:47], v[46:47] op_sel:[0,0,0] op_sel_hi:[1,0,0]
    v_rcp_f32_e64 v48, v48
    buffer_load_dwordx4 v[152:155], v0, s[4:7], s45 offen offset:1024 sc1
    v_rcp_f32 v49, v49
    v_rcp_f32 v50, v50
    v_rcp_f32_e64 v51, v51
    buffer_load_dwordx4 v[156:159], v0, s[4:7], s47 offen offset:1024 sc1
    v_rcp_f32 v52, v52
    v_rcp_f32 v53, v53
    v_rcp_f32_e64 v54, v54
    buffer_load_dwordx4 v[160:163], v0, s[4:7], s41 offen sc1
    v_rcp_f32_e64 v55, v55
    v_pk_mul_f32 v[104:105], v[104:105], v[48:49]
    v_pk_mul_f32 v[106:107], v[106:107], v[50:51]
    v_pk_mul_f32 v[108:109], v[108:109], v[52:53]
    v_pk_mul_f32 v[110:111], v[110:111], v[54:55]
    buffer_load_dwordx4 v[164:167], v0, s[4:7], s43 offen sc1
    v_cvt_pk_bf16_f32 v56, v104, v105
    v_cvt_pk_bf16_f32 v57, v106, v107
    v_cvt_pk_bf16_f32 v58, v108, v109
    v_cvt_pk_bf16_f32 v59, v110, v111
    buffer_store_dwordx4 v[56:59], v0, s[4:7], s73 offen sc1
    buffer_load_dwordx4 v[168:171], v0, s[4:7], s45 offen sc1
L_p4_1:
    v_lshlrev_b32_e64 v14, 6, v0
    v_and_b32 v14, 0x7c00, v14
    v_lshrrev_b32_e64 v48, 9, v0
    v_lshl_add_u32 v14, v48, 4, v14
    v_lshlrev_b32_e64 v64, 16, v32
    v_and_b32 v65, 0xffff0000, v32
    v_lshlrev_b32_e64 v66, 16, v33
    v_and_b32 v67, 0xffff0000, v33
    v_lshlrev_b32_e64 v68, 16, v34
    v_and_b32 v69, 0xffff0000, v34
    v_lshlrev_b32_e64 v70, 16, v35
    v_and_b32 v71, 0xffff0000, v35
    v_mov_b64 v[72:73], 0
    v_mov_b64 v[74:75], 0
    v_mov_b64 v[76:77], 0
    v_mov_b64 v[78:79], 0
    v_lshlrev_b32_e64 v96, 16, v36
    v_and_b32 v97, 0xffff0000, v36
    v_lshlrev_b32_e64 v98, 16, v37
    v_and_b32 v99, 0xffff0000, v37
    v_lshlrev_b32_e64 v100, 16, v38
    v_and_b32 v101, 0xffff0000, v38
    v_lshlrev_b32_e64 v102, 16, v39
    v_and_b32 v103, 0xffff0000, v39
    v_mov_b64 v[104:105], 0
    v_mov_b64 v[106:107], 0
    v_mov_b64 v[108:109], 0
    v_mov_b64 v[110:111], 0
    v_add_u32 v24, s99, v20
    v_add_u32 v25, s100, v20
    v_add_u32 v26, s101, v20
    v_add_u32 v27, s3, v20
    s_add_u32 s39, s3, 135168
    v_add_u32_e64 v28, s39, v1
    s_and_b32 s39, s32, 1
    s_lshl_b32 s39, s39, 8
    s_add_u32 s39, s39, 135168
    v_add_u32 v29, s39, v1
    s_waitcnt vmcnt(11)
    v_mfma_f32_32x32x16_bf16 v[64:79], a[24:27], v[128:131], v[64:79]
    buffer_load_dwordx4 v[172:175], v0, s[4:7], s47 offen sc1
    v_mfma_f32_32x32x16_bf16 v[80:95], a[136:139], v[128:131], 0
    s_waitcnt vmcnt(11)
    v_mfma_f32_32x32x16_bf16 v[64:79], a[52:55], v[132:135], v[64:79]
    buffer_load_dwordx4 v[176:179], v0, s[4:7], s49 offen offset:2048 sc1
    v_mfma_f32_32x32x16_bf16 v[80:95], a[164:167], v[132:135], v[80:95]
    s_waitcnt vmcnt(11)
    v_mfma_f32_32x32x16_bf16 v[64:79], a[80:83], v[136:139], v[64:79]
    buffer_load_dwordx2 v[60:61], v15, s[4:7], s92 offen offset:640 sc1
    buffer_load_dwordx4 v[180:183], v0, s[4:7], s51 offen offset:2048 sc1
    v_mfma_f32_32x32x16_bf16 v[80:95], a[192:195], v[136:139], v[80:95]
    s_waitcnt vmcnt(12)
    v_mfma_f32_32x32x16_bf16 v[64:79], a[108:111], v[140:143], v[64:79]
    buffer_load_dwordx4 v[184:187], v0, s[4:7], s53 offen offset:2048 sc1
    v_mfma_f32_32x32x16_bf16 v[80:95], a[220:223], v[140:143], v[80:95]
    s_waitcnt vmcnt(12)
    v_mfma_f32_32x32x16_bf16 v[64:79], a[20:23], v[144:147], v[64:79]
    buffer_load_dwordx4 v[188:191], v0, s[4:7], s55 offen offset:2048 sc1
    v_mfma_f32_32x32x16_bf16 v[80:95], a[132:135], v[144:147], v[80:95]
    s_waitcnt vmcnt(12)
    v_mfma_f32_32x32x16_bf16 v[64:79], a[48:51], v[148:151], v[64:79]
    buffer_load_dwordx4 v[192:195], v0, s[4:7], s49 offen offset:1024 sc1
    v_mfma_f32_32x32x16_bf16 v[80:95], a[160:163], v[148:151], v[80:95]
    s_waitcnt vmcnt(12)
    v_mfma_f32_32x32x16_bf16 v[64:79], a[76:79], v[152:155], v[64:79]
    buffer_load_dwordx4 v[196:199], v0, s[4:7], s51 offen offset:1024 sc1
    v_mfma_f32_32x32x16_bf16 v[80:95], a[188:191], v[152:155], v[80:95]
    s_waitcnt vmcnt(12)
    v_mfma_f32_32x32x16_bf16 v[64:79], a[104:107], v[156:159], v[64:79]
    buffer_load_dwordx4 v[200:203], v0, s[4:7], s53 offen offset:1024 sc1
    v_mfma_f32_32x32x16_bf16 v[80:95], a[216:219], v[156:159], v[80:95]
    s_waitcnt vmcnt(12)
    v_mfma_f32_32x32x16_bf16 v[64:79], a[16:19], v[160:163], v[64:79]
    buffer_load_dwordx4 v[204:207], v0, s[4:7], s55 offen offset:1024 sc1
    v_mfma_f32_32x32x16_bf16 v[80:95], a[128:131], v[160:163], v[80:95]
    s_waitcnt vmcnt(12)
    v_mfma_f32_32x32x16_bf16 v[64:79], a[44:47], v[164:167], v[64:79]
    buffer_load_dwordx4 v[208:211], v0, s[4:7], s49 offen sc1
    v_mfma_f32_32x32x16_bf16 v[80:95], a[156:159], v[164:167], v[80:95]
    s_waitcnt vmcnt(11)
    v_mfma_f32_32x32x16_bf16 v[64:79], a[72:75], v[168:171], v[64:79]
    buffer_load_dwordx4 v[212:215], v0, s[4:7], s51 offen sc1
    v_mfma_f32_32x32x16_bf16 v[80:95], a[184:187], v[168:171], v[80:95]
    s_waitcnt vmcnt(11)
    v_mfma_f32_32x32x16_bf16 v[64:79], a[100:103], v[172:175], v[64:79]
    s_mov_b64 exec, 1
    s_cmp_lg_u32 s8, 0
    s_cbranch_scc1 ss_101
    buffer_store_dwordx2 v[16:17], off, s[4:7], s87 offset:768
sb_102:
    s_mov_b64 exec, -1
    buffer_load_dwordx4 v[216:219], v0, s[4:7], s53 offen sc1
    v_mfma_f32_32x32x16_bf16 v[80:95], a[212:215], v[172:175], v[80:95]
    s_waitcnt vmcnt(12)
    v_mfma_f32_32x32x16_bf16 v[96:111], a[24:27], v[176:179], v[96:111]
    buffer_load_dwordx4 v[220:223], v0, s[4:7], s55 offen sc1
    v_mfma_f32_32x32x16_bf16 v[112:127], a[136:139], v[176:179], 0
    s_waitcnt vmcnt(11)
    v_mfma_f32_32x32x16_bf16 v[96:111], a[52:55], v[180:183], v[96:111]
    v_cmp_ne_u64_e64 vcc, s[28:29], v[60:61]
    s_cbranch_vccnz fstub_103
fback_104:
    buffer_load_dwordx4 v[224:227], v0, s[4:7], s40 offen offset:3072 sc1
    v_mfma_f32_32x32x16_bf16 v[112:127], a[164:167], v[180:183], v[112:127]
    s_waitcnt vmcnt(11)
    v_mfma_f32_32x32x16_bf16 v[96:111], a[80:83], v[184:187], v[96:111]
    buffer_load_dwordx4 v[228:231], v0, s[4:7], s42 offen offset:3072 sc1
    v_mfma_f32_32x32x16_bf16 v[112:127], a[192:195], v[184:187], v[112:127]
    s_waitcnt vmcnt(11)
    v_mfma_f32_32x32x16_bf16 v[96:111], a[108:111], v[188:191], v[96:111]
    buffer_load_dwordx4 v[232:235], v0, s[4:7], s44 offen offset:3072 sc1
    v_mfma_f32_32x32x16_bf16 v[112:127], a[220:223], v[188:191], v[112:127]
    s_waitcnt vmcnt(11)
    v_mfma_f32_32x32x16_bf16 v[96:111], a[20:23], v[192:195], v[96:111]
    buffer_load_dwordx4 v[236:239], v0, s[4:7], s46 offen offset:3072 sc1
    v_mfma_f32_32x32x16_bf16 v[112:127], a[132:135], v[192:195], v[112:127]
    s_waitcnt vmcnt(11)
    v_mfma_f32_32x32x16_bf16 v[96:111], a[48:51], v[196:199], v[96:111]
    buffer_load_dwordx4 v[240:243], v0, s[4:7], s40 offen offset:2048 sc1
    v_mfma_f32_32x32x16_bf16 v[112:127], a[160:163], v[196:199], v[112:127]
    s_waitcnt vmcnt(11)
    v_mfma_f32_32x32x16_bf16 v[96:111], a[76:79], v[200:203], v[96:111]
    buffer_load_dwordx2 v[60:61], v15, s[4:7], s92 offen offset:768 sc1
    buffer_load_dwordx4 v[244:247], v0, s[4:7], s42 offen offset:2048 sc1
    v_mfma_f32_32x32x16_bf16 v[112:127], a[188:191], v[200:203], v[112:127]
    s_waitcnt vmcnt(12)
    v_mfma_f32_32x32x16_bf16 v[96:111], a[104:107], v[204:207], v[96:111]
    buffer_load_dwordx4 v[248:251], v0, s[4:7], s44 offen offset:2048 sc1
    v_mfma_f32_32x32x16_bf16 v[112:127], a[216:219], v[204:207], v[112:127]
    s_waitcnt vmcnt(12)
    v_mfma_f32_32x32x16_bf16 v[96:111], a[16:19], v[208:211], v[96:111]
    buffer_load_dwordx4 v[252:255], v0, s[4:7], s46 offen offset:2048 sc1
    v_mfma_f32_32x32x16_bf16 v[112:127], a[128:131], v[208:211], v[112:127]
    s_waitcnt vmcnt(12)
    v_mfma_f32_32x32x16_bf16 v[96:111], a[44:47], v[212:215], v[96:111]
    buffer_load_dwordx4 v[128:131], v0, s[4:7], s48 offen offset:3072 sc1
    v_mfma_f32_32x32x16_bf16 v[112:127], a[156:159], v[212:215], v[112:127]
    s_waitcnt vmcnt(11)
    v_mfma_f32_32x32x16_bf16 v[96:111], a[72:75], v[216:219], v[96:111]
    buffer_load_dwordx4 v[132:135], v0, s[4:7], s50 offen offset:3072 sc1
    v_mfma_f32_32x32x16_bf16 v[112:127], a[184:187], v[216:219], v[112:127]
    s_waitcnt vmcnt(11)
    v_mfma_f32_32x32x16_bf16 v[96:111], a[100:103], v[220:223], v[96:111]
    buffer_load_dwordx4 v[136:139], v0, s[4:7], s52 offen offset:3072 sc1
    v_mfma_f32_32x32x16_bf16 v[112:127], a[212:215], v[220:223], v[112:127]
    s_waitcnt vmcnt(11)
    v_mfma_f32_32x32x16_bf16 v[64:79], a[12:15], v[224:227], v[64:79]
    buffer_load_dwordx4 v[140:143], v0, s[4:7], s54 offen offset:3072 sc1
    v_mfma_f32_32x32x16_bf16 v[80:95], a[124:127], v[224:227], v[80:95]
    s_waitcnt vmcnt(11)
    v_mfma_f32_32x32x16_bf16 v[64:79], a[40:43], v[228:231], v[64:79]
    buffer_load_dwordx4 v[144:147], v0, s[4:7], s48 offen offset:2048 sc1
    v_mfma_f32_32x32x16_bf16 v[80:95], a[152:155], v[228:231], v[80:95]
    s_waitcnt vmcnt(11)
    v_mfma_f32_32x32x16_bf16 v[64:79], a[68:71], v[232:235], v[64:79]
    buffer_load_dwordx4 v[148:151], v0, s[4:7], s50 offen offset:2048 sc1
    v_mfma_f32_32x32x16_bf16 v[80:95], a[180:183], v[232:235], v[80:95]
    s_waitcnt vmcnt(11)
    v_mfma_f32_32x32x16_bf16 v[64:79], a[96:99], v[236:239], v[64:79]
    buffer_load_dwordx4 v[152:155], v0, s[4:7], s52 offen offset:2048 sc1
    v_mfma_f32_32x32x16_bf16 v[80:95], a[208:211], v[236:239], v[80:95]
    s_waitcnt vmcnt(11)
    v_mfma_f32_32x32x16_bf16 v[64:79], a[8:11], v[240:243], v[64:79]
    buffer_load_dwordx4 v[156:159], v0, s[4:7], s54 offen offset:2048 sc1
    v_mfma_f32_32x32x16_bf16 v[80:95], a[120:123], v[240:243], v[80:95]
    s_waitcnt vmcnt(10)
    v_mfma_f32_32x32x16_bf16 v[64:79], a[36:39], v[244:247], v[64:79]
    v_cmp_ne_u64 vcc, s[28:29], v[60:61]
    s_cbranch_vccnz fstub_105
fback_106:
    buffer_load_dwordx4 v[160:163], v0, s[4:7], s40 offen offset:1024 sc1
    v_mfma_f32_32x32x16_bf16 v[80:95], a[148:151], v[244:247], v[80:95]
    s_waitcnt vmcnt(10)
    v_mfma_f32_32x32x16_bf16 v[64:79], a[64:67], v[248:251], v[64:79]
    buffer_load_dwordx4 v[164:167], v0, s[4:7], s42 offen offset:1024 sc1
    v_mfma_f32_32x32x16_bf16 v[80:95], a[176:179], v[248:251], v[80:95]
    s_waitcnt vmcnt(10)
    v_mfma_f32_32x32x16_bf16 v[64:79], a[92:95], v[252:255], v[64:79]
    buffer_load_dwordx4 v[168:171], v0, s[4:7], s44 offen offset:1024 sc1
    v_mfma_f32_32x32x16_bf16 v[80:95], a[204:207], v[252:255], v[80:95]
    s_waitcnt vmcnt(10)
    v_mfma_f32_32x32x16_bf16 v[96:111], a[12:15], v[128:131], v[96:111]
    buffer_load_dwordx4 v[172:175], v0, s[4:7], s46 offen offset:1024 sc1
    v_mfma_f32_32x32x16_bf16 v[112:127], a[124:127], v[128:131], v[112:127]
    s_waitcnt vmcnt(10)
    v_mfma_f32_32x32x16_bf16 v[96:111], a[40:43], v[132:135], v[96:111]
    buffer_load_dwordx4 v[176:179], v0, s[4:7], s40 offen sc1
    v_mfma_f32_32x32x16_bf16 v[112:127], a[152:155], v[132:135], v[112:127]
    s_waitcnt vmcnt(10)
    v_mfma_f32_32x32x16_bf16 v[96:111], a[68:71], v[136:139], v[96:111]
    buffer_load_dwordx4 v[180:183], v0, s[4:7], s42 offen sc1
    v_mfma_f32_32x32x16_bf16 v[112:127], a[180:183], v[136:139], v[112:127]
    s_waitcnt vmcnt(10)
    v_mfma_f32_32x32x16_bf16 v[96:111], a[96:99], v[140:143], v[96:111]
    buffer_load_dwordx4 v[184:187], v0, s[4:7], s44 offen sc1
    v_mfma_f32_32x32x16_bf16 v[112:127], a[208:211], v[140:143], v[112:127]
    s_waitcnt vmcnt(10)
    v_mfma_f32_32x32x16_bf16 v[96:111], a[8:11], v[144:147], v[96:111]
    buffer_load_dwordx4 v[188:191], v0, s[4:7], s46 offen sc1
    v_mfma_f32_32x32x16_bf16 v[112:127], a[120:123], v[144:147], v[112:127]
    s_waitcnt vmcnt(10)
    v_mfma_f32_32x32x16_bf16 v[96:111], a[36:39], v[148:151], v[96:111]
    buffer_load_dwordx4 v[192:195], v0, s[4:7], s48 offen offset:1024 sc1
    v_mfma_f32_32x32x16_bf16 v[112:127], a[148:151], v[148:151], v[112:127]
    s_waitcnt vmcnt(10)
    v_mfma_f32_32x32x16_bf16 v[96:111], a[64:67], v[152:155], v[96:111]
    buffer_load_dwordx4 v[196:199], v0, s[4:7], s50 offen offset:1024 sc1
    v_mfma_f32_32x32x16_bf16 v[112:127], a[176:179], v[152:155], v[112:127]
    s_waitcnt vmcnt(10)
    v_mfma_f32_32x32x16_bf16 v[96:111], a[92:95], v[156:159], v[96:111]
    buffer_load_dwordx4 v[200:203], v0, s[4:7], s52 offen offset:1024 sc1
    v_mfma_f32_32x32x16_bf16 v[112:127], a[204:207], v[156:159], v[112:127]
    s_waitcnt vmcnt(10)
    v_mfma_f32_32x32x16_bf16 v[64:79], a[4:7], v[160:163], v[64:79]
    buffer_load_dwordx4 v[204:207], v0, s[4:7], s54 offen offset:1024 sc1
    v_mfma_f32_32x32x16_bf16 v[80:95], a[116:119], v[160:163], v[80:95]
    s_waitcnt vmcnt(10)
    v_mfma_f32_32x32x16_bf16 v[64:79], a[32:35], v[164:167], v[64:79]
    buffer_load_dwordx4 v[208:211], v0, s[4:7], s48 offen sc1
    v_mfma_f32_32x32x16_bf16 v[80:95], a[144:147], v[164:167], v[80:95]
    s_waitcnt vmcnt(10)
    v_mfma_f32_32x32x16_bf16 v[64:79], a[60:63], v[168:171], v[64:79]
    buffer_load_dwordx4 v[212:215], v0, s[4:7], s50 offen sc1
    v_mfma_f32_32x32x16_bf16 v[80:95], a[172:175], v[168:171], v[80:95]
    s_waitcnt vmcnt(10)
    v_mfma_f32_32x32x16_bf16 v[64:79], a[88:91], v[172:175], v[64:79]
    buffer_load_dwordx4 v[216:219], v0, s[4:7], s52 offen sc1
    v_mfma_f32_32x32x16_bf16 v[80:95], a[200:203], v[172:175], v[80:95]
    s_waitcnt vmcnt(10)
    v_mfma_f32_32x32x16_bf16 v[64:79], a[0:3], v[176:179], v[64:79]
    buffer_load_dwordx4 v[220:223], v0, s[4:7], s54 offen sc1
    v_mfma_f32_32x32x16_bf16 v[80:95], a[112:115], v[176:179], v[80:95]
    s_waitcnt vmcnt(10)
    v_mfma_f32_32x32x16_bf16 v[64:79], a[28:31], v[180:183], v[64:79]
    v_mfma_f32_32x32x16_bf16 v[80:95], a[140:143], v[180:183], v[80:95]
    s_waitcnt vmcnt(9)
    v_mfma_f32_32x32x16_bf16 v[64:79], a[56:59], v[184:187], v[64:79]
    v_mfma_f32_32x32x16_bf16 v[80:95], a[168:171], v[184:187], v[80:95]
    s_waitcnt vmcnt(8)
    v_mfma_f32_32x32x16_bf16 v[64:79], a[84:87], v[188:191], v[64:79]
    v_mfma_f32_32x32x16_bf16 v[80:95], a[196:199], v[188:191], v[80:95]
    s_waitcnt vmcnt(7)
    v_mfma_f32_32x32x16_bf16 v[96:111], a[4:7], v[192:195], v[96:111]
    v_mfma_f32_32x32x16_bf16 v[112:127], a[116:119], v[192:195], v[112:127]
    s_nop 7
    ds_write_b128 v24, v[72:75]
    s_waitcnt vmcnt(6)
    v_mfma_f32_32x32x16_bf16 v[96:111], a[32:35], v[196:199], v[96:111]
    ds_write_b128 v24, v[76:79] offset:1024
    v_mfma_f32_32x32x16_bf16 v[112:127], a[144:147], v[196:199], v[112:127]
    ds_write_b128 v25, v[80:83]
    s_waitcnt vmcnt(5)
    v_mfma_f32_32x32x16_bf16 v[96:111], a[60:63], v[200:203], v[96:111]
    ds_write_b128 v25, v[84:87] offset:1024
    v_mfma_f32_32x32x16_bf16 v[112:127], a[172:175], v[200:203], v[112:127]
    ds_write_b128 v26, v[88:91]
    s_waitcnt vmcnt(4)
    v_mfma_f32_32x32x16_bf16 v[96:111], a[88:91], v[204:207], v[96:111]
    ds_write_b128 v26, v[92:95] offset:1024
    v_mfma_f32_32x32x16_bf16 v[112:127], a[200:203], v[204:207], v[112:127]
    s_waitcnt lgkmcnt(0)
    s_barrier
    ds_read_b128 v[72:75], v27 offset:0
    ds_read_b128 v[76:79], v27 offset:1024
    ds_read_b128 v[80:83], v27 offset:2048
    s_waitcnt vmcnt(3)
    v_mfma_f32_32x32x16_bf16 v[96:111], a[0:3], v[208:211], v[96:111]
    ds_read_b128 v[84:87], v27 offset:3072
    ds_read_b128 v[88:91], v27 offset:4096
    ds_read_b128 v[92:95], v27 offset:5120
    s_waitcnt lgkmcnt(5)
    v_add_f32 v64, v64, v72
    v_add_f32_e64 v65, v65, v73
    v_mfma_f32_32x32x16_bf16 v[112:127], a[112:115], v[208:211], v[112:127]
    v_add_f32 v66, v66, v74
    v_add_f32 v67, v67, v75
    s_waitcnt lgkmcnt(4)
    v_add_f32 v68, v68, v76
    v_add_f32 v69, v69, v77
    s_waitcnt vmcnt(2)
    v_mfma_f32_32x32x16_bf16 v[96:111], a[28:31], v[212:215], v[96:111]
    v_add_f32 v70, v70, v78
    v_add_f32 v71, v71, v79
    s_waitcnt lgkmcnt(3)
    v_add_f32 v64, v64, v80
    v_add_f32 v65, v65, v81
    v_add_f32 v66, v66, v82
    v_mfma_f32_32x32x16_bf16 v[112:127], a[140:143], v[212:215], v[112:127]
    v_add_f32 v67, v67, v83
    s_waitcnt lgkmcnt(2)
    v_add_f32 v68, v68, v84
    v_add_f32 v69, v69, v85
    v_add_f32 v70, v70, v86
    s_waitcnt vmcnt(1)
    v_mfma_f32_32x32x16_bf16 v[96:111], a[56:59], v[216:219], v[96:111]
    v_add_f32 v71, v71, v87
    s_waitcnt lgkmcnt(1)
    v_add_f32 v64, v64, v88
    v_add_f32 v65, v65, v89
    v_add_f32 v66, v66, v90
    v_add_f32 v67, v67, v91
    v_mfma_f32_32x32x16_bf16 v[112:127], a[168:171], v[216:219], v[112:127]
    s_waitcnt lgkmcnt(0)
    v_add_f32 v68, v68, v92
    v_add_f32 v69, v69, v93
    v_add_f32 v70, v70, v94
    v_add_f32 v71, v71, v95
    s_waitcnt vmcnt(0)
    v_mfma_f32_32x32x16_bf16 v[96:111], a[84:87], v[220:223], v[96:111]
    s_barrier
    v_cvt_pk_bf16_f32 v72, v64, v65
    v_cvt_pk_bf16_f32 v73, v66, v67
    v_cvt_pk_bf16_f32 v74, v68, v69
    v_cvt_pk_bf16_f32 v75, v70, v71
    v_mfma_f32_32x32x16_bf16 v[112:127], a[196:199], v[220:223], v[112:127]
    v_permlane32_swap_b32 v72, v74
    v_permlane32_swap_b32_e64 v73, v75
    buffer_store_dwordx4 v[72:75], v14, s[20:23], s85 offen
    s_nop 2
    ds_write_b128 v24, v[104:107]
    ds_write_b128 v24, v[108:111] offset:1024
    s_nop 3
    ds_write_b128 v25, v[112:115]
    ds_write_b128 v25, v[116:119] offset:1024
    ds_write_b128 v26, v[120:123]
    ds_write_b128 v26, v[124:127] offset:1024
    s_waitcnt lgkmcnt(0)
    s_barrier
    ds_read_b128 v[104:107], v27 offset:0
    ds_read_b128 v[108:111], v27 offset:1024
    ds_read_b128 v[112:115], v27 offset:2048
    ds_read_b128 v[116:119], v27 offset:3072
    ds_read_b128 v[120:123], v27 offset:4096
    ds_read_b128 v[124:127], v27 offset:5120
    s_waitcnt lgkmcnt(5)
    v_pk_add_f32 v[96:97], v[96:97], v[104:105]
    v_pk_add_f32 v[98:99], v[98:99], v[106:107]
    s_waitcnt lgkmcnt(4)
    v_pk_add_f32 v[100:101], v[100:101], v[108:109]
    v_pk_add_f32 v[102:103], v[102:103], v[110:111]
    s_waitcnt lgkmcnt(3)
    v_pk_add_f32 v[96:97], v[96:97], v[112:113]
    v_pk_add_f32 v[98:99], v[98:99], v[114:115]
    s_waitcnt lgkmcnt(2)
    v_pk_add_f32 v[100:101], v[100:101], v[116:117]
    v_pk_add_f32 v[102:103], v[102:103], v[118:119]
    s_waitcnt lgkmcnt(1)
    v_pk_add_f32 v[96:97], v[96:97], v[120:121]
    v_pk_add_f32 v[98:99], v[98:99], v[122:123]
    s_waitcnt lgkmcnt(0)
    v_pk_add_f32 v[100:101], v[100:101], v[124:125]
    v_pk_add_f32 v[102:103], v[102:103], v[126:127]
    v_cvt_pk_bf16_f32 v104, v96, v97
    v_cvt_pk_bf16_f32 v105, v98, v99
    v_cvt_pk_bf16_f32 v106, v100, v101
    v_cvt_pk_bf16_f32 v107, v102, v103
    s_nop 0
    v_permlane32_swap_b32 v104, v106
    v_permlane32_swap_b32_e64 v105, v107
    buffer_store_dwordx4 v[104:107], v14, s[20:23], s86 offen
L_finish:
    s_cmp_lg_u32 s2, 0
    s_cbranch_scc1 L_end
    s_cmp_lg_u32 s32, 0
    s_cbranch_scc1 L_end
    s_mov_b64 exec, 1
    buffer_store_dwordx2 v[16:17], off, s[4:7], 0
L_end:
    s_endpgm
gstub_12:
    s_mov_b32 s74, 0
gl_107:
    buffer_load_dwordx4 v[192:195], v0, s[4:7], s76 offen sc1
    buffer_load_dwordx4 v[196:199], v0, s[4:7], s76 offen offset:1024 sc1
    buffer_load_dwordx4 v[200:203], v0, s[4:7], s76 offen offset:2048 sc1
    buffer_load_dwordx4 v[204:207], v0, s[4:7], s76 offen offset:3072 sc1
    s_add_u32 s94, s76, 4096
    buffer_load_dwordx4 v[208:211], v0, s[4:7], s94 offen sc1
    buffer_load_dwordx4 v[212:215], v0, s[4:7], s94 offen offset:1024 sc1
    buffer_load_dwordx4 v[216:219], v0, s[4:7], s94 offen offset:2048 sc1
    buffer_load_dwordx4 v[220:223], v0, s[4:7], s94 offen offset:3072 sc1
    buffer_load_dwordx4 v[224:227], v11, s[4:7], s76 offen sc1
    s_waitcnt vmcnt(0)
    v_max3_u32 v48, v192, v196, v200
    v_max3_u32 v48, v204, v208, v48
    v_max3_u32 v48, v212, v216, v48
    v_max3_u32 v48, v220, v224, v48
    v_cmp_eq_u32 vcc, -1, v48
    s_cbranch_vccz gback_13
    s_sleep 2
    s_add_u32 s74, s74, 1
    s_cmp_lt_u32 s74, 0x20000
    s_cbranch_scc1 gl_107
    s_mov_b32 s74, 2
    s_branch L_timeout
fstub_14:
    s_mov_b32 s74, 0
fl_108:
    buffer_load_dwordx2 v[60:61], v18, s[4:7], 0 offen sc1
    s_waitcnt vmcnt(0)
    v_cmp_ne_u64_e64 vcc, s[28:29], v[60:61]
    s_cbranch_vccz fback_15
    s_sleep 1
    s_add_u32 s74, s74, 1
    s_cmp_lt_u32 s74, 0x20000
    s_cbranch_scc1 fl_108
    s_mov_b32 s74, 3
    s_branch L_timeout
ss_18:
    s_nop 11
    buffer_store_dwordx2 v[16:17], off, s[4:7], s77 sc1
    s_branch sb_19
ss_25:
    s_nop 11
    buffer_store_dwordx2 v[16:17], off, s[4:7], s77 offset:128 sc1
    s_branch sb_26
ss_32:
    s_nop 11
    buffer_store_dwordx2 v[16:17], off, s[4:7], s9 offset:384 sc1
    s_branch sb_33
fstub_34:
    s_mov_b32 s74, 0
fl_109:
    buffer_load_dwordx2 v[60:61], v62, s[4:7], s10 offen offset:384 sc1
    s_waitcnt vmcnt(0)
    v_cmp_ne_u64_e64 vcc, s[28:29], v[60:61]
    s_cbranch_vccz fback_35
    s_sleep 1
    s_add_u32 s74, s74, 1
    s_cmp_lt_u32 s74, 0x20000
    s_cbranch_scc1 fl_109
    s_mov_b32 s74, 8
    s_branch L_timeout
ss_36:
    s_nop 11
    buffer_store_dwordx2 v[16:17], off, s[4:7], s87 sc1
    s_branch sb_37
ss_38:
    s_nop 11
    buffer_store_dwordx2 v[16:17], off, s[4:7], s87 offset:128 sc1
    s_branch sb_39
fstub_40:
    s_mov_b32 s74, 0
fl_110:
    buffer_load_dwordx2 v[60:61], v15, s[4:7], s92 offen sc1
    s_waitcnt vmcnt(0)
    v_cmp_ne_u64_e64 vcc, s[28:29], v[60:61]
    s_cbranch_vccz fback_41
    s_sleep 1
    s_add_u32 s74, s74, 1
    s_cmp_lt_u32 s74, 0x20000
    s_cbranch_scc1 fl_110
    s_mov_b32 s74, 4
    s_branch L_timeout
ss_42:
    s_nop 11
    buffer_store_dwordx2 v[16:17], off, s[4:7], s87 offset:256 sc1
    s_branch sb_43
fstub_44:
    s_mov_b32 s74, 0
fl_111:
    buffer_load_dwordx2 v[60:61], v15, s[4:7], s92 offen offset:128 sc1
    s_waitcnt vmcnt(0)
    v_cmp_ne_u64_e64 vcc, s[28:29], v[60:61]
    s_cbranch_vccz fback_45
    s_sleep 1
    s_add_u32 s74, s74, 1
    s_cmp_lt_u32 s74, 0x20000
    s_cbranch_scc1 fl_111
    s_mov_b32 s74, 5
    s_branch L_timeout
fstub_46:
    s_mov_b32 s74, 0
fl_112:
    buffer_load_dwordx2 v[60:61], v15, s[4:7], s92 offen offset:256 sc1
    s_waitcnt vmcnt(0)
    v_cmp_ne_u64_e64 vcc, s[28:29], v[60:61]
    s_cbranch_vccz fback_47
    s_sleep 1
    s_add_u32 s74, s74, 1
    s_cmp_lt_u32 s74, 0x20000
    s_cbranch_scc1 fl_112
    s_mov_b32 s74, 6
    s_branch L_timeout
ss_48:
    s_nop 11
    buffer_store_dwordx4 v[72:75], v0, s[4:7], s69 offen sc1
    s_branch sb_49
ss_50:
    s_nop 11
    buffer_store_dwordx4 v[104:107], v0, s[4:7], s70 offen sc1
    s_branch sb_51
ss_54:
    s_nop 11
    buffer_store_dwordx2 v[16:17], off, s[4:7], s77 offset:256 sc1
    s_branch sb_55
ss_61:
    s_nop 11
    buffer_store_dword v48, v1, s[4:7], s71 offen sc1
    s_branch sb_62
ss_63:
    s_nop 11
    buffer_store_dwordx2 v[16:17], off, s[4:7], s9 offset:448 sc1
    s_branch sb_64
fstub_65:
    s_mov_b32 s74, 0
fl_113:
    buffer_load_dwordx2 v[60:61], v62, s[4:7], s10 offen offset:448 sc1
    s_waitcnt vmcnt(0)
    v_cmp_ne_u64_e64 vcc, s[28:29], v[60:61]
    s_cbranch_vccz fback_66
    s_sleep 1
    s_add_u32 s74, s74, 1
    s_cmp_lt_u32 s74, 0x20000
    s_cbranch_scc1 fl_113
    s_mov_b32 s74, 8
    s_branch L_timeout
gstub_67:
    s_mov_b32 s74, 0
gl_114:
    buffer_load_dwordx4 v[192:195], v0, s[4:7], s76 offen sc1
    buffer_load_dwordx4 v[196:199], v0, s[4:7], s76 offen offset:1024 sc1
    buffer_load_dwordx4 v[200:203], v0, s[4:7], s76 offen offset:2048 sc1
    buffer_load_dwordx4 v[204:207], v0, s[4:7], s76 offen offset:3072 sc1
    s_add_u32 s94, s76, 4096
    buffer_load_dwordx4 v[208:211], v0, s[4:7], s94 offen sc1
    buffer_load_dwordx4 v[212:215], v0, s[4:7], s94 offen offset:1024 sc1
    buffer_load_dwordx4 v[216:219], v0, s[4:7], s94 offen offset:2048 sc1
    buffer_load_dwordx4 v[220:223], v0, s[4:7], s94 offen offset:3072 sc1
    buffer_load_dwordx4 v[224:227], v11, s[4:7], s76 offen sc1
    s_waitcnt vmcnt(0)
    v_max3_u32 v48, v192, v196, v200
    v_max3_u32 v48, v204, v208, v48
    v_max3_u32 v48, v212, v216, v48
    v_max3_u32 v48, v220, v224, v48
    v_cmp_eq_u32_e64 vcc, -1, v48
    s_cbranch_vccz gback_68
    s_sleep 2
    s_add_u32 s74, s74, 1
    s_cmp_lt_u32 s74, 0x20000
    s_cbranch_scc1 gl_114
    s_mov_b32 s74, 2
    s_branch L_timeout
ss_71:
    s_nop 11
    buffer_store_dwordx2 v[16:17], off, s[4:7], s77 offset:384 sc1
    s_branch sb_72
ss_76:
    s_nop 11
    buffer_store_dwordx4 v[72:75], v0, s[4:7], s69 offen sc1
    s_branch sb_77
ss_78:
    s_nop 11
    buffer_store_dwordx4 v[104:107], v0, s[4:7], s70 offen sc1
    s_branch sb_79
ss_82:
    s_nop 11
    buffer_store_dwordx2 v[16:17], off, s[4:7], s77 offset:512 sc1
    s_branch sb_83
ss_89:
    s_nop 11
    buffer_store_dword v48, v1, s[4:7], s71 offen sc1
    s_branch sb_90
ss_91:
    s_nop 11
    buffer_store_dwordx2 v[16:17], off, s[4:7], s9 offset:896 sc1
    s_branch sb_92
fstub_93:
    s_mov_b32 s74, 0
fl_115:
    buffer_load_dwordx2 v[60:61], v62, s[4:7], s10 offen offset:896 sc1
    s_waitcnt vmcnt(0)
    v_cmp_ne_u64_e64 vcc, s[28:29], v[60:61]
    s_cbranch_vccz fback_94
    s_sleep 1
    s_add_u32 s74, s74, 1
    s_cmp_lt_u32 s74, 0x20000
    s_cbranch_scc1 fl_115
    s_mov_b32 s74, 8
    s_branch L_timeout
ss_95:
    s_nop 11
    buffer_store_dwordx2 v[16:17], off, s[4:7], s87 offset:512 sc1
    s_branch sb_96
ss_97:
    s_nop 11
    buffer_store_dwordx2 v[16:17], off, s[4:7], s87 offset:640 sc1
    s_branch sb_98
fstub_99:
    s_mov_b32 s74, 0
fl_116:
    buffer_load_dwordx2 v[60:61], v15, s[4:7], s92 offen offset:512 sc1
    s_waitcnt vmcnt(0)
    v_cmp_ne_u64_e64 vcc, s[28:29], v[60:61]
    s_cbranch_vccz fback_100
    s_sleep 1
    s_add_u32 s74, s74, 1
    s_cmp_lt_u32 s74, 0x20000
    s_cbranch_scc1 fl_116
    s_mov_b32 s74, 4
    s_branch L_timeout
ss_101:
    s_nop 11
    buffer_store_dwordx2 v[16:17], off, s[4:7], s87 offset:768 sc1
    s_branch sb_102
fstub_103:
    s_mov_b32 s74, 0
fl_117:
    buffer_load_dwordx2 v[60:61], v15, s[4:7], s92 offen offset:640 sc1
    s_waitcnt vmcnt(0)
    v_cmp_ne_u64_e64 vcc, s[28:29], v[60:61]
    s_cbranch_vccz fback_104
    s_sleep 1
    s_add_u32 s74, s74, 1
    s_cmp_lt_u32 s74, 0x20000
    s_cbranch_scc1 fl_117
    s_mov_b32 s74, 5
    s_branch L_timeout
fstub_105:
    s_mov_b32 s74, 0
fl_118:
    buffer_load_dwordx2 v[60:61], v15, s[4:7], s92 offen offset:768 sc1
    s_waitcnt vmcnt(0)
    v_cmp_ne_u64_e64 vcc, s[28:29], v[60:61]
    s_cbranch_vccz fback_106
    s_sleep 1
    s_add_u32 s74, s74, 1
    s_cmp_lt_u32 s74, 0x20000
    s_cbranch_scc1 fl_118
    s_mov_b32 s74, 6
    s_branch L_timeout
L_timeout:
    v_mov_b32 v48, s74
    v_mov_b32 v49, 0
    s_mov_b64 exec, 1
    global_store_dword v49, v48, s[58:59]
    s_endpgm
L_codeend:
.section .rodata,"a"
.p2align 6
.amdhsa_kernel interleave_layers__linear_kernel_hedgehog__geglu_ffn__prompt_kernel
  .amdhsa_next_free_vgpr 512
  .amdhsa_next_free_sgpr 102
  .amdhsa_accum_offset 256
  .amdhsa_group_segment_fixed_size 0
  .amdhsa_kernarg_size 88
  .amdhsa_user_sgpr_count 2
  .amdhsa_user_sgpr_kernarg_segment_ptr 1
  .amdhsa_system_sgpr_workgroup_id_x 1
.end_amdhsa_kernel
```
